```python
import torch

def _softmax(x, axis=-1):
    return torch.softmax(x, dim=axis)
def _gelu(x):
    return torch.nn.functional.gelu(x, approximate="tanh")
def _silu(x):
    return torch.nn.functional.silu(x)
def _sigmoid(x):
    return torch.sigmoid(x)
def _layernorm(x, axis=-1, eps=1e-5):
    m = x.mean(dim=axis, keepdim=True)
    v = x.var(dim=axis, keepdim=True, unbiased=False)
    return (x - m) / torch.sqrt(v + eps)
def _scatter_add(tgt, idx, src, axis=0):
    return tgt.clone().index_add_(axis, idx, src)
def _segment_sum(src, seg, n):
    out = torch.zeros((n,) + src.shape[1:], dtype=src.dtype)
    return out.index_add_(0, seg, src)
def _pad(x, pw):
    flat = tuple(v for pair in reversed(pw) for v in pair)
    return torch.nn.functional.pad(x, flat)

kernel_name = 'recurrent_scan__linear_kernel_hedgehog__dense_activation_gelu__prompt'

def setup_inputs():

    _w = (lambda a: (lambda t: t.to(torch.bfloat16) if t.is_floating_point() else t)(torch.as_tensor(a)))
    def _A_setup():
        B, S, D, H = 1, 2048, 576, 32
        Dh = D // H
        return {
            "x": _w((lambda *s: torch.randn(*s, dtype=torch.bfloat16) * 0.05)(B, S, D)),
            "wqkv": _w((lambda *s: torch.randn(*s, dtype=torch.bfloat16) * 0.4)(D, 3 * D)),
            "w_phi": _w((lambda *s: torch.randn(*s, dtype=torch.bfloat16) * 0.4)(H, Dh, Dh) * (Dh ** -0.5)),
            "wo": _w((lambda *s: torch.randn(*s, dtype=torch.bfloat16) * 0.2)(D, D)),
        }
    _A_in = _A_setup()

    def _B_setup():
        B, S, D, F = 1, 2048, 576, 4608
        return {
            "x": _w((lambda *s: torch.randn(*s, dtype=torch.bfloat16) * 0.05)(B, S, D)),
            "w1": _w((lambda *s: torch.randn(*s, dtype=torch.bfloat16) * 0.4)(D, F) * (D ** -0.5)),
            "b1": _w((lambda *s: torch.randn(*s, dtype=torch.bfloat16) * 12.8)(F) * 0.01),
            "w2": _w((lambda *s: torch.randn(*s, dtype=torch.bfloat16) * 0.1)(F, D) * (F ** -0.5)),
            "b2": _w((lambda *s: torch.randn(*s, dtype=torch.bfloat16) * 0.8)(D) * 0.01),
        }
    _B_in = _B_setup()

    return {
        "A_x": _A_in["x"],
        "A_wqkv": _A_in["wqkv"],
        "A_w_phi": _A_in["w_phi"],
        "A_wo": _A_in["wo"],
        "B_x": _B_in["x"],
        "B_w1": _B_in["w1"],
        "B_b1": _B_in["b1"],
        "B_w2": _B_in["w2"],
        "B_b2": _B_in["b2"],
    }

def reference(A_x, A_wqkv, A_w_phi, A_wo, B_x, B_w1, B_b1, B_w2, B_b2):
    def _A_ref(x, wqkv, w_phi, wo):
        B, S, D = x.shape
        H = 32; Dh = D // H
        qkv = (lambda x, *d: x.permute(*d))((x @ wqkv).reshape(B, S, 3, H, Dh), 2, 0, 3, 1, 4)
        q, k, v = qkv[0], qkv[1], qkv[2]
        pq = torch.einsum("bhsd,hdf->bhsf", q, w_phi)
        pk = torch.einsum("bhsd,hdf->bhsf", k, w_phi)
        phi_q = torch.concatenate([_softmax(pq, axis=-1), _softmax(-pq, axis=-1)], axis=-1)
        phi_k = torch.concatenate([_softmax(pk, axis=-1), _softmax(-pk, axis=-1)], axis=-1)
        kv = torch.einsum("bhsf,bhsd->bhfd", phi_k, v)
        z  = torch.einsum("bhsf->bhf", phi_k)
        num = torch.einsum("bhqf,bhfd->bhqd", phi_q, kv)
        den = torch.einsum("bhqf,bhf->bhq", phi_q, z)[..., None] + 1e-6
        o = num / den
        return (lambda x, *d: x.permute(*d))(o, 0, 2, 1, 3).reshape(B, S, D) @ wo

    def _B_ref(x, w1, b1, w2, b2):
        h = torch.einsum("bsd,df->bsf", x, w1) + b1
        h = _gelu(h)
        return torch.einsum("bsf,fd->bsd", h, w2) + b2

    x = A_x
    xn = _layernorm(x, axis=-1)
    s = _A_ref(xn, A_wqkv, A_w_phi, A_wo)
    g = _silu(_B_ref(xn, B_w1, B_b1, B_w2, B_b2))
    return x + s * g
```

```asm
; @launch kernel=k_ln_kernel grid=(256,1,1) block=(256,1,1) lds=0
; @launch kernel=k_qkv_kernel grid=(192,1,1) block=(256,1,1) lds=38912
; @launch kernel=k_l3_kernel grid=(768,1,1) block=(256,1,1) lds=44288
; @launch kernel=k_l4_kernel grid=(512,1,1) block=(256,1,1) lds=38912
; @launch kernel=k_final_kernel grid=(128,1,1) block=(256,1,1) lds=38912
.amdgcn_target "amdgcn-amd-amdhsa--gfx950"
.text
.globl k_ln_kernel
.p2align 8
.type k_ln_kernel,@function
k_ln_kernel:
    s_cmp_ge_u32 s2, 256
    s_cbranch_scc1 L_k_ln_kernel_end
    s_load_dwordx2 s[4:5], s[0:1], 0
    s_load_dwordx2 s[6:7], s[0:1], 88
    v_lshrrev_b32 v1, 5, v0
    v_and_b32 v2, 31, v0
    s_lshl_b32 s3, s2, 3
    v_add_u32 v1, s3, v1
    v_mul_u32_u24 v1, 1152, v1
    v_mul_u32_u24 v2, 36, v2
    v_add_u32 v1, v1, v2
    s_waitcnt lgkmcnt(0)
    s_mov_b32 s8, s4
    s_mov_b32 s9, s5
    s_mov_b32 s10, 2359296
    s_mov_b32 s11, 0x00020000
    s_mov_b32 s12, s6
    s_mov_b32 s13, s7
    s_mov_b32 s14, 2359296
    s_mov_b32 s15, 0x00020000
    buffer_load_dwordx4 v[4:7], v1, s[8:11], 0 offen
    buffer_load_dwordx4 v[8:11], v1, s[8:11], 0 offen offset:16
    buffer_load_dword v12, v1, s[8:11], 0 offen offset:32
    s_waitcnt vmcnt(0)
    v_lshlrev_b32 v16, 16, v4
    v_and_b32 v17, 0xffff0000, v4
    v_lshlrev_b32 v18, 16, v5
    v_and_b32 v19, 0xffff0000, v5
    v_lshlrev_b32 v20, 16, v6
    v_and_b32 v21, 0xffff0000, v6
    v_lshlrev_b32 v22, 16, v7
    v_and_b32 v23, 0xffff0000, v7
    v_lshlrev_b32 v24, 16, v8
    v_and_b32 v25, 0xffff0000, v8
    v_lshlrev_b32 v26, 16, v9
    v_and_b32 v27, 0xffff0000, v9
    v_lshlrev_b32 v28, 16, v10
    v_and_b32 v29, 0xffff0000, v10
    v_lshlrev_b32 v30, 16, v11
    v_and_b32 v31, 0xffff0000, v11
    v_lshlrev_b32 v32, 16, v12
    v_and_b32 v33, 0xffff0000, v12
    v_add_f32 v40, v16, v17
    v_add_f32 v40, v40, v18
    v_add_f32 v40, v40, v19
    v_add_f32 v40, v40, v20
    v_add_f32 v40, v40, v21
    v_add_f32 v40, v40, v22
    v_add_f32 v40, v40, v23
    v_add_f32 v40, v40, v24
    v_add_f32 v40, v40, v25
    v_add_f32 v40, v40, v26
    v_add_f32 v40, v40, v27
    v_add_f32 v40, v40, v28
    v_add_f32 v40, v40, v29
    v_add_f32 v40, v40, v30
    v_add_f32 v40, v40, v31
    v_add_f32 v40, v40, v32
    v_add_f32 v40, v40, v33
    ds_swizzle_b32 v41, v40 offset:0x041F
    s_waitcnt lgkmcnt(0)
    v_add_f32 v40, v40, v41
    ds_swizzle_b32 v41, v40 offset:0x081F
    s_waitcnt lgkmcnt(0)
    v_add_f32 v40, v40, v41
    ds_swizzle_b32 v41, v40 offset:0x101F
    s_waitcnt lgkmcnt(0)
    v_add_f32 v40, v40, v41
    ds_swizzle_b32 v41, v40 offset:0x201F
    s_waitcnt lgkmcnt(0)
    v_add_f32 v40, v40, v41
    ds_swizzle_b32 v41, v40 offset:0x401F
    s_waitcnt lgkmcnt(0)
    v_add_f32 v40, v40, v41
    v_mul_f32 v40, 0x3ae38e39, v40
    v_sub_f32 v42, v16, v40
    v_mul_f32 v43, v42, v42
    v_sub_f32 v42, v17, v40
    v_fmac_f32 v43, v42, v42
    v_sub_f32 v42, v18, v40
    v_fmac_f32 v43, v42, v42
    v_sub_f32 v42, v19, v40
    v_fmac_f32 v43, v42, v42
    v_sub_f32 v42, v20, v40
    v_fmac_f32 v43, v42, v42
    v_sub_f32 v42, v21, v40
    v_fmac_f32 v43, v42, v42
    v_sub_f32 v42, v22, v40
    v_fmac_f32 v43, v42, v42
    v_sub_f32 v42, v23, v40
    v_fmac_f32 v43, v42, v42
    v_sub_f32 v42, v24, v40
    v_fmac_f32 v43, v42, v42
    v_sub_f32 v42, v25, v40
    v_fmac_f32 v43, v42, v42
    v_sub_f32 v42, v26, v40
    v_fmac_f32 v43, v42, v42
    v_sub_f32 v42, v27, v40
    v_fmac_f32 v43, v42, v42
    v_sub_f32 v42, v28, v40
    v_fmac_f32 v43, v42, v42
    v_sub_f32 v42, v29, v40
    v_fmac_f32 v43, v42, v42
    v_sub_f32 v42, v30, v40
    v_fmac_f32 v43, v42, v42
    v_sub_f32 v42, v31, v40
    v_fmac_f32 v43, v42, v42
    v_sub_f32 v42, v32, v40
    v_fmac_f32 v43, v42, v42
    v_sub_f32 v42, v33, v40
    v_fmac_f32 v43, v42, v42
    ds_swizzle_b32 v41, v43 offset:0x041F
    s_waitcnt lgkmcnt(0)
    v_add_f32 v43, v43, v41
    ds_swizzle_b32 v41, v43 offset:0x081F
    s_waitcnt lgkmcnt(0)
    v_add_f32 v43, v43, v41
    ds_swizzle_b32 v41, v43 offset:0x101F
    s_waitcnt lgkmcnt(0)
    v_add_f32 v43, v43, v41
    ds_swizzle_b32 v41, v43 offset:0x201F
    s_waitcnt lgkmcnt(0)
    v_add_f32 v43, v43, v41
    ds_swizzle_b32 v41, v43 offset:0x401F
    s_waitcnt lgkmcnt(0)
    v_add_f32 v43, v43, v41
    v_mul_f32 v43, 0x3ae38e39, v43
    v_cvt_pk_bf16_f32 v44, v40, v40
    v_lshlrev_b32 v40, 16, v44
    v_cvt_pk_bf16_f32 v44, v43, v43
    v_lshlrev_b32 v43, 16, v44
    v_add_f32 v43, 0x3727c5ac, v43
    v_cvt_pk_bf16_f32 v44, v43, v43
    v_lshlrev_b32 v43, 16, v44
    v_sqrt_f32 v43, v43
    s_nop 0
    v_cvt_pk_bf16_f32 v44, v43, v43
    v_lshlrev_b32 v43, 16, v44
    v_rcp_f32 v45, v43
    v_sub_f32 v16, v16, v40
    v_sub_f32 v17, v17, v40
    v_sub_f32 v18, v18, v40
    v_sub_f32 v19, v19, v40
    v_sub_f32 v20, v20, v40
    v_sub_f32 v21, v21, v40
    v_sub_f32 v22, v22, v40
    v_sub_f32 v23, v23, v40
    v_sub_f32 v24, v24, v40
    v_sub_f32 v25, v25, v40
    v_sub_f32 v26, v26, v40
    v_sub_f32 v27, v27, v40
    v_sub_f32 v28, v28, v40
    v_sub_f32 v29, v29, v40
    v_sub_f32 v30, v30, v40
    v_sub_f32 v31, v31, v40
    v_sub_f32 v32, v32, v40
    v_sub_f32 v33, v33, v40
    v_cvt_pk_bf16_f32 v44, v16, v17
    v_lshlrev_b32 v16, 16, v44
    v_and_b32 v17, 0xffff0000, v44
    v_cvt_pk_bf16_f32 v44, v18, v19
    v_lshlrev_b32 v18, 16, v44
    v_and_b32 v19, 0xffff0000, v44
    v_cvt_pk_bf16_f32 v44, v20, v21
    v_lshlrev_b32 v20, 16, v44
    v_and_b32 v21, 0xffff0000, v44
    v_cvt_pk_bf16_f32 v44, v22, v23
    v_lshlrev_b32 v22, 16, v44
    v_and_b32 v23, 0xffff0000, v44
    v_cvt_pk_bf16_f32 v44, v24, v25
    v_lshlrev_b32 v24, 16, v44
    v_and_b32 v25, 0xffff0000, v44
    v_cvt_pk_bf16_f32 v44, v26, v27
    v_lshlrev_b32 v26, 16, v44
    v_and_b32 v27, 0xffff0000, v44
    v_cvt_pk_bf16_f32 v44, v28, v29
    v_lshlrev_b32 v28, 16, v44
    v_and_b32 v29, 0xffff0000, v44
    v_cvt_pk_bf16_f32 v44, v30, v31
    v_lshlrev_b32 v30, 16, v44
    v_and_b32 v31, 0xffff0000, v44
    v_cvt_pk_bf16_f32 v44, v32, v33
    v_lshlrev_b32 v32, 16, v44
    v_and_b32 v33, 0xffff0000, v44
    v_mul_f32 v16, v16, v45
    v_mul_f32 v17, v17, v45
    v_mul_f32 v18, v18, v45
    v_mul_f32 v19, v19, v45
    v_mul_f32 v20, v20, v45
    v_mul_f32 v21, v21, v45
    v_mul_f32 v22, v22, v45
    v_mul_f32 v23, v23, v45
    v_mul_f32 v24, v24, v45
    v_mul_f32 v25, v25, v45
    v_mul_f32 v26, v26, v45
    v_mul_f32 v27, v27, v45
    v_mul_f32 v28, v28, v45
    v_mul_f32 v29, v29, v45
    v_mul_f32 v30, v30, v45
    v_mul_f32 v31, v31, v45
    v_mul_f32 v32, v32, v45
    v_mul_f32 v33, v33, v45
    v_cvt_pk_bf16_f32 v4, v16, v17
    v_cvt_pk_bf16_f32 v5, v18, v19
    v_cvt_pk_bf16_f32 v6, v20, v21
    v_cvt_pk_bf16_f32 v7, v22, v23
    v_cvt_pk_bf16_f32 v8, v24, v25
    v_cvt_pk_bf16_f32 v9, v26, v27
    v_cvt_pk_bf16_f32 v10, v28, v29
    v_cvt_pk_bf16_f32 v11, v30, v31
    v_cvt_pk_bf16_f32 v12, v32, v33
    buffer_store_dwordx4 v[4:7], v1, s[12:15], 0 offen
    buffer_store_dwordx4 v[8:11], v1, s[12:15], 0 offen offset:16
    buffer_store_dword v12, v1, s[12:15], 0 offen offset:32
L_k_ln_kernel_end:
    s_endpgm
.globl k_qkv_kernel
.p2align 8
.type k_qkv_kernel,@function
k_qkv_kernel:
    s_cmp_ge_u32 s2, 192
    s_cbranch_scc1 L_k_qkv_kernel_end
    s_load_dwordx2 s[4:5], s[0:1], 88
    s_load_dwordx2 s[6:7], s[0:1], 8
    s_load_dwordx2 s[16:17], s[0:1], 88
    s_and_b32 s20, s2, 15
    s_lshr_b32 s21, s2, 4
    s_mov_b32 s22, s21
    s_mov_b32 s23, 0
    v_and_b32 v1, 63, v0
    v_lshrrev_b32 v2, 6, v0
    v_and_b32 v3, 15, v1
    v_lshrrev_b32 v4, 4, v1
    s_mul_i32 s24, s20, 128
    v_mul_u32_u24 v5, 32, v2
    v_add_u32 v5, v5, v3
    v_add_u32 v5, s24, v5
    v_add_u32 v6, 0, v5
    s_mov_b32 s25, 1152
    v_mul_lo_u32 v6, v6, s25
    v_lshlrev_b32 v7, 4, v4
    v_add_u32 v10, v6, v7
    v_add_u32 v6, 16, v5
    s_mov_b32 s25, 1152
    v_mul_lo_u32 v6, v6, s25
    v_lshlrev_b32 v7, 4, v4
    v_add_u32 v11, v6, v7
    v_add_u32 v6, 0, v0
    s_mov_b32 s25, 0x71c71c8
    v_mul_hi_u32 v7, v6, s25
    v_mul_u32_u24 v8, 36, v7
    v_sub_u32 v8, v6, v8
    s_mov_b32 s25, 3456
    v_mul_lo_u32 v9, v7, s25
    v_lshl_add_u32 v12, v8, 3, v9
    v_lshrrev_b32 v9, 3, v7
    v_mul_u32_u24 v9, 2432, v9
    v_and_b32 v6, 7, v7
    v_mul_u32_u24 v6, 288, v6
    v_add_u32 v9, v9, v6
    v_lshl_add_u32 v21, v8, 3, v9
    v_add_u32 v6, 256, v0
    s_mov_b32 s25, 0x71c71c8
    v_mul_hi_u32 v7, v6, s25
    v_mul_u32_u24 v8, 36, v7
    v_sub_u32 v8, v6, v8
    s_mov_b32 s25, 3456
    v_mul_lo_u32 v9, v7, s25
    v_lshl_add_u32 v13, v8, 3, v9
    v_lshrrev_b32 v9, 3, v7
    v_mul_u32_u24 v9, 2432, v9
    v_and_b32 v6, 7, v7
    v_mul_u32_u24 v6, 288, v6
    v_add_u32 v9, v9, v6
    v_lshl_add_u32 v22, v8, 3, v9
    v_add_u32 v6, 512, v0
    s_mov_b32 s25, 0x71c71c8
    v_mul_hi_u32 v7, v6, s25
    v_mul_u32_u24 v8, 36, v7
    v_sub_u32 v8, v6, v8
    s_mov_b32 s25, 3456
    v_mul_lo_u32 v9, v7, s25
    v_lshl_add_u32 v14, v8, 3, v9
    v_lshrrev_b32 v9, 3, v7
    v_mul_u32_u24 v9, 2432, v9
    v_and_b32 v6, 7, v7
    v_mul_u32_u24 v6, 288, v6
    v_add_u32 v9, v9, v6
    v_lshl_add_u32 v23, v8, 3, v9
    v_add_u32 v6, 768, v0
    s_mov_b32 s25, 0x71c71c8
    v_mul_hi_u32 v7, v6, s25
    v_mul_u32_u24 v8, 36, v7
    v_sub_u32 v8, v6, v8
    s_mov_b32 s25, 3456
    v_mul_lo_u32 v9, v7, s25
    v_lshl_add_u32 v15, v8, 3, v9
    v_lshrrev_b32 v9, 3, v7
    v_mul_u32_u24 v9, 2432, v9
    v_and_b32 v6, 7, v7
    v_mul_u32_u24 v6, 288, v6
    v_add_u32 v9, v9, v6
    v_lshl_add_u32 v24, v8, 3, v9
    v_add_u32 v6, 1024, v0
    s_mov_b32 s25, 0x71c71c8
    v_mul_hi_u32 v7, v6, s25
    v_mul_u32_u24 v8, 36, v7
    v_sub_u32 v8, v6, v8
    s_mov_b32 s25, 3456
    v_mul_lo_u32 v9, v7, s25
    v_lshl_add_u32 v16, v8, 3, v9
    v_lshrrev_b32 v9, 3, v7
    v_mul_u32_u24 v9, 2432, v9
    v_and_b32 v6, 7, v7
    v_mul_u32_u24 v6, 288, v6
    v_add_u32 v9, v9, v6
    v_lshl_add_u32 v25, v8, 3, v9
    v_add_u32 v6, 1280, v0
    s_mov_b32 s25, 0x71c71c8
    v_mul_hi_u32 v7, v6, s25
    v_mul_u32_u24 v8, 36, v7
    v_sub_u32 v8, v6, v8
    s_mov_b32 s25, 3456
    v_mul_lo_u32 v9, v7, s25
    v_lshl_add_u32 v17, v8, 3, v9
    v_lshrrev_b32 v9, 3, v7
    v_mul_u32_u24 v9, 2432, v9
    v_and_b32 v6, 7, v7
    v_mul_u32_u24 v6, 288, v6
    v_add_u32 v9, v9, v6
    v_lshl_add_u32 v26, v8, 3, v9
    v_add_u32 v6, 1536, v0
    s_mov_b32 s25, 0x71c71c8
    v_mul_hi_u32 v7, v6, s25
    v_mul_u32_u24 v8, 36, v7
    v_sub_u32 v8, v6, v8
    s_mov_b32 s25, 3456
    v_mul_lo_u32 v9, v7, s25
    v_lshl_add_u32 v18, v8, 3, v9
    v_lshrrev_b32 v9, 3, v7
    v_mul_u32_u24 v9, 2432, v9
    v_and_b32 v6, 7, v7
    v_mul_u32_u24 v6, 288, v6
    v_add_u32 v9, v9, v6
    v_lshl_add_u32 v27, v8, 3, v9
    v_add_u32 v6, 1792, v0
    s_mov_b32 s25, 0x71c71c8
    v_mul_hi_u32 v7, v6, s25
    v_mul_u32_u24 v8, 36, v7
    v_sub_u32 v8, v6, v8
    s_mov_b32 s25, 3456
    v_mul_lo_u32 v9, v7, s25
    v_lshl_add_u32 v19, v8, 3, v9
    v_lshrrev_b32 v9, 3, v7
    v_mul_u32_u24 v9, 2432, v9
    v_and_b32 v6, 7, v7
    v_mul_u32_u24 v6, 288, v6
    v_add_u32 v9, v9, v6
    v_lshl_add_u32 v28, v8, 3, v9
    v_add_u32 v6, 2048, v0
    s_mov_b32 s25, 0x71c71c8
    v_mul_hi_u32 v7, v6, s25
    v_mul_u32_u24 v8, 36, v7
    v_sub_u32 v8, v6, v8
    s_mov_b32 s25, 3456
    v_mul_lo_u32 v9, v7, s25
    v_lshl_add_u32 v20, v8, 3, v9
    v_lshrrev_b32 v9, 3, v7
    v_mul_u32_u24 v9, 2432, v9
    v_and_b32 v6, 7, v7
    v_mul_u32_u24 v6, 288, v6
    v_add_u32 v9, v9, v6
    v_lshl_add_u32 v29, v8, 3, v9
    v_mul_u32_u24 v30, 2432, v4
    v_lshrrev_b32 v6, 2, v3
    v_mul_u32_u24 v6, 288, v6
    v_add_u32 v30, v30, v6
    v_and_b32 v6, 3, v1
    v_lshl_add_u32 v30, v6, 3, v30
    s_waitcnt lgkmcnt(0)
    s_mov_b32 s8, s4
    s_mov_b32 s9, s5
    s_mov_b32 s10, 2359296
    s_mov_b32 s11, 0x00020000
    s_mul_i32 s26, s22, 288
    s_add_u32 s12, s6, s26
    s_addc_u32 s13, s7, 0
    s_sub_u32 s14, 1990656, s26
    s_mov_b32 s15, 0x00020000
    s_mul_i32 s27, s23, 1152
    s_mul_i32 s28, s23, 1990656
    v_mov_b32 v156, 0
    v_mov_b32 v157, 0
    v_mov_b32 v158, 0
    v_mov_b32 v159, 0
    v_mov_b32 v160, 0
    v_mov_b32 v161, 0
    v_mov_b32 v162, 0
    v_mov_b32 v163, 0
    v_mov_b32 v164, 0
    v_mov_b32 v165, 0
    v_mov_b32 v166, 0
    v_mov_b32 v167, 0
    v_mov_b32 v168, 0
    v_mov_b32 v169, 0
    v_mov_b32 v170, 0
    v_mov_b32 v171, 0
    v_mov_b32 v172, 0
    v_mov_b32 v173, 0
    v_mov_b32 v174, 0
    v_mov_b32 v175, 0
    v_mov_b32 v176, 0
    v_mov_b32 v177, 0
    v_mov_b32 v178, 0
    v_mov_b32 v179, 0
    v_mov_b32 v180, 0
    v_mov_b32 v181, 0
    v_mov_b32 v182, 0
    v_mov_b32 v183, 0
    v_mov_b32 v184, 0
    v_mov_b32 v185, 0
    v_mov_b32 v186, 0
    v_mov_b32 v187, 0
    v_mov_b32 v188, 0
    v_mov_b32 v189, 0
    v_mov_b32 v190, 0
    v_mov_b32 v191, 0
    v_mov_b32 v192, 0
    v_mov_b32 v193, 0
    v_mov_b32 v194, 0
    v_mov_b32 v195, 0
    v_mov_b32 v196, 0
    v_mov_b32 v197, 0
    v_mov_b32 v198, 0
    v_mov_b32 v199, 0
    v_mov_b32 v200, 0
    v_mov_b32 v201, 0
    v_mov_b32 v202, 0
    v_mov_b32 v203, 0
    v_mov_b32 v204, 0
    v_mov_b32 v205, 0
    v_mov_b32 v206, 0
    v_mov_b32 v207, 0
    v_mov_b32 v208, 0
    v_mov_b32 v209, 0
    v_mov_b32 v210, 0
    v_mov_b32 v211, 0
    v_mov_b32 v212, 0
    v_mov_b32 v213, 0
    v_mov_b32 v214, 0
    v_mov_b32 v215, 0
    v_mov_b32 v216, 0
    v_mov_b32 v217, 0
    v_mov_b32 v218, 0
    v_mov_b32 v219, 0
    v_mov_b32 v220, 0
    v_mov_b32 v221, 0
    v_mov_b32 v222, 0
    v_mov_b32 v223, 0
    v_mov_b32 v224, 0
    v_mov_b32 v225, 0
    v_mov_b32 v226, 0
    v_mov_b32 v227, 0
    s_add_u32 s29, s28, 0
    buffer_load_dwordx2 v[80:81], v12, s[12:15], s29 offen
    buffer_load_dwordx2 v[82:83], v13, s[12:15], s29 offen
    buffer_load_dwordx2 v[84:85], v14, s[12:15], s29 offen
    buffer_load_dwordx2 v[86:87], v15, s[12:15], s29 offen
    buffer_load_dwordx2 v[88:89], v16, s[12:15], s29 offen
    buffer_load_dwordx2 v[90:91], v17, s[12:15], s29 offen
    buffer_load_dwordx2 v[92:93], v18, s[12:15], s29 offen
    buffer_load_dwordx2 v[94:95], v19, s[12:15], s29 offen
    buffer_load_dwordx2 v[96:97], v20, s[12:15], s29 offen
    s_add_u32 s30, s27, 0
    buffer_load_dwordx4 v[32:35], v10, s[8:11], s30 offen offset:0
    buffer_load_dwordx4 v[36:39], v10, s[8:11], s30 offen offset:64
    buffer_load_dwordx4 v[40:43], v11, s[8:11], s30 offen offset:0
    buffer_load_dwordx4 v[44:47], v11, s[8:11], s30 offen offset:64
    s_add_u32 s29, s28, 221184
    buffer_load_dwordx2 v[98:99], v12, s[12:15], s29 offen
    buffer_load_dwordx2 v[100:101], v13, s[12:15], s29 offen
    buffer_load_dwordx2 v[102:103], v14, s[12:15], s29 offen
    buffer_load_dwordx2 v[104:105], v15, s[12:15], s29 offen
    buffer_load_dwordx2 v[106:107], v16, s[12:15], s29 offen
    buffer_load_dwordx2 v[108:109], v17, s[12:15], s29 offen
    buffer_load_dwordx2 v[110:111], v18, s[12:15], s29 offen
    buffer_load_dwordx2 v[112:113], v19, s[12:15], s29 offen
    buffer_load_dwordx2 v[114:115], v20, s[12:15], s29 offen
    s_add_u32 s30, s27, 128
    buffer_load_dwordx4 v[48:51], v10, s[8:11], s30 offen offset:0
    buffer_load_dwordx4 v[52:55], v10, s[8:11], s30 offen offset:64
    buffer_load_dwordx4 v[56:59], v11, s[8:11], s30 offen offset:0
    buffer_load_dwordx4 v[60:63], v11, s[8:11], s30 offen offset:64
    s_waitcnt vmcnt(17)
    ds_write_b64 v21, v[80:81] offset:0
    ds_write_b64 v22, v[82:83] offset:0
    ds_write_b64 v23, v[84:85] offset:0
    ds_write_b64 v24, v[86:87] offset:0
    ds_write_b64 v25, v[88:89] offset:0
    ds_write_b64 v26, v[90:91] offset:0
    ds_write_b64 v27, v[92:93] offset:0
    ds_write_b64 v28, v[94:95] offset:0
    ds_write_b64 v29, v[96:97] offset:0
    s_waitcnt lgkmcnt(0)
    s_barrier
    s_add_u32 s29, s28, 442368
    buffer_load_dwordx2 v[80:81], v12, s[12:15], s29 offen
    buffer_load_dwordx2 v[82:83], v13, s[12:15], s29 offen
    buffer_load_dwordx2 v[84:85], v14, s[12:15], s29 offen
    buffer_load_dwordx2 v[86:87], v15, s[12:15], s29 offen
    buffer_load_dwordx2 v[88:89], v16, s[12:15], s29 offen
    buffer_load_dwordx2 v[90:91], v17, s[12:15], s29 offen
    buffer_load_dwordx2 v[92:93], v18, s[12:15], s29 offen
    buffer_load_dwordx2 v[94:95], v19, s[12:15], s29 offen
    buffer_load_dwordx2 v[96:97], v20, s[12:15], s29 offen
    s_add_u32 s30, s27, 256
    buffer_load_dwordx4 v[64:67], v10, s[8:11], s30 offen offset:0
    buffer_load_dwordx4 v[68:71], v10, s[8:11], s30 offen offset:64
    buffer_load_dwordx4 v[72:75], v11, s[8:11], s30 offen offset:0
    buffer_load_dwordx4 v[76:79], v11, s[8:11], s30 offen offset:64
    ds_read_b64_tr_b16 v[116:117], v30 offset:0
    ds_read_b64_tr_b16 v[118:119], v30 offset:1152
    ds_read_b64_tr_b16 v[120:121], v30 offset:32
    ds_read_b64_tr_b16 v[122:123], v30 offset:1184
    ds_read_b64_tr_b16 v[124:125], v30 offset:64
    ds_read_b64_tr_b16 v[126:127], v30 offset:1216
    ds_read_b64_tr_b16 v[128:129], v30 offset:96
    ds_read_b64_tr_b16 v[130:131], v30 offset:1248
    ds_read_b64_tr_b16 v[132:133], v30 offset:128
    ds_read_b64_tr_b16 v[134:135], v30 offset:1280
    ds_read_b64_tr_b16 v[136:137], v30 offset:160
    ds_read_b64_tr_b16 v[138:139], v30 offset:1312
    ds_read_b64_tr_b16 v[140:141], v30 offset:192
    ds_read_b64_tr_b16 v[142:143], v30 offset:1344
    ds_read_b64_tr_b16 v[144:145], v30 offset:224
    ds_read_b64_tr_b16 v[146:147], v30 offset:1376
    ds_read_b64_tr_b16 v[148:149], v30 offset:256
    ds_read_b64_tr_b16 v[150:151], v30 offset:1408
    s_waitcnt vmcnt(26)
    s_waitcnt lgkmcnt(0)
    v_mfma_f32_16x16x32_bf16 v[156:159], v[116:119], v[32:35], v[156:159]
    v_mfma_f32_16x16x32_bf16 v[192:195], v[116:119], v[40:43], v[192:195]
    v_mfma_f32_16x16x32_bf16 v[160:163], v[120:123], v[32:35], v[160:163]
    v_mfma_f32_16x16x32_bf16 v[196:199], v[120:123], v[40:43], v[196:199]
    v_mfma_f32_16x16x32_bf16 v[164:167], v[124:127], v[32:35], v[164:167]
    v_mfma_f32_16x16x32_bf16 v[200:203], v[124:127], v[40:43], v[200:203]
    v_mfma_f32_16x16x32_bf16 v[168:171], v[128:131], v[32:35], v[168:171]
    v_mfma_f32_16x16x32_bf16 v[204:207], v[128:131], v[40:43], v[204:207]
    v_mfma_f32_16x16x32_bf16 v[172:175], v[132:135], v[32:35], v[172:175]
    v_mfma_f32_16x16x32_bf16 v[208:211], v[132:135], v[40:43], v[208:211]
    v_mfma_f32_16x16x32_bf16 v[176:179], v[136:139], v[32:35], v[176:179]
    v_mfma_f32_16x16x32_bf16 v[212:215], v[136:139], v[40:43], v[212:215]
    v_mfma_f32_16x16x32_bf16 v[180:183], v[140:143], v[32:35], v[180:183]
    v_mfma_f32_16x16x32_bf16 v[216:219], v[140:143], v[40:43], v[216:219]
    v_mfma_f32_16x16x32_bf16 v[184:187], v[144:147], v[32:35], v[184:187]
    v_mfma_f32_16x16x32_bf16 v[220:223], v[144:147], v[40:43], v[220:223]
    v_mfma_f32_16x16x32_bf16 v[188:191], v[148:151], v[32:35], v[188:191]
    v_mfma_f32_16x16x32_bf16 v[224:227], v[148:151], v[40:43], v[224:227]
    ds_read_b64_tr_b16 v[116:117], v30 offset:9728
    ds_read_b64_tr_b16 v[118:119], v30 offset:10880
    ds_read_b64_tr_b16 v[120:121], v30 offset:9760
    ds_read_b64_tr_b16 v[122:123], v30 offset:10912
    ds_read_b64_tr_b16 v[124:125], v30 offset:9792
    ds_read_b64_tr_b16 v[126:127], v30 offset:10944
    ds_read_b64_tr_b16 v[128:129], v30 offset:9824
    ds_read_b64_tr_b16 v[130:131], v30 offset:10976
    ds_read_b64_tr_b16 v[132:133], v30 offset:9856
    ds_read_b64_tr_b16 v[134:135], v30 offset:11008
    ds_read_b64_tr_b16 v[136:137], v30 offset:9888
    ds_read_b64_tr_b16 v[138:139], v30 offset:11040
    ds_read_b64_tr_b16 v[140:141], v30 offset:9920
    ds_read_b64_tr_b16 v[142:143], v30 offset:11072
    ds_read_b64_tr_b16 v[144:145], v30 offset:9952
    ds_read_b64_tr_b16 v[146:147], v30 offset:11104
    ds_read_b64_tr_b16 v[148:149], v30 offset:9984
    ds_read_b64_tr_b16 v[150:151], v30 offset:11136
    s_waitcnt lgkmcnt(0)
    v_mfma_f32_16x16x32_bf16 v[156:159], v[116:119], v[36:39], v[156:159]
    v_mfma_f32_16x16x32_bf16 v[192:195], v[116:119], v[44:47], v[192:195]
    v_mfma_f32_16x16x32_bf16 v[160:163], v[120:123], v[36:39], v[160:163]
    v_mfma_f32_16x16x32_bf16 v[196:199], v[120:123], v[44:47], v[196:199]
    v_mfma_f32_16x16x32_bf16 v[164:167], v[124:127], v[36:39], v[164:167]
    v_mfma_f32_16x16x32_bf16 v[200:203], v[124:127], v[44:47], v[200:203]
    v_mfma_f32_16x16x32_bf16 v[168:171], v[128:131], v[36:39], v[168:171]
    v_mfma_f32_16x16x32_bf16 v[204:207], v[128:131], v[44:47], v[204:207]
    v_mfma_f32_16x16x32_bf16 v[172:175], v[132:135], v[36:39], v[172:175]
    v_mfma_f32_16x16x32_bf16 v[208:211], v[132:135], v[44:47], v[208:211]
    v_mfma_f32_16x16x32_bf16 v[176:179], v[136:139], v[36:39], v[176:179]
    v_mfma_f32_16x16x32_bf16 v[212:215], v[136:139], v[44:47], v[212:215]
    v_mfma_f32_16x16x32_bf16 v[180:183], v[140:143], v[36:39], v[180:183]
    v_mfma_f32_16x16x32_bf16 v[216:219], v[140:143], v[44:47], v[216:219]
    v_mfma_f32_16x16x32_bf16 v[184:187], v[144:147], v[36:39], v[184:187]
    v_mfma_f32_16x16x32_bf16 v[220:223], v[144:147], v[44:47], v[220:223]
    v_mfma_f32_16x16x32_bf16 v[188:191], v[148:151], v[36:39], v[188:191]
    v_mfma_f32_16x16x32_bf16 v[224:227], v[148:151], v[44:47], v[224:227]
    s_waitcnt vmcnt(17)
    ds_write_b64 v21, v[98:99] offset:19456
    ds_write_b64 v22, v[100:101] offset:19456
    ds_write_b64 v23, v[102:103] offset:19456
    ds_write_b64 v24, v[104:105] offset:19456
    ds_write_b64 v25, v[106:107] offset:19456
    ds_write_b64 v26, v[108:109] offset:19456
    ds_write_b64 v27, v[110:111] offset:19456
    ds_write_b64 v28, v[112:113] offset:19456
    ds_write_b64 v29, v[114:115] offset:19456
    s_waitcnt lgkmcnt(0)
    s_barrier
    s_add_u32 s29, s28, 663552
    buffer_load_dwordx2 v[98:99], v12, s[12:15], s29 offen
    buffer_load_dwordx2 v[100:101], v13, s[12:15], s29 offen
    buffer_load_dwordx2 v[102:103], v14, s[12:15], s29 offen
    buffer_load_dwordx2 v[104:105], v15, s[12:15], s29 offen
    buffer_load_dwordx2 v[106:107], v16, s[12:15], s29 offen
    buffer_load_dwordx2 v[108:109], v17, s[12:15], s29 offen
    buffer_load_dwordx2 v[110:111], v18, s[12:15], s29 offen
    buffer_load_dwordx2 v[112:113], v19, s[12:15], s29 offen
    buffer_load_dwordx2 v[114:115], v20, s[12:15], s29 offen
    s_add_u32 s30, s27, 384
    buffer_load_dwordx4 v[32:35], v10, s[8:11], s30 offen offset:0
    buffer_load_dwordx4 v[36:39], v10, s[8:11], s30 offen offset:64
    buffer_load_dwordx4 v[40:43], v11, s[8:11], s30 offen offset:0
    buffer_load_dwordx4 v[44:47], v11, s[8:11], s30 offen offset:64
    ds_read_b64_tr_b16 v[116:117], v30 offset:19456
    ds_read_b64_tr_b16 v[118:119], v30 offset:20608
    ds_read_b64_tr_b16 v[120:121], v30 offset:19488
    ds_read_b64_tr_b16 v[122:123], v30 offset:20640
    ds_read_b64_tr_b16 v[124:125], v30 offset:19520
    ds_read_b64_tr_b16 v[126:127], v30 offset:20672
    ds_read_b64_tr_b16 v[128:129], v30 offset:19552
    ds_read_b64_tr_b16 v[130:131], v30 offset:20704
    ds_read_b64_tr_b16 v[132:133], v30 offset:19584
    ds_read_b64_tr_b16 v[134:135], v30 offset:20736
    ds_read_b64_tr_b16 v[136:137], v30 offset:19616
    ds_read_b64_tr_b16 v[138:139], v30 offset:20768
    ds_read_b64_tr_b16 v[140:141], v30 offset:19648
    ds_read_b64_tr_b16 v[142:143], v30 offset:20800
    ds_read_b64_tr_b16 v[144:145], v30 offset:19680
    ds_read_b64_tr_b16 v[146:147], v30 offset:20832
    ds_read_b64_tr_b16 v[148:149], v30 offset:19712
    ds_read_b64_tr_b16 v[150:151], v30 offset:20864
    s_waitcnt vmcnt(26)
    s_waitcnt lgkmcnt(0)
    v_mfma_f32_16x16x32_bf16 v[156:159], v[116:119], v[48:51], v[156:159]
    v_mfma_f32_16x16x32_bf16 v[192:195], v[116:119], v[56:59], v[192:195]
    v_mfma_f32_16x16x32_bf16 v[160:163], v[120:123], v[48:51], v[160:163]
    v_mfma_f32_16x16x32_bf16 v[196:199], v[120:123], v[56:59], v[196:199]
    v_mfma_f32_16x16x32_bf16 v[164:167], v[124:127], v[48:51], v[164:167]
    v_mfma_f32_16x16x32_bf16 v[200:203], v[124:127], v[56:59], v[200:203]
    v_mfma_f32_16x16x32_bf16 v[168:171], v[128:131], v[48:51], v[168:171]
    v_mfma_f32_16x16x32_bf16 v[204:207], v[128:131], v[56:59], v[204:207]
    v_mfma_f32_16x16x32_bf16 v[172:175], v[132:135], v[48:51], v[172:175]
    v_mfma_f32_16x16x32_bf16 v[208:211], v[132:135], v[56:59], v[208:211]
    v_mfma_f32_16x16x32_bf16 v[176:179], v[136:139], v[48:51], v[176:179]
    v_mfma_f32_16x16x32_bf16 v[212:215], v[136:139], v[56:59], v[212:215]
    v_mfma_f32_16x16x32_bf16 v[180:183], v[140:143], v[48:51], v[180:183]
    v_mfma_f32_16x16x32_bf16 v[216:219], v[140:143], v[56:59], v[216:219]
    v_mfma_f32_16x16x32_bf16 v[184:187], v[144:147], v[48:51], v[184:187]
    v_mfma_f32_16x16x32_bf16 v[220:223], v[144:147], v[56:59], v[220:223]
    v_mfma_f32_16x16x32_bf16 v[188:191], v[148:151], v[48:51], v[188:191]
    v_mfma_f32_16x16x32_bf16 v[224:227], v[148:151], v[56:59], v[224:227]
    ds_read_b64_tr_b16 v[116:117], v30 offset:29184
    ds_read_b64_tr_b16 v[118:119], v30 offset:30336
    ds_read_b64_tr_b16 v[120:121], v30 offset:29216
    ds_read_b64_tr_b16 v[122:123], v30 offset:30368
    ds_read_b64_tr_b16 v[124:125], v30 offset:29248
    ds_read_b64_tr_b16 v[126:127], v30 offset:30400
    ds_read_b64_tr_b16 v[128:129], v30 offset:29280
    ds_read_b64_tr_b16 v[130:131], v30 offset:30432
    ds_read_b64_tr_b16 v[132:133], v30 offset:29312
    ds_read_b64_tr_b16 v[134:135], v30 offset:30464
    ds_read_b64_tr_b16 v[136:137], v30 offset:29344
    ds_read_b64_tr_b16 v[138:139], v30 offset:30496
    ds_read_b64_tr_b16 v[140:141], v30 offset:29376
    ds_read_b64_tr_b16 v[142:143], v30 offset:30528
    ds_read_b64_tr_b16 v[144:145], v30 offset:29408
    ds_read_b64_tr_b16 v[146:147], v30 offset:30560
    ds_read_b64_tr_b16 v[148:149], v30 offset:29440
    ds_read_b64_tr_b16 v[150:151], v30 offset:30592
    s_waitcnt lgkmcnt(0)
    v_mfma_f32_16x16x32_bf16 v[156:159], v[116:119], v[52:55], v[156:159]
    v_mfma_f32_16x16x32_bf16 v[192:195], v[116:119], v[60:63], v[192:195]
    v_mfma_f32_16x16x32_bf16 v[160:163], v[120:123], v[52:55], v[160:163]
    v_mfma_f32_16x16x32_bf16 v[196:199], v[120:123], v[60:63], v[196:199]
    v_mfma_f32_16x16x32_bf16 v[164:167], v[124:127], v[52:55], v[164:167]
    v_mfma_f32_16x16x32_bf16 v[200:203], v[124:127], v[60:63], v[200:203]
    v_mfma_f32_16x16x32_bf16 v[168:171], v[128:131], v[52:55], v[168:171]
    v_mfma_f32_16x16x32_bf16 v[204:207], v[128:131], v[60:63], v[204:207]
    v_mfma_f32_16x16x32_bf16 v[172:175], v[132:135], v[52:55], v[172:175]
    v_mfma_f32_16x16x32_bf16 v[208:211], v[132:135], v[60:63], v[208:211]
    v_mfma_f32_16x16x32_bf16 v[176:179], v[136:139], v[52:55], v[176:179]
    v_mfma_f32_16x16x32_bf16 v[212:215], v[136:139], v[60:63], v[212:215]
    v_mfma_f32_16x16x32_bf16 v[180:183], v[140:143], v[52:55], v[180:183]
    v_mfma_f32_16x16x32_bf16 v[216:219], v[140:143], v[60:63], v[216:219]
    v_mfma_f32_16x16x32_bf16 v[184:187], v[144:147], v[52:55], v[184:187]
    v_mfma_f32_16x16x32_bf16 v[220:223], v[144:147], v[60:63], v[220:223]
    v_mfma_f32_16x16x32_bf16 v[188:191], v[148:151], v[52:55], v[188:191]
    v_mfma_f32_16x16x32_bf16 v[224:227], v[148:151], v[60:63], v[224:227]
    s_waitcnt vmcnt(17)
    ds_write_b64 v21, v[80:81] offset:0
    ds_write_b64 v22, v[82:83] offset:0
    ds_write_b64 v23, v[84:85] offset:0
    ds_write_b64 v24, v[86:87] offset:0
    ds_write_b64 v25, v[88:89] offset:0
    ds_write_b64 v26, v[90:91] offset:0
    ds_write_b64 v27, v[92:93] offset:0
    ds_write_b64 v28, v[94:95] offset:0
    ds_write_b64 v29, v[96:97] offset:0
    s_waitcnt lgkmcnt(0)
    s_barrier
    s_add_u32 s29, s28, 884736
    buffer_load_dwordx2 v[80:81], v12, s[12:15], s29 offen
    buffer_load_dwordx2 v[82:83], v13, s[12:15], s29 offen
    buffer_load_dwordx2 v[84:85], v14, s[12:15], s29 offen
    buffer_load_dwordx2 v[86:87], v15, s[12:15], s29 offen
    buffer_load_dwordx2 v[88:89], v16, s[12:15], s29 offen
    buffer_load_dwordx2 v[90:91], v17, s[12:15], s29 offen
    buffer_load_dwordx2 v[92:93], v18, s[12:15], s29 offen
    buffer_load_dwordx2 v[94:95], v19, s[12:15], s29 offen
    buffer_load_dwordx2 v[96:97], v20, s[12:15], s29 offen
    s_add_u32 s30, s27, 512
    buffer_load_dwordx4 v[48:51], v10, s[8:11], s30 offen offset:0
    buffer_load_dwordx4 v[52:55], v10, s[8:11], s30 offen offset:64
    buffer_load_dwordx4 v[56:59], v11, s[8:11], s30 offen offset:0
    buffer_load_dwordx4 v[60:63], v11, s[8:11], s30 offen offset:64
    ds_read_b64_tr_b16 v[116:117], v30 offset:0
    ds_read_b64_tr_b16 v[118:119], v30 offset:1152
    ds_read_b64_tr_b16 v[120:121], v30 offset:32
    ds_read_b64_tr_b16 v[122:123], v30 offset:1184
    ds_read_b64_tr_b16 v[124:125], v30 offset:64
    ds_read_b64_tr_b16 v[126:127], v30 offset:1216
    ds_read_b64_tr_b16 v[128:129], v30 offset:96
    ds_read_b64_tr_b16 v[130:131], v30 offset:1248
    ds_read_b64_tr_b16 v[132:133], v30 offset:128
    ds_read_b64_tr_b16 v[134:135], v30 offset:1280
    ds_read_b64_tr_b16 v[136:137], v30 offset:160
    ds_read_b64_tr_b16 v[138:139], v30 offset:1312
    ds_read_b64_tr_b16 v[140:141], v30 offset:192
    ds_read_b64_tr_b16 v[142:143], v30 offset:1344
    ds_read_b64_tr_b16 v[144:145], v30 offset:224
    ds_read_b64_tr_b16 v[146:147], v30 offset:1376
    ds_read_b64_tr_b16 v[148:149], v30 offset:256
    ds_read_b64_tr_b16 v[150:151], v30 offset:1408
    s_waitcnt vmcnt(26)
    s_waitcnt lgkmcnt(0)
    v_mfma_f32_16x16x32_bf16 v[156:159], v[116:119], v[64:67], v[156:159]
    v_mfma_f32_16x16x32_bf16 v[192:195], v[116:119], v[72:75], v[192:195]
    v_mfma_f32_16x16x32_bf16 v[160:163], v[120:123], v[64:67], v[160:163]
    v_mfma_f32_16x16x32_bf16 v[196:199], v[120:123], v[72:75], v[196:199]
    v_mfma_f32_16x16x32_bf16 v[164:167], v[124:127], v[64:67], v[164:167]
    v_mfma_f32_16x16x32_bf16 v[200:203], v[124:127], v[72:75], v[200:203]
    v_mfma_f32_16x16x32_bf16 v[168:171], v[128:131], v[64:67], v[168:171]
    v_mfma_f32_16x16x32_bf16 v[204:207], v[128:131], v[72:75], v[204:207]
    v_mfma_f32_16x16x32_bf16 v[172:175], v[132:135], v[64:67], v[172:175]
    v_mfma_f32_16x16x32_bf16 v[208:211], v[132:135], v[72:75], v[208:211]
    v_mfma_f32_16x16x32_bf16 v[176:179], v[136:139], v[64:67], v[176:179]
    v_mfma_f32_16x16x32_bf16 v[212:215], v[136:139], v[72:75], v[212:215]
    v_mfma_f32_16x16x32_bf16 v[180:183], v[140:143], v[64:67], v[180:183]
    v_mfma_f32_16x16x32_bf16 v[216:219], v[140:143], v[72:75], v[216:219]
    v_mfma_f32_16x16x32_bf16 v[184:187], v[144:147], v[64:67], v[184:187]
    v_mfma_f32_16x16x32_bf16 v[220:223], v[144:147], v[72:75], v[220:223]
    v_mfma_f32_16x16x32_bf16 v[188:191], v[148:151], v[64:67], v[188:191]
    v_mfma_f32_16x16x32_bf16 v[224:227], v[148:151], v[72:75], v[224:227]
    ds_read_b64_tr_b16 v[116:117], v30 offset:9728
    ds_read_b64_tr_b16 v[118:119], v30 offset:10880
    ds_read_b64_tr_b16 v[120:121], v30 offset:9760
    ds_read_b64_tr_b16 v[122:123], v30 offset:10912
    ds_read_b64_tr_b16 v[124:125], v30 offset:9792
    ds_read_b64_tr_b16 v[126:127], v30 offset:10944
    ds_read_b64_tr_b16 v[128:129], v30 offset:9824
    ds_read_b64_tr_b16 v[130:131], v30 offset:10976
    ds_read_b64_tr_b16 v[132:133], v30 offset:9856
    ds_read_b64_tr_b16 v[134:135], v30 offset:11008
    ds_read_b64_tr_b16 v[136:137], v30 offset:9888
    ds_read_b64_tr_b16 v[138:139], v30 offset:11040
    ds_read_b64_tr_b16 v[140:141], v30 offset:9920
    ds_read_b64_tr_b16 v[142:143], v30 offset:11072
    ds_read_b64_tr_b16 v[144:145], v30 offset:9952
    ds_read_b64_tr_b16 v[146:147], v30 offset:11104
    ds_read_b64_tr_b16 v[148:149], v30 offset:9984
    ds_read_b64_tr_b16 v[150:151], v30 offset:11136
    s_waitcnt lgkmcnt(0)
    v_mfma_f32_16x16x32_bf16 v[156:159], v[116:119], v[68:71], v[156:159]
    v_mfma_f32_16x16x32_bf16 v[192:195], v[116:119], v[76:79], v[192:195]
    v_mfma_f32_16x16x32_bf16 v[160:163], v[120:123], v[68:71], v[160:163]
    v_mfma_f32_16x16x32_bf16 v[196:199], v[120:123], v[76:79], v[196:199]
    v_mfma_f32_16x16x32_bf16 v[164:167], v[124:127], v[68:71], v[164:167]
    v_mfma_f32_16x16x32_bf16 v[200:203], v[124:127], v[76:79], v[200:203]
    v_mfma_f32_16x16x32_bf16 v[168:171], v[128:131], v[68:71], v[168:171]
    v_mfma_f32_16x16x32_bf16 v[204:207], v[128:131], v[76:79], v[204:207]
    v_mfma_f32_16x16x32_bf16 v[172:175], v[132:135], v[68:71], v[172:175]
    v_mfma_f32_16x16x32_bf16 v[208:211], v[132:135], v[76:79], v[208:211]
    v_mfma_f32_16x16x32_bf16 v[176:179], v[136:139], v[68:71], v[176:179]
    v_mfma_f32_16x16x32_bf16 v[212:215], v[136:139], v[76:79], v[212:215]
    v_mfma_f32_16x16x32_bf16 v[180:183], v[140:143], v[68:71], v[180:183]
    v_mfma_f32_16x16x32_bf16 v[216:219], v[140:143], v[76:79], v[216:219]
    v_mfma_f32_16x16x32_bf16 v[184:187], v[144:147], v[68:71], v[184:187]
    v_mfma_f32_16x16x32_bf16 v[220:223], v[144:147], v[76:79], v[220:223]
    v_mfma_f32_16x16x32_bf16 v[188:191], v[148:151], v[68:71], v[188:191]
    v_mfma_f32_16x16x32_bf16 v[224:227], v[148:151], v[76:79], v[224:227]
    s_waitcnt vmcnt(17)
    ds_write_b64 v21, v[98:99] offset:19456
    ds_write_b64 v22, v[100:101] offset:19456
    ds_write_b64 v23, v[102:103] offset:19456
    ds_write_b64 v24, v[104:105] offset:19456
    ds_write_b64 v25, v[106:107] offset:19456
    ds_write_b64 v26, v[108:109] offset:19456
    ds_write_b64 v27, v[110:111] offset:19456
    ds_write_b64 v28, v[112:113] offset:19456
    ds_write_b64 v29, v[114:115] offset:19456
    s_waitcnt lgkmcnt(0)
    s_barrier
    s_add_u32 s29, s28, 1105920
    buffer_load_dwordx2 v[98:99], v12, s[12:15], s29 offen
    buffer_load_dwordx2 v[100:101], v13, s[12:15], s29 offen
    buffer_load_dwordx2 v[102:103], v14, s[12:15], s29 offen
    buffer_load_dwordx2 v[104:105], v15, s[12:15], s29 offen
    buffer_load_dwordx2 v[106:107], v16, s[12:15], s29 offen
    buffer_load_dwordx2 v[108:109], v17, s[12:15], s29 offen
    buffer_load_dwordx2 v[110:111], v18, s[12:15], s29 offen
    buffer_load_dwordx2 v[112:113], v19, s[12:15], s29 offen
    buffer_load_dwordx2 v[114:115], v20, s[12:15], s29 offen
    s_add_u32 s30, s27, 640
    buffer_load_dwordx4 v[64:67], v10, s[8:11], s30 offen offset:0
    buffer_load_dwordx4 v[68:71], v10, s[8:11], s30 offen offset:64
    buffer_load_dwordx4 v[72:75], v11, s[8:11], s30 offen offset:0
    buffer_load_dwordx4 v[76:79], v11, s[8:11], s30 offen offset:64
    ds_read_b64_tr_b16 v[116:117], v30 offset:19456
    ds_read_b64_tr_b16 v[118:119], v30 offset:20608
    ds_read_b64_tr_b16 v[120:121], v30 offset:19488
    ds_read_b64_tr_b16 v[122:123], v30 offset:20640
    ds_read_b64_tr_b16 v[124:125], v30 offset:19520
    ds_read_b64_tr_b16 v[126:127], v30 offset:20672
    ds_read_b64_tr_b16 v[128:129], v30 offset:19552
    ds_read_b64_tr_b16 v[130:131], v30 offset:20704
    ds_read_b64_tr_b16 v[132:133], v30 offset:19584
    ds_read_b64_tr_b16 v[134:135], v30 offset:20736
    ds_read_b64_tr_b16 v[136:137], v30 offset:19616
    ds_read_b64_tr_b16 v[138:139], v30 offset:20768
    ds_read_b64_tr_b16 v[140:141], v30 offset:19648
    ds_read_b64_tr_b16 v[142:143], v30 offset:20800
    ds_read_b64_tr_b16 v[144:145], v30 offset:19680
    ds_read_b64_tr_b16 v[146:147], v30 offset:20832
    ds_read_b64_tr_b16 v[148:149], v30 offset:19712
    ds_read_b64_tr_b16 v[150:151], v30 offset:20864
    s_waitcnt vmcnt(26)
    s_waitcnt lgkmcnt(0)
    v_mfma_f32_16x16x32_bf16 v[156:159], v[116:119], v[32:35], v[156:159]
    v_mfma_f32_16x16x32_bf16 v[192:195], v[116:119], v[40:43], v[192:195]
    v_mfma_f32_16x16x32_bf16 v[160:163], v[120:123], v[32:35], v[160:163]
    v_mfma_f32_16x16x32_bf16 v[196:199], v[120:123], v[40:43], v[196:199]
    v_mfma_f32_16x16x32_bf16 v[164:167], v[124:127], v[32:35], v[164:167]
    v_mfma_f32_16x16x32_bf16 v[200:203], v[124:127], v[40:43], v[200:203]
    v_mfma_f32_16x16x32_bf16 v[168:171], v[128:131], v[32:35], v[168:171]
    v_mfma_f32_16x16x32_bf16 v[204:207], v[128:131], v[40:43], v[204:207]
    v_mfma_f32_16x16x32_bf16 v[172:175], v[132:135], v[32:35], v[172:175]
    v_mfma_f32_16x16x32_bf16 v[208:211], v[132:135], v[40:43], v[208:211]
    v_mfma_f32_16x16x32_bf16 v[176:179], v[136:139], v[32:35], v[176:179]
    v_mfma_f32_16x16x32_bf16 v[212:215], v[136:139], v[40:43], v[212:215]
    v_mfma_f32_16x16x32_bf16 v[180:183], v[140:143], v[32:35], v[180:183]
    v_mfma_f32_16x16x32_bf16 v[216:219], v[140:143], v[40:43], v[216:219]
    v_mfma_f32_16x16x32_bf16 v[184:187], v[144:147], v[32:35], v[184:187]
    v_mfma_f32_16x16x32_bf16 v[220:223], v[144:147], v[40:43], v[220:223]
    v_mfma_f32_16x16x32_bf16 v[188:191], v[148:151], v[32:35], v[188:191]
    v_mfma_f32_16x16x32_bf16 v[224:227], v[148:151], v[40:43], v[224:227]
    ds_read_b64_tr_b16 v[116:117], v30 offset:29184
    ds_read_b64_tr_b16 v[118:119], v30 offset:30336
    ds_read_b64_tr_b16 v[120:121], v30 offset:29216
    ds_read_b64_tr_b16 v[122:123], v30 offset:30368
    ds_read_b64_tr_b16 v[124:125], v30 offset:29248
    ds_read_b64_tr_b16 v[126:127], v30 offset:30400
    ds_read_b64_tr_b16 v[128:129], v30 offset:29280
    ds_read_b64_tr_b16 v[130:131], v30 offset:30432
    ds_read_b64_tr_b16 v[132:133], v30 offset:29312
    ds_read_b64_tr_b16 v[134:135], v30 offset:30464
    ds_read_b64_tr_b16 v[136:137], v30 offset:29344
    ds_read_b64_tr_b16 v[138:139], v30 offset:30496
    ds_read_b64_tr_b16 v[140:141], v30 offset:29376
    ds_read_b64_tr_b16 v[142:143], v30 offset:30528
    ds_read_b64_tr_b16 v[144:145], v30 offset:29408
    ds_read_b64_tr_b16 v[146:147], v30 offset:30560
    ds_read_b64_tr_b16 v[148:149], v30 offset:29440
    ds_read_b64_tr_b16 v[150:151], v30 offset:30592
    s_waitcnt lgkmcnt(0)
    v_mfma_f32_16x16x32_bf16 v[156:159], v[116:119], v[36:39], v[156:159]
    v_mfma_f32_16x16x32_bf16 v[192:195], v[116:119], v[44:47], v[192:195]
    v_mfma_f32_16x16x32_bf16 v[160:163], v[120:123], v[36:39], v[160:163]
    v_mfma_f32_16x16x32_bf16 v[196:199], v[120:123], v[44:47], v[196:199]
    v_mfma_f32_16x16x32_bf16 v[164:167], v[124:127], v[36:39], v[164:167]
    v_mfma_f32_16x16x32_bf16 v[200:203], v[124:127], v[44:47], v[200:203]
    v_mfma_f32_16x16x32_bf16 v[168:171], v[128:131], v[36:39], v[168:171]
    v_mfma_f32_16x16x32_bf16 v[204:207], v[128:131], v[44:47], v[204:207]
    v_mfma_f32_16x16x32_bf16 v[172:175], v[132:135], v[36:39], v[172:175]
    v_mfma_f32_16x16x32_bf16 v[208:211], v[132:135], v[44:47], v[208:211]
    v_mfma_f32_16x16x32_bf16 v[176:179], v[136:139], v[36:39], v[176:179]
    v_mfma_f32_16x16x32_bf16 v[212:215], v[136:139], v[44:47], v[212:215]
    v_mfma_f32_16x16x32_bf16 v[180:183], v[140:143], v[36:39], v[180:183]
    v_mfma_f32_16x16x32_bf16 v[216:219], v[140:143], v[44:47], v[216:219]
    v_mfma_f32_16x16x32_bf16 v[184:187], v[144:147], v[36:39], v[184:187]
    v_mfma_f32_16x16x32_bf16 v[220:223], v[144:147], v[44:47], v[220:223]
    v_mfma_f32_16x16x32_bf16 v[188:191], v[148:151], v[36:39], v[188:191]
    v_mfma_f32_16x16x32_bf16 v[224:227], v[148:151], v[44:47], v[224:227]
    s_waitcnt vmcnt(17)
    ds_write_b64 v21, v[80:81] offset:0
    ds_write_b64 v22, v[82:83] offset:0
    ds_write_b64 v23, v[84:85] offset:0
    ds_write_b64 v24, v[86:87] offset:0
    ds_write_b64 v25, v[88:89] offset:0
    ds_write_b64 v26, v[90:91] offset:0
    ds_write_b64 v27, v[92:93] offset:0
    ds_write_b64 v28, v[94:95] offset:0
    ds_write_b64 v29, v[96:97] offset:0
    s_waitcnt lgkmcnt(0)
    s_barrier
    s_add_u32 s29, s28, 1327104
    buffer_load_dwordx2 v[80:81], v12, s[12:15], s29 offen
    buffer_load_dwordx2 v[82:83], v13, s[12:15], s29 offen
    buffer_load_dwordx2 v[84:85], v14, s[12:15], s29 offen
    buffer_load_dwordx2 v[86:87], v15, s[12:15], s29 offen
    buffer_load_dwordx2 v[88:89], v16, s[12:15], s29 offen
    buffer_load_dwordx2 v[90:91], v17, s[12:15], s29 offen
    buffer_load_dwordx2 v[92:93], v18, s[12:15], s29 offen
    buffer_load_dwordx2 v[94:95], v19, s[12:15], s29 offen
    buffer_load_dwordx2 v[96:97], v20, s[12:15], s29 offen
    s_add_u32 s30, s27, 768
    buffer_load_dwordx4 v[32:35], v10, s[8:11], s30 offen offset:0
    buffer_load_dwordx4 v[36:39], v10, s[8:11], s30 offen offset:64
    buffer_load_dwordx4 v[40:43], v11, s[8:11], s30 offen offset:0
    buffer_load_dwordx4 v[44:47], v11, s[8:11], s30 offen offset:64
    ds_read_b64_tr_b16 v[116:117], v30 offset:0
    ds_read_b64_tr_b16 v[118:119], v30 offset:1152
    ds_read_b64_tr_b16 v[120:121], v30 offset:32
    ds_read_b64_tr_b16 v[122:123], v30 offset:1184
    ds_read_b64_tr_b16 v[124:125], v30 offset:64
    ds_read_b64_tr_b16 v[126:127], v30 offset:1216
    ds_read_b64_tr_b16 v[128:129], v30 offset:96
    ds_read_b64_tr_b16 v[130:131], v30 offset:1248
    ds_read_b64_tr_b16 v[132:133], v30 offset:128
    ds_read_b64_tr_b16 v[134:135], v30 offset:1280
    ds_read_b64_tr_b16 v[136:137], v30 offset:160
    ds_read_b64_tr_b16 v[138:139], v30 offset:1312
    ds_read_b64_tr_b16 v[140:141], v30 offset:192
    ds_read_b64_tr_b16 v[142:143], v30 offset:1344
    ds_read_b64_tr_b16 v[144:145], v30 offset:224
    ds_read_b64_tr_b16 v[146:147], v30 offset:1376
    ds_read_b64_tr_b16 v[148:149], v30 offset:256
    ds_read_b64_tr_b16 v[150:151], v30 offset:1408
    s_waitcnt vmcnt(26)
    s_waitcnt lgkmcnt(0)
    v_mfma_f32_16x16x32_bf16 v[156:159], v[116:119], v[48:51], v[156:159]
    v_mfma_f32_16x16x32_bf16 v[192:195], v[116:119], v[56:59], v[192:195]
    v_mfma_f32_16x16x32_bf16 v[160:163], v[120:123], v[48:51], v[160:163]
    v_mfma_f32_16x16x32_bf16 v[196:199], v[120:123], v[56:59], v[196:199]
    v_mfma_f32_16x16x32_bf16 v[164:167], v[124:127], v[48:51], v[164:167]
    v_mfma_f32_16x16x32_bf16 v[200:203], v[124:127], v[56:59], v[200:203]
    v_mfma_f32_16x16x32_bf16 v[168:171], v[128:131], v[48:51], v[168:171]
    v_mfma_f32_16x16x32_bf16 v[204:207], v[128:131], v[56:59], v[204:207]
    v_mfma_f32_16x16x32_bf16 v[172:175], v[132:135], v[48:51], v[172:175]
    v_mfma_f32_16x16x32_bf16 v[208:211], v[132:135], v[56:59], v[208:211]
    v_mfma_f32_16x16x32_bf16 v[176:179], v[136:139], v[48:51], v[176:179]
    v_mfma_f32_16x16x32_bf16 v[212:215], v[136:139], v[56:59], v[212:215]
    v_mfma_f32_16x16x32_bf16 v[180:183], v[140:143], v[48:51], v[180:183]
    v_mfma_f32_16x16x32_bf16 v[216:219], v[140:143], v[56:59], v[216:219]
    v_mfma_f32_16x16x32_bf16 v[184:187], v[144:147], v[48:51], v[184:187]
    v_mfma_f32_16x16x32_bf16 v[220:223], v[144:147], v[56:59], v[220:223]
    v_mfma_f32_16x16x32_bf16 v[188:191], v[148:151], v[48:51], v[188:191]
    v_mfma_f32_16x16x32_bf16 v[224:227], v[148:151], v[56:59], v[224:227]
    ds_read_b64_tr_b16 v[116:117], v30 offset:9728
    ds_read_b64_tr_b16 v[118:119], v30 offset:10880
    ds_read_b64_tr_b16 v[120:121], v30 offset:9760
    ds_read_b64_tr_b16 v[122:123], v30 offset:10912
    ds_read_b64_tr_b16 v[124:125], v30 offset:9792
    ds_read_b64_tr_b16 v[126:127], v30 offset:10944
    ds_read_b64_tr_b16 v[128:129], v30 offset:9824
    ds_read_b64_tr_b16 v[130:131], v30 offset:10976
    ds_read_b64_tr_b16 v[132:133], v30 offset:9856
    ds_read_b64_tr_b16 v[134:135], v30 offset:11008
    ds_read_b64_tr_b16 v[136:137], v30 offset:9888
    ds_read_b64_tr_b16 v[138:139], v30 offset:11040
    ds_read_b64_tr_b16 v[140:141], v30 offset:9920
    ds_read_b64_tr_b16 v[142:143], v30 offset:11072
    ds_read_b64_tr_b16 v[144:145], v30 offset:9952
    ds_read_b64_tr_b16 v[146:147], v30 offset:11104
    ds_read_b64_tr_b16 v[148:149], v30 offset:9984
    ds_read_b64_tr_b16 v[150:151], v30 offset:11136
    s_waitcnt lgkmcnt(0)
    v_mfma_f32_16x16x32_bf16 v[156:159], v[116:119], v[52:55], v[156:159]
    v_mfma_f32_16x16x32_bf16 v[192:195], v[116:119], v[60:63], v[192:195]
    v_mfma_f32_16x16x32_bf16 v[160:163], v[120:123], v[52:55], v[160:163]
    v_mfma_f32_16x16x32_bf16 v[196:199], v[120:123], v[60:63], v[196:199]
    v_mfma_f32_16x16x32_bf16 v[164:167], v[124:127], v[52:55], v[164:167]
    v_mfma_f32_16x16x32_bf16 v[200:203], v[124:127], v[60:63], v[200:203]
    v_mfma_f32_16x16x32_bf16 v[168:171], v[128:131], v[52:55], v[168:171]
    v_mfma_f32_16x16x32_bf16 v[204:207], v[128:131], v[60:63], v[204:207]
    v_mfma_f32_16x16x32_bf16 v[172:175], v[132:135], v[52:55], v[172:175]
    v_mfma_f32_16x16x32_bf16 v[208:211], v[132:135], v[60:63], v[208:211]
    v_mfma_f32_16x16x32_bf16 v[176:179], v[136:139], v[52:55], v[176:179]
    v_mfma_f32_16x16x32_bf16 v[212:215], v[136:139], v[60:63], v[212:215]
    v_mfma_f32_16x16x32_bf16 v[180:183], v[140:143], v[52:55], v[180:183]
    v_mfma_f32_16x16x32_bf16 v[216:219], v[140:143], v[60:63], v[216:219]
    v_mfma_f32_16x16x32_bf16 v[184:187], v[144:147], v[52:55], v[184:187]
    v_mfma_f32_16x16x32_bf16 v[220:223], v[144:147], v[60:63], v[220:223]
    v_mfma_f32_16x16x32_bf16 v[188:191], v[148:151], v[52:55], v[188:191]
    v_mfma_f32_16x16x32_bf16 v[224:227], v[148:151], v[60:63], v[224:227]
    s_waitcnt vmcnt(17)
    ds_write_b64 v21, v[98:99] offset:19456
    ds_write_b64 v22, v[100:101] offset:19456
    ds_write_b64 v23, v[102:103] offset:19456
    ds_write_b64 v24, v[104:105] offset:19456
    ds_write_b64 v25, v[106:107] offset:19456
    ds_write_b64 v26, v[108:109] offset:19456
    ds_write_b64 v27, v[110:111] offset:19456
    ds_write_b64 v28, v[112:113] offset:19456
    ds_write_b64 v29, v[114:115] offset:19456
    s_waitcnt lgkmcnt(0)
    s_barrier
    s_add_u32 s29, s28, 1548288
    buffer_load_dwordx2 v[98:99], v12, s[12:15], s29 offen
    buffer_load_dwordx2 v[100:101], v13, s[12:15], s29 offen
    buffer_load_dwordx2 v[102:103], v14, s[12:15], s29 offen
    buffer_load_dwordx2 v[104:105], v15, s[12:15], s29 offen
    buffer_load_dwordx2 v[106:107], v16, s[12:15], s29 offen
    buffer_load_dwordx2 v[108:109], v17, s[12:15], s29 offen
    buffer_load_dwordx2 v[110:111], v18, s[12:15], s29 offen
    buffer_load_dwordx2 v[112:113], v19, s[12:15], s29 offen
    buffer_load_dwordx2 v[114:115], v20, s[12:15], s29 offen
    s_add_u32 s30, s27, 896
    buffer_load_dwordx4 v[48:51], v10, s[8:11], s30 offen offset:0
    buffer_load_dwordx4 v[52:55], v10, s[8:11], s30 offen offset:64
    buffer_load_dwordx4 v[56:59], v11, s[8:11], s30 offen offset:0
    buffer_load_dwordx4 v[60:63], v11, s[8:11], s30 offen offset:64
    ds_read_b64_tr_b16 v[116:117], v30 offset:19456
    ds_read_b64_tr_b16 v[118:119], v30 offset:20608
    ds_read_b64_tr_b16 v[120:121], v30 offset:19488
    ds_read_b64_tr_b16 v[122:123], v30 offset:20640
    ds_read_b64_tr_b16 v[124:125], v30 offset:19520
    ds_read_b64_tr_b16 v[126:127], v30 offset:20672
    ds_read_b64_tr_b16 v[128:129], v30 offset:19552
    ds_read_b64_tr_b16 v[130:131], v30 offset:20704
    ds_read_b64_tr_b16 v[132:133], v30 offset:19584
    ds_read_b64_tr_b16 v[134:135], v30 offset:20736
    ds_read_b64_tr_b16 v[136:137], v30 offset:19616
    ds_read_b64_tr_b16 v[138:139], v30 offset:20768
    ds_read_b64_tr_b16 v[140:141], v30 offset:19648
    ds_read_b64_tr_b16 v[142:143], v30 offset:20800
    ds_read_b64_tr_b16 v[144:145], v30 offset:19680
    ds_read_b64_tr_b16 v[146:147], v30 offset:20832
    ds_read_b64_tr_b16 v[148:149], v30 offset:19712
    ds_read_b64_tr_b16 v[150:151], v30 offset:20864
    s_waitcnt vmcnt(26)
    s_waitcnt lgkmcnt(0)
    v_mfma_f32_16x16x32_bf16 v[156:159], v[116:119], v[64:67], v[156:159]
    v_mfma_f32_16x16x32_bf16 v[192:195], v[116:119], v[72:75], v[192:195]
    v_mfma_f32_16x16x32_bf16 v[160:163], v[120:123], v[64:67], v[160:163]
    v_mfma_f32_16x16x32_bf16 v[196:199], v[120:123], v[72:75], v[196:199]
    v_mfma_f32_16x16x32_bf16 v[164:167], v[124:127], v[64:67], v[164:167]
    v_mfma_f32_16x16x32_bf16 v[200:203], v[124:127], v[72:75], v[200:203]
    v_mfma_f32_16x16x32_bf16 v[168:171], v[128:131], v[64:67], v[168:171]
    v_mfma_f32_16x16x32_bf16 v[204:207], v[128:131], v[72:75], v[204:207]
    v_mfma_f32_16x16x32_bf16 v[172:175], v[132:135], v[64:67], v[172:175]
    v_mfma_f32_16x16x32_bf16 v[208:211], v[132:135], v[72:75], v[208:211]
    v_mfma_f32_16x16x32_bf16 v[176:179], v[136:139], v[64:67], v[176:179]
    v_mfma_f32_16x16x32_bf16 v[212:215], v[136:139], v[72:75], v[212:215]
    v_mfma_f32_16x16x32_bf16 v[180:183], v[140:143], v[64:67], v[180:183]
    v_mfma_f32_16x16x32_bf16 v[216:219], v[140:143], v[72:75], v[216:219]
    v_mfma_f32_16x16x32_bf16 v[184:187], v[144:147], v[64:67], v[184:187]
    v_mfma_f32_16x16x32_bf16 v[220:223], v[144:147], v[72:75], v[220:223]
    v_mfma_f32_16x16x32_bf16 v[188:191], v[148:151], v[64:67], v[188:191]
    v_mfma_f32_16x16x32_bf16 v[224:227], v[148:151], v[72:75], v[224:227]
    ds_read_b64_tr_b16 v[116:117], v30 offset:29184
    ds_read_b64_tr_b16 v[118:119], v30 offset:30336
    ds_read_b64_tr_b16 v[120:121], v30 offset:29216
    ds_read_b64_tr_b16 v[122:123], v30 offset:30368
    ds_read_b64_tr_b16 v[124:125], v30 offset:29248
    ds_read_b64_tr_b16 v[126:127], v30 offset:30400
    ds_read_b64_tr_b16 v[128:129], v30 offset:29280
    ds_read_b64_tr_b16 v[130:131], v30 offset:30432
    ds_read_b64_tr_b16 v[132:133], v30 offset:29312
    ds_read_b64_tr_b16 v[134:135], v30 offset:30464
    ds_read_b64_tr_b16 v[136:137], v30 offset:29344
    ds_read_b64_tr_b16 v[138:139], v30 offset:30496
    ds_read_b64_tr_b16 v[140:141], v30 offset:29376
    ds_read_b64_tr_b16 v[142:143], v30 offset:30528
    ds_read_b64_tr_b16 v[144:145], v30 offset:29408
    ds_read_b64_tr_b16 v[146:147], v30 offset:30560
    ds_read_b64_tr_b16 v[148:149], v30 offset:29440
    ds_read_b64_tr_b16 v[150:151], v30 offset:30592
    s_waitcnt lgkmcnt(0)
    v_mfma_f32_16x16x32_bf16 v[156:159], v[116:119], v[68:71], v[156:159]
    v_mfma_f32_16x16x32_bf16 v[192:195], v[116:119], v[76:79], v[192:195]
    v_mfma_f32_16x16x32_bf16 v[160:163], v[120:123], v[68:71], v[160:163]
    v_mfma_f32_16x16x32_bf16 v[196:199], v[120:123], v[76:79], v[196:199]
    v_mfma_f32_16x16x32_bf16 v[164:167], v[124:127], v[68:71], v[164:167]
    v_mfma_f32_16x16x32_bf16 v[200:203], v[124:127], v[76:79], v[200:203]
    v_mfma_f32_16x16x32_bf16 v[168:171], v[128:131], v[68:71], v[168:171]
    v_mfma_f32_16x16x32_bf16 v[204:207], v[128:131], v[76:79], v[204:207]
    v_mfma_f32_16x16x32_bf16 v[172:175], v[132:135], v[68:71], v[172:175]
    v_mfma_f32_16x16x32_bf16 v[208:211], v[132:135], v[76:79], v[208:211]
    v_mfma_f32_16x16x32_bf16 v[176:179], v[136:139], v[68:71], v[176:179]
    v_mfma_f32_16x16x32_bf16 v[212:215], v[136:139], v[76:79], v[212:215]
    v_mfma_f32_16x16x32_bf16 v[180:183], v[140:143], v[68:71], v[180:183]
    v_mfma_f32_16x16x32_bf16 v[216:219], v[140:143], v[76:79], v[216:219]
    v_mfma_f32_16x16x32_bf16 v[184:187], v[144:147], v[68:71], v[184:187]
    v_mfma_f32_16x16x32_bf16 v[220:223], v[144:147], v[76:79], v[220:223]
    v_mfma_f32_16x16x32_bf16 v[188:191], v[148:151], v[68:71], v[188:191]
    v_mfma_f32_16x16x32_bf16 v[224:227], v[148:151], v[76:79], v[224:227]
    s_waitcnt vmcnt(17)
    ds_write_b64 v21, v[80:81] offset:0
    ds_write_b64 v22, v[82:83] offset:0
    ds_write_b64 v23, v[84:85] offset:0
    ds_write_b64 v24, v[86:87] offset:0
    ds_write_b64 v25, v[88:89] offset:0
    ds_write_b64 v26, v[90:91] offset:0
    ds_write_b64 v27, v[92:93] offset:0
    ds_write_b64 v28, v[94:95] offset:0
    ds_write_b64 v29, v[96:97] offset:0
    s_waitcnt lgkmcnt(0)
    s_barrier
    s_add_u32 s29, s28, 1769472
    buffer_load_dwordx2 v[80:81], v12, s[12:15], s29 offen
    buffer_load_dwordx2 v[82:83], v13, s[12:15], s29 offen
    buffer_load_dwordx2 v[84:85], v14, s[12:15], s29 offen
    buffer_load_dwordx2 v[86:87], v15, s[12:15], s29 offen
    buffer_load_dwordx2 v[88:89], v16, s[12:15], s29 offen
    buffer_load_dwordx2 v[90:91], v17, s[12:15], s29 offen
    buffer_load_dwordx2 v[92:93], v18, s[12:15], s29 offen
    buffer_load_dwordx2 v[94:95], v19, s[12:15], s29 offen
    buffer_load_dwordx2 v[96:97], v20, s[12:15], s29 offen
    s_add_u32 s30, s27, 1024
    buffer_load_dwordx4 v[64:67], v10, s[8:11], s30 offen offset:0
    buffer_load_dwordx4 v[68:71], v10, s[8:11], s30 offen offset:64
    buffer_load_dwordx4 v[72:75], v11, s[8:11], s30 offen offset:0
    buffer_load_dwordx4 v[76:79], v11, s[8:11], s30 offen offset:64
    ds_read_b64_tr_b16 v[116:117], v30 offset:0
    ds_read_b64_tr_b16 v[118:119], v30 offset:1152
    ds_read_b64_tr_b16 v[120:121], v30 offset:32
    ds_read_b64_tr_b16 v[122:123], v30 offset:1184
    ds_read_b64_tr_b16 v[124:125], v30 offset:64
    ds_read_b64_tr_b16 v[126:127], v30 offset:1216
    ds_read_b64_tr_b16 v[128:129], v30 offset:96
    ds_read_b64_tr_b16 v[130:131], v30 offset:1248
    ds_read_b64_tr_b16 v[132:133], v30 offset:128
    ds_read_b64_tr_b16 v[134:135], v30 offset:1280
    ds_read_b64_tr_b16 v[136:137], v30 offset:160
    ds_read_b64_tr_b16 v[138:139], v30 offset:1312
    ds_read_b64_tr_b16 v[140:141], v30 offset:192
    ds_read_b64_tr_b16 v[142:143], v30 offset:1344
    ds_read_b64_tr_b16 v[144:145], v30 offset:224
    ds_read_b64_tr_b16 v[146:147], v30 offset:1376
    ds_read_b64_tr_b16 v[148:149], v30 offset:256
    ds_read_b64_tr_b16 v[150:151], v30 offset:1408
    s_waitcnt vmcnt(26)
    s_waitcnt lgkmcnt(0)
    v_mfma_f32_16x16x32_bf16 v[156:159], v[116:119], v[32:35], v[156:159]
    v_mfma_f32_16x16x32_bf16 v[192:195], v[116:119], v[40:43], v[192:195]
    v_mfma_f32_16x16x32_bf16 v[160:163], v[120:123], v[32:35], v[160:163]
    v_mfma_f32_16x16x32_bf16 v[196:199], v[120:123], v[40:43], v[196:199]
    v_mfma_f32_16x16x32_bf16 v[164:167], v[124:127], v[32:35], v[164:167]
    v_mfma_f32_16x16x32_bf16 v[200:203], v[124:127], v[40:43], v[200:203]
    v_mfma_f32_16x16x32_bf16 v[168:171], v[128:131], v[32:35], v[168:171]
    v_mfma_f32_16x16x32_bf16 v[204:207], v[128:131], v[40:43], v[204:207]
    v_mfma_f32_16x16x32_bf16 v[172:175], v[132:135], v[32:35], v[172:175]
    v_mfma_f32_16x16x32_bf16 v[208:211], v[132:135], v[40:43], v[208:211]
    v_mfma_f32_16x16x32_bf16 v[176:179], v[136:139], v[32:35], v[176:179]
    v_mfma_f32_16x16x32_bf16 v[212:215], v[136:139], v[40:43], v[212:215]
    v_mfma_f32_16x16x32_bf16 v[180:183], v[140:143], v[32:35], v[180:183]
    v_mfma_f32_16x16x32_bf16 v[216:219], v[140:143], v[40:43], v[216:219]
    v_mfma_f32_16x16x32_bf16 v[184:187], v[144:147], v[32:35], v[184:187]
    v_mfma_f32_16x16x32_bf16 v[220:223], v[144:147], v[40:43], v[220:223]
    v_mfma_f32_16x16x32_bf16 v[188:191], v[148:151], v[32:35], v[188:191]
    v_mfma_f32_16x16x32_bf16 v[224:227], v[148:151], v[40:43], v[224:227]
    ds_read_b64_tr_b16 v[116:117], v30 offset:9728
    ds_read_b64_tr_b16 v[118:119], v30 offset:10880
    ds_read_b64_tr_b16 v[120:121], v30 offset:9760
    ds_read_b64_tr_b16 v[122:123], v30 offset:10912
    ds_read_b64_tr_b16 v[124:125], v30 offset:9792
    ds_read_b64_tr_b16 v[126:127], v30 offset:10944
    ds_read_b64_tr_b16 v[128:129], v30 offset:9824
    ds_read_b64_tr_b16 v[130:131], v30 offset:10976
    ds_read_b64_tr_b16 v[132:133], v30 offset:9856
    ds_read_b64_tr_b16 v[134:135], v30 offset:11008
    ds_read_b64_tr_b16 v[136:137], v30 offset:9888
    ds_read_b64_tr_b16 v[138:139], v30 offset:11040
    ds_read_b64_tr_b16 v[140:141], v30 offset:9920
    ds_read_b64_tr_b16 v[142:143], v30 offset:11072
    ds_read_b64_tr_b16 v[144:145], v30 offset:9952
    ds_read_b64_tr_b16 v[146:147], v30 offset:11104
    ds_read_b64_tr_b16 v[148:149], v30 offset:9984
    ds_read_b64_tr_b16 v[150:151], v30 offset:11136
    s_waitcnt lgkmcnt(0)
    v_mfma_f32_16x16x32_bf16 v[156:159], v[116:119], v[36:39], v[156:159]
    v_mfma_f32_16x16x32_bf16 v[192:195], v[116:119], v[44:47], v[192:195]
    v_mfma_f32_16x16x32_bf16 v[160:163], v[120:123], v[36:39], v[160:163]
    v_mfma_f32_16x16x32_bf16 v[196:199], v[120:123], v[44:47], v[196:199]
    v_mfma_f32_16x16x32_bf16 v[164:167], v[124:127], v[36:39], v[164:167]
    v_mfma_f32_16x16x32_bf16 v[200:203], v[124:127], v[44:47], v[200:203]
    v_mfma_f32_16x16x32_bf16 v[168:171], v[128:131], v[36:39], v[168:171]
    v_mfma_f32_16x16x32_bf16 v[204:207], v[128:131], v[44:47], v[204:207]
    v_mfma_f32_16x16x32_bf16 v[172:175], v[132:135], v[36:39], v[172:175]
    v_mfma_f32_16x16x32_bf16 v[208:211], v[132:135], v[44:47], v[208:211]
    v_mfma_f32_16x16x32_bf16 v[176:179], v[136:139], v[36:39], v[176:179]
    v_mfma_f32_16x16x32_bf16 v[212:215], v[136:139], v[44:47], v[212:215]
    v_mfma_f32_16x16x32_bf16 v[180:183], v[140:143], v[36:39], v[180:183]
    v_mfma_f32_16x16x32_bf16 v[216:219], v[140:143], v[44:47], v[216:219]
    v_mfma_f32_16x16x32_bf16 v[184:187], v[144:147], v[36:39], v[184:187]
    v_mfma_f32_16x16x32_bf16 v[220:223], v[144:147], v[44:47], v[220:223]
    v_mfma_f32_16x16x32_bf16 v[188:191], v[148:151], v[36:39], v[188:191]
    v_mfma_f32_16x16x32_bf16 v[224:227], v[148:151], v[44:47], v[224:227]
    s_waitcnt vmcnt(17)
    ds_write_b64 v21, v[98:99] offset:19456
    ds_write_b64 v22, v[100:101] offset:19456
    ds_write_b64 v23, v[102:103] offset:19456
    ds_write_b64 v24, v[104:105] offset:19456
    ds_write_b64 v25, v[106:107] offset:19456
    ds_write_b64 v26, v[108:109] offset:19456
    ds_write_b64 v27, v[110:111] offset:19456
    ds_write_b64 v28, v[112:113] offset:19456
    ds_write_b64 v29, v[114:115] offset:19456
    s_waitcnt lgkmcnt(0)
    s_barrier
    ds_read_b64_tr_b16 v[116:117], v30 offset:19456
    ds_read_b64_tr_b16 v[118:119], v30 offset:20608
    ds_read_b64_tr_b16 v[120:121], v30 offset:19488
    ds_read_b64_tr_b16 v[122:123], v30 offset:20640
    ds_read_b64_tr_b16 v[124:125], v30 offset:19520
    ds_read_b64_tr_b16 v[126:127], v30 offset:20672
    ds_read_b64_tr_b16 v[128:129], v30 offset:19552
    ds_read_b64_tr_b16 v[130:131], v30 offset:20704
    ds_read_b64_tr_b16 v[132:133], v30 offset:19584
    ds_read_b64_tr_b16 v[134:135], v30 offset:20736
    ds_read_b64_tr_b16 v[136:137], v30 offset:19616
    ds_read_b64_tr_b16 v[138:139], v30 offset:20768
    ds_read_b64_tr_b16 v[140:141], v30 offset:19648
    ds_read_b64_tr_b16 v[142:143], v30 offset:20800
    ds_read_b64_tr_b16 v[144:145], v30 offset:19680
    ds_read_b64_tr_b16 v[146:147], v30 offset:20832
    ds_read_b64_tr_b16 v[148:149], v30 offset:19712
    ds_read_b64_tr_b16 v[150:151], v30 offset:20864
    s_waitcnt vmcnt(13)
    s_waitcnt lgkmcnt(0)
    v_mfma_f32_16x16x32_bf16 v[156:159], v[116:119], v[48:51], v[156:159]
    v_mfma_f32_16x16x32_bf16 v[192:195], v[116:119], v[56:59], v[192:195]
    v_mfma_f32_16x16x32_bf16 v[160:163], v[120:123], v[48:51], v[160:163]
    v_mfma_f32_16x16x32_bf16 v[196:199], v[120:123], v[56:59], v[196:199]
    v_mfma_f32_16x16x32_bf16 v[164:167], v[124:127], v[48:51], v[164:167]
    v_mfma_f32_16x16x32_bf16 v[200:203], v[124:127], v[56:59], v[200:203]
    v_mfma_f32_16x16x32_bf16 v[168:171], v[128:131], v[48:51], v[168:171]
    v_mfma_f32_16x16x32_bf16 v[204:207], v[128:131], v[56:59], v[204:207]
    v_mfma_f32_16x16x32_bf16 v[172:175], v[132:135], v[48:51], v[172:175]
    v_mfma_f32_16x16x32_bf16 v[208:211], v[132:135], v[56:59], v[208:211]
    v_mfma_f32_16x16x32_bf16 v[176:179], v[136:139], v[48:51], v[176:179]
    v_mfma_f32_16x16x32_bf16 v[212:215], v[136:139], v[56:59], v[212:215]
    v_mfma_f32_16x16x32_bf16 v[180:183], v[140:143], v[48:51], v[180:183]
    v_mfma_f32_16x16x32_bf16 v[216:219], v[140:143], v[56:59], v[216:219]
    v_mfma_f32_16x16x32_bf16 v[184:187], v[144:147], v[48:51], v[184:187]
    v_mfma_f32_16x16x32_bf16 v[220:223], v[144:147], v[56:59], v[220:223]
    v_mfma_f32_16x16x32_bf16 v[188:191], v[148:151], v[48:51], v[188:191]
    v_mfma_f32_16x16x32_bf16 v[224:227], v[148:151], v[56:59], v[224:227]
    ds_read_b64_tr_b16 v[116:117], v30 offset:29184
    ds_read_b64_tr_b16 v[118:119], v30 offset:30336
    ds_read_b64_tr_b16 v[120:121], v30 offset:29216
    ds_read_b64_tr_b16 v[122:123], v30 offset:30368
    ds_read_b64_tr_b16 v[124:125], v30 offset:29248
    ds_read_b64_tr_b16 v[126:127], v30 offset:30400
    ds_read_b64_tr_b16 v[128:129], v30 offset:29280
    ds_read_b64_tr_b16 v[130:131], v30 offset:30432
    ds_read_b64_tr_b16 v[132:133], v30 offset:29312
    ds_read_b64_tr_b16 v[134:135], v30 offset:30464
    ds_read_b64_tr_b16 v[136:137], v30 offset:29344
    ds_read_b64_tr_b16 v[138:139], v30 offset:30496
    ds_read_b64_tr_b16 v[140:141], v30 offset:29376
    ds_read_b64_tr_b16 v[142:143], v30 offset:30528
    ds_read_b64_tr_b16 v[144:145], v30 offset:29408
    ds_read_b64_tr_b16 v[146:147], v30 offset:30560
    ds_read_b64_tr_b16 v[148:149], v30 offset:29440
    ds_read_b64_tr_b16 v[150:151], v30 offset:30592
    s_waitcnt lgkmcnt(0)
    v_mfma_f32_16x16x32_bf16 v[156:159], v[116:119], v[52:55], v[156:159]
    v_mfma_f32_16x16x32_bf16 v[192:195], v[116:119], v[60:63], v[192:195]
    v_mfma_f32_16x16x32_bf16 v[160:163], v[120:123], v[52:55], v[160:163]
    v_mfma_f32_16x16x32_bf16 v[196:199], v[120:123], v[60:63], v[196:199]
    v_mfma_f32_16x16x32_bf16 v[164:167], v[124:127], v[52:55], v[164:167]
    v_mfma_f32_16x16x32_bf16 v[200:203], v[124:127], v[60:63], v[200:203]
    v_mfma_f32_16x16x32_bf16 v[168:171], v[128:131], v[52:55], v[168:171]
    v_mfma_f32_16x16x32_bf16 v[204:207], v[128:131], v[60:63], v[204:207]
    v_mfma_f32_16x16x32_bf16 v[172:175], v[132:135], v[52:55], v[172:175]
    v_mfma_f32_16x16x32_bf16 v[208:211], v[132:135], v[60:63], v[208:211]
    v_mfma_f32_16x16x32_bf16 v[176:179], v[136:139], v[52:55], v[176:179]
    v_mfma_f32_16x16x32_bf16 v[212:215], v[136:139], v[60:63], v[212:215]
    v_mfma_f32_16x16x32_bf16 v[180:183], v[140:143], v[52:55], v[180:183]
    v_mfma_f32_16x16x32_bf16 v[216:219], v[140:143], v[60:63], v[216:219]
    v_mfma_f32_16x16x32_bf16 v[184:187], v[144:147], v[52:55], v[184:187]
    v_mfma_f32_16x16x32_bf16 v[220:223], v[144:147], v[60:63], v[220:223]
    v_mfma_f32_16x16x32_bf16 v[188:191], v[148:151], v[52:55], v[188:191]
    v_mfma_f32_16x16x32_bf16 v[224:227], v[148:151], v[60:63], v[224:227]
    s_waitcnt vmcnt(4)
    ds_write_b64 v21, v[80:81] offset:0
    ds_write_b64 v22, v[82:83] offset:0
    ds_write_b64 v23, v[84:85] offset:0
    ds_write_b64 v24, v[86:87] offset:0
    ds_write_b64 v25, v[88:89] offset:0
    ds_write_b64 v26, v[90:91] offset:0
    ds_write_b64 v27, v[92:93] offset:0
    ds_write_b64 v28, v[94:95] offset:0
    ds_write_b64 v29, v[96:97] offset:0
    s_waitcnt lgkmcnt(0)
    s_barrier
    ds_read_b64_tr_b16 v[116:117], v30 offset:0
    ds_read_b64_tr_b16 v[118:119], v30 offset:1152
    ds_read_b64_tr_b16 v[120:121], v30 offset:32
    ds_read_b64_tr_b16 v[122:123], v30 offset:1184
    ds_read_b64_tr_b16 v[124:125], v30 offset:64
    ds_read_b64_tr_b16 v[126:127], v30 offset:1216
    ds_read_b64_tr_b16 v[128:129], v30 offset:96
    ds_read_b64_tr_b16 v[130:131], v30 offset:1248
    ds_read_b64_tr_b16 v[132:133], v30 offset:128
    ds_read_b64_tr_b16 v[134:135], v30 offset:1280
    ds_read_b64_tr_b16 v[136:137], v30 offset:160
    ds_read_b64_tr_b16 v[138:139], v30 offset:1312
    ds_read_b64_tr_b16 v[140:141], v30 offset:192
    ds_read_b64_tr_b16 v[142:143], v30 offset:1344
    ds_read_b64_tr_b16 v[144:145], v30 offset:224
    ds_read_b64_tr_b16 v[146:147], v30 offset:1376
    ds_read_b64_tr_b16 v[148:149], v30 offset:256
    ds_read_b64_tr_b16 v[150:151], v30 offset:1408
    s_waitcnt vmcnt(0)
    s_waitcnt lgkmcnt(0)
    v_mfma_f32_16x16x32_bf16 v[156:159], v[116:119], v[64:67], v[156:159]
    v_mfma_f32_16x16x32_bf16 v[192:195], v[116:119], v[72:75], v[192:195]
    v_mfma_f32_16x16x32_bf16 v[160:163], v[120:123], v[64:67], v[160:163]
    v_mfma_f32_16x16x32_bf16 v[196:199], v[120:123], v[72:75], v[196:199]
    v_mfma_f32_16x16x32_bf16 v[164:167], v[124:127], v[64:67], v[164:167]
    v_mfma_f32_16x16x32_bf16 v[200:203], v[124:127], v[72:75], v[200:203]
    v_mfma_f32_16x16x32_bf16 v[168:171], v[128:131], v[64:67], v[168:171]
    v_mfma_f32_16x16x32_bf16 v[204:207], v[128:131], v[72:75], v[204:207]
    v_mfma_f32_16x16x32_bf16 v[172:175], v[132:135], v[64:67], v[172:175]
    v_mfma_f32_16x16x32_bf16 v[208:211], v[132:135], v[72:75], v[208:211]
    v_mfma_f32_16x16x32_bf16 v[176:179], v[136:139], v[64:67], v[176:179]
    v_mfma_f32_16x16x32_bf16 v[212:215], v[136:139], v[72:75], v[212:215]
    v_mfma_f32_16x16x32_bf16 v[180:183], v[140:143], v[64:67], v[180:183]
    v_mfma_f32_16x16x32_bf16 v[216:219], v[140:143], v[72:75], v[216:219]
    v_mfma_f32_16x16x32_bf16 v[184:187], v[144:147], v[64:67], v[184:187]
    v_mfma_f32_16x16x32_bf16 v[220:223], v[144:147], v[72:75], v[220:223]
    v_mfma_f32_16x16x32_bf16 v[188:191], v[148:151], v[64:67], v[188:191]
    v_mfma_f32_16x16x32_bf16 v[224:227], v[148:151], v[72:75], v[224:227]
    ds_read_b64_tr_b16 v[116:117], v30 offset:9728
    ds_read_b64_tr_b16 v[118:119], v30 offset:10880
    ds_read_b64_tr_b16 v[120:121], v30 offset:9760
    ds_read_b64_tr_b16 v[122:123], v30 offset:10912
    ds_read_b64_tr_b16 v[124:125], v30 offset:9792
    ds_read_b64_tr_b16 v[126:127], v30 offset:10944
    ds_read_b64_tr_b16 v[128:129], v30 offset:9824
    ds_read_b64_tr_b16 v[130:131], v30 offset:10976
    ds_read_b64_tr_b16 v[132:133], v30 offset:9856
    ds_read_b64_tr_b16 v[134:135], v30 offset:11008
    ds_read_b64_tr_b16 v[136:137], v30 offset:9888
    ds_read_b64_tr_b16 v[138:139], v30 offset:11040
    ds_read_b64_tr_b16 v[140:141], v30 offset:9920
    ds_read_b64_tr_b16 v[142:143], v30 offset:11072
    ds_read_b64_tr_b16 v[144:145], v30 offset:9952
    ds_read_b64_tr_b16 v[146:147], v30 offset:11104
    ds_read_b64_tr_b16 v[148:149], v30 offset:9984
    ds_read_b64_tr_b16 v[150:151], v30 offset:11136
    s_waitcnt lgkmcnt(0)
    v_mfma_f32_16x16x32_bf16 v[156:159], v[116:119], v[68:71], v[156:159]
    v_mfma_f32_16x16x32_bf16 v[192:195], v[116:119], v[76:79], v[192:195]
    v_mfma_f32_16x16x32_bf16 v[160:163], v[120:123], v[68:71], v[160:163]
    v_mfma_f32_16x16x32_bf16 v[196:199], v[120:123], v[76:79], v[196:199]
    v_mfma_f32_16x16x32_bf16 v[164:167], v[124:127], v[68:71], v[164:167]
    v_mfma_f32_16x16x32_bf16 v[200:203], v[124:127], v[76:79], v[200:203]
    v_mfma_f32_16x16x32_bf16 v[168:171], v[128:131], v[68:71], v[168:171]
    v_mfma_f32_16x16x32_bf16 v[204:207], v[128:131], v[76:79], v[204:207]
    v_mfma_f32_16x16x32_bf16 v[172:175], v[132:135], v[68:71], v[172:175]
    v_mfma_f32_16x16x32_bf16 v[208:211], v[132:135], v[76:79], v[208:211]
    v_mfma_f32_16x16x32_bf16 v[176:179], v[136:139], v[68:71], v[176:179]
    v_mfma_f32_16x16x32_bf16 v[212:215], v[136:139], v[76:79], v[212:215]
    v_mfma_f32_16x16x32_bf16 v[180:183], v[140:143], v[68:71], v[180:183]
    v_mfma_f32_16x16x32_bf16 v[216:219], v[140:143], v[76:79], v[216:219]
    v_mfma_f32_16x16x32_bf16 v[184:187], v[144:147], v[68:71], v[184:187]
    v_mfma_f32_16x16x32_bf16 v[220:223], v[144:147], v[76:79], v[220:223]
    v_mfma_f32_16x16x32_bf16 v[188:191], v[148:151], v[68:71], v[188:191]
    v_mfma_f32_16x16x32_bf16 v[224:227], v[148:151], v[76:79], v[224:227]
    s_nop 15
    s_nop 3
    s_add_u32 s32, s16, 4194304
    s_addc_u32 s33, s17, 0
    s_mov_b32 s34, 7077888
    s_mov_b32 s35, 0x00020000
    s_mul_i32 s31, s22, 288
    v_mul_u32_u24 v7, 8, v4
    v_add_u32 v7, s31, v7
    s_mov_b32 s25, 3456
    v_add_u32 v6, 0, v5
    v_mul_lo_u32 v6, v6, s25
    v_add_u32 v60, v6, v7
    v_add_u32 v6, 16, v5
    v_mul_lo_u32 v6, v6, s25
    v_add_u32 v61, v6, v7
    v_cvt_pk_bf16_f32 v156, v156, v157
    v_cvt_pk_bf16_f32 v157, v158, v159
    buffer_store_dwordx2 v[156:157], v60, s[32:35], 0 offen offset:0
    v_cvt_pk_bf16_f32 v160, v160, v161
    v_cvt_pk_bf16_f32 v161, v162, v163
    buffer_store_dwordx2 v[160:161], v60, s[32:35], 0 offen offset:32
    v_cvt_pk_bf16_f32 v164, v164, v165
    v_cvt_pk_bf16_f32 v165, v166, v167
    buffer_store_dwordx2 v[164:165], v60, s[32:35], 0 offen offset:64
    v_cvt_pk_bf16_f32 v168, v168, v169
    v_cvt_pk_bf16_f32 v169, v170, v171
    buffer_store_dwordx2 v[168:169], v60, s[32:35], 0 offen offset:96
    v_cvt_pk_bf16_f32 v172, v172, v173
    v_cvt_pk_bf16_f32 v173, v174, v175
    buffer_store_dwordx2 v[172:173], v60, s[32:35], 0 offen offset:128
    v_cvt_pk_bf16_f32 v176, v176, v177
    v_cvt_pk_bf16_f32 v177, v178, v179
    buffer_store_dwordx2 v[176:177], v60, s[32:35], 0 offen offset:160
    v_cvt_pk_bf16_f32 v180, v180, v181
    v_cvt_pk_bf16_f32 v181, v182, v183
    buffer_store_dwordx2 v[180:181], v60, s[32:35], 0 offen offset:192
    v_cvt_pk_bf16_f32 v184, v184, v185
    v_cvt_pk_bf16_f32 v185, v186, v187
    buffer_store_dwordx2 v[184:185], v60, s[32:35], 0 offen offset:224
    v_cvt_pk_bf16_f32 v188, v188, v189
    v_cvt_pk_bf16_f32 v189, v190, v191
    buffer_store_dwordx2 v[188:189], v60, s[32:35], 0 offen offset:256
    v_cvt_pk_bf16_f32 v192, v192, v193
    v_cvt_pk_bf16_f32 v193, v194, v195
    buffer_store_dwordx2 v[192:193], v61, s[32:35], 0 offen offset:0
    v_cvt_pk_bf16_f32 v196, v196, v197
    v_cvt_pk_bf16_f32 v197, v198, v199
    buffer_store_dwordx2 v[196:197], v61, s[32:35], 0 offen offset:32
    v_cvt_pk_bf16_f32 v200, v200, v201
    v_cvt_pk_bf16_f32 v201, v202, v203
    buffer_store_dwordx2 v[200:201], v61, s[32:35], 0 offen offset:64
    v_cvt_pk_bf16_f32 v204, v204, v205
    v_cvt_pk_bf16_f32 v205, v206, v207
    buffer_store_dwordx2 v[204:205], v61, s[32:35], 0 offen offset:96
    v_cvt_pk_bf16_f32 v208, v208, v209
    v_cvt_pk_bf16_f32 v209, v210, v211
    buffer_store_dwordx2 v[208:209], v61, s[32:35], 0 offen offset:128
    v_cvt_pk_bf16_f32 v212, v212, v213
    v_cvt_pk_bf16_f32 v213, v214, v215
    buffer_store_dwordx2 v[212:213], v61, s[32:35], 0 offen offset:160
    v_cvt_pk_bf16_f32 v216, v216, v217
    v_cvt_pk_bf16_f32 v217, v218, v219
    buffer_store_dwordx2 v[216:217], v61, s[32:35], 0 offen offset:192
    v_cvt_pk_bf16_f32 v220, v220, v221
    v_cvt_pk_bf16_f32 v221, v222, v223
    buffer_store_dwordx2 v[220:221], v61, s[32:35], 0 offen offset:224
    v_cvt_pk_bf16_f32 v224, v224, v225
    v_cvt_pk_bf16_f32 v225, v226, v227
    buffer_store_dwordx2 v[224:225], v61, s[32:35], 0 offen offset:256
L_k_qkv_kernel_end:
    s_endpgm
.globl k_l3_kernel
.p2align 8
.type k_l3_kernel,@function
k_l3_kernel:
    s_cmp_ge_u32 s2, 256
    s_cbranch_scc1 L_k_l3_kernel_roleB
    s_cmp_ge_u32 s2, 256
    s_cbranch_scc1 L_k_attn1_end
    s_load_dwordx2 s[4:5], s[0:1], 16
    s_load_dwordx2 s[6:7], s[0:1], 88
    s_and_b32 s20, s2, 31
    s_lshr_b32 s21, s2, 5
    s_waitcnt lgkmcnt(0)
    s_mov_b32 s8, s4
    s_mov_b32 s9, s5
    s_mov_b32 s10, 20736
    s_mov_b32 s11, 0x00020000
    s_mul_i32 s24, s20, 648
    v_cmp_gt_u32 vcc, 162, v0
    s_and_saveexec_b64 s[12:13], vcc
    v_lshlrev_b32 v1, 2, v0
    buffer_load_dword v2, v1, s[8:11], s24 offen
    v_lshlrev_b32 v3, 1, v0
    s_mov_b32 s25, 0xe38e38f
    v_mul_hi_u32 v4, v3, s25
    v_mul_u32_u24 v5, 18, v4
    v_sub_u32 v5, v3, v5
    v_mul_u32_u24 v4, 80, v4
    v_lshl_add_u32 v4, v5, 2, v4
    s_waitcnt vmcnt(0)
    v_lshlrev_b32 v6, 16, v2
    v_and_b32 v7, 0xffff0000, v2
    ds_write_b64 v4, v[6:7]
    s_mov_b64 exec, s[12:13]
    s_add_u32 s12, s6, 4194304
    s_addc_u32 s13, s7, 0
    s_mov_b32 s14, 7077888
    s_mov_b32 s15, 0x00020000
    s_lshl_b32 s24, s21, 8
    v_add_u32 v1, s24, v0
    s_mov_b32 s25, 3456
    v_mul_lo_u32 v1, v1, s25
    s_mul_i32 s26, s20, 36
    s_add_u32 s26, s26, 1152
    buffer_load_dword v16, v1, s[12:15], s26 offen offset:0
    buffer_load_dword v17, v1, s[12:15], s26 offen offset:4
    buffer_load_dword v18, v1, s[12:15], s26 offen offset:8
    buffer_load_dword v19, v1, s[12:15], s26 offen offset:12
    buffer_load_dword v20, v1, s[12:15], s26 offen offset:16
    buffer_load_dword v21, v1, s[12:15], s26 offen offset:20
    buffer_load_dword v22, v1, s[12:15], s26 offen offset:24
    buffer_load_dword v23, v1, s[12:15], s26 offen offset:28
    buffer_load_dword v24, v1, s[12:15], s26 offen offset:32
    buffer_load_dword v26, v1, s[12:15], s26 offen offset:1152
    buffer_load_dword v27, v1, s[12:15], s26 offen offset:1156
    buffer_load_dword v28, v1, s[12:15], s26 offen offset:1160
    buffer_load_dword v29, v1, s[12:15], s26 offen offset:1164
    buffer_load_dword v30, v1, s[12:15], s26 offen offset:1168
    buffer_load_dword v31, v1, s[12:15], s26 offen offset:1172
    buffer_load_dword v32, v1, s[12:15], s26 offen offset:1176
    buffer_load_dword v33, v1, s[12:15], s26 offen offset:1180
    buffer_load_dword v34, v1, s[12:15], s26 offen offset:1184
    v_mov_b32 v9, 0
    s_waitcnt vmcnt(0) lgkmcnt(0)
    s_barrier
    v_mov_b32 v40, 0
    v_mov_b32 v41, 0
    v_mov_b32 v42, 0
    v_mov_b32 v43, 0
    v_mov_b32 v44, 0
    v_mov_b32 v45, 0
    v_mov_b32 v46, 0
    v_mov_b32 v47, 0
    v_mov_b32 v48, 0
    v_mov_b32 v49, 0
    v_mov_b32 v50, 0
    v_mov_b32 v51, 0
    v_mov_b32 v52, 0
    v_mov_b32 v53, 0
    v_mov_b32 v54, 0
    v_mov_b32 v55, 0
    v_mov_b32 v56, 0
    v_mov_b32 v57, 0
    ds_read_b128 v[100:103], v9 offset:0
    ds_read_b128 v[104:107], v9 offset:16
    ds_read_b128 v[108:111], v9 offset:32
    ds_read_b128 v[112:115], v9 offset:48
    ds_read_b64 v[116:117], v9 offset:64
    v_lshlrev_b32 v120, 16, v16
    s_waitcnt lgkmcnt(0)
    v_fmac_f32 v40, v120, v100
    v_fmac_f32 v41, v120, v101
    v_fmac_f32 v42, v120, v102
    v_fmac_f32 v43, v120, v103
    v_fmac_f32 v44, v120, v104
    v_fmac_f32 v45, v120, v105
    v_fmac_f32 v46, v120, v106
    v_fmac_f32 v47, v120, v107
    v_fmac_f32 v48, v120, v108
    v_fmac_f32 v49, v120, v109
    v_fmac_f32 v50, v120, v110
    v_fmac_f32 v51, v120, v111
    v_fmac_f32 v52, v120, v112
    v_fmac_f32 v53, v120, v113
    v_fmac_f32 v54, v120, v114
    v_fmac_f32 v55, v120, v115
    v_fmac_f32 v56, v120, v116
    v_fmac_f32 v57, v120, v117
    ds_read_b128 v[100:103], v9 offset:80
    ds_read_b128 v[104:107], v9 offset:96
    ds_read_b128 v[108:111], v9 offset:112
    ds_read_b128 v[112:115], v9 offset:128
    ds_read_b64 v[116:117], v9 offset:144
    v_and_b32 v120, 0xffff0000, v16
    s_waitcnt lgkmcnt(0)
    v_fmac_f32 v40, v120, v100
    v_fmac_f32 v41, v120, v101
    v_fmac_f32 v42, v120, v102
    v_fmac_f32 v43, v120, v103
    v_fmac_f32 v44, v120, v104
    v_fmac_f32 v45, v120, v105
    v_fmac_f32 v46, v120, v106
    v_fmac_f32 v47, v120, v107
    v_fmac_f32 v48, v120, v108
    v_fmac_f32 v49, v120, v109
    v_fmac_f32 v50, v120, v110
    v_fmac_f32 v51, v120, v111
    v_fmac_f32 v52, v120, v112
    v_fmac_f32 v53, v120, v113
    v_fmac_f32 v54, v120, v114
    v_fmac_f32 v55, v120, v115
    v_fmac_f32 v56, v120, v116
    v_fmac_f32 v57, v120, v117
    ds_read_b128 v[100:103], v9 offset:160
    ds_read_b128 v[104:107], v9 offset:176
    ds_read_b128 v[108:111], v9 offset:192
    ds_read_b128 v[112:115], v9 offset:208
    ds_read_b64 v[116:117], v9 offset:224
    v_lshlrev_b32 v120, 16, v17
    s_waitcnt lgkmcnt(0)
    v_fmac_f32 v40, v120, v100
    v_fmac_f32 v41, v120, v101
    v_fmac_f32 v42, v120, v102
    v_fmac_f32 v43, v120, v103
    v_fmac_f32 v44, v120, v104
    v_fmac_f32 v45, v120, v105
    v_fmac_f32 v46, v120, v106
    v_fmac_f32 v47, v120, v107
    v_fmac_f32 v48, v120, v108
    v_fmac_f32 v49, v120, v109
    v_fmac_f32 v50, v120, v110
    v_fmac_f32 v51, v120, v111
    v_fmac_f32 v52, v120, v112
    v_fmac_f32 v53, v120, v113
    v_fmac_f32 v54, v120, v114
    v_fmac_f32 v55, v120, v115
    v_fmac_f32 v56, v120, v116
    v_fmac_f32 v57, v120, v117
    ds_read_b128 v[100:103], v9 offset:240
    ds_read_b128 v[104:107], v9 offset:256
    ds_read_b128 v[108:111], v9 offset:272
    ds_read_b128 v[112:115], v9 offset:288
    ds_read_b64 v[116:117], v9 offset:304
    v_and_b32 v120, 0xffff0000, v17
    s_waitcnt lgkmcnt(0)
    v_fmac_f32 v40, v120, v100
    v_fmac_f32 v41, v120, v101
    v_fmac_f32 v42, v120, v102
    v_fmac_f32 v43, v120, v103
    v_fmac_f32 v44, v120, v104
    v_fmac_f32 v45, v120, v105
    v_fmac_f32 v46, v120, v106
    v_fmac_f32 v47, v120, v107
    v_fmac_f32 v48, v120, v108
    v_fmac_f32 v49, v120, v109
    v_fmac_f32 v50, v120, v110
    v_fmac_f32 v51, v120, v111
    v_fmac_f32 v52, v120, v112
    v_fmac_f32 v53, v120, v113
    v_fmac_f32 v54, v120, v114
    v_fmac_f32 v55, v120, v115
    v_fmac_f32 v56, v120, v116
    v_fmac_f32 v57, v120, v117
    ds_read_b128 v[100:103], v9 offset:320
    ds_read_b128 v[104:107], v9 offset:336
    ds_read_b128 v[108:111], v9 offset:352
    ds_read_b128 v[112:115], v9 offset:368
    ds_read_b64 v[116:117], v9 offset:384
    v_lshlrev_b32 v120, 16, v18
    s_waitcnt lgkmcnt(0)
    v_fmac_f32 v40, v120, v100
    v_fmac_f32 v41, v120, v101
    v_fmac_f32 v42, v120, v102
    v_fmac_f32 v43, v120, v103
    v_fmac_f32 v44, v120, v104
    v_fmac_f32 v45, v120, v105
    v_fmac_f32 v46, v120, v106
    v_fmac_f32 v47, v120, v107
    v_fmac_f32 v48, v120, v108
    v_fmac_f32 v49, v120, v109
    v_fmac_f32 v50, v120, v110
    v_fmac_f32 v51, v120, v111
    v_fmac_f32 v52, v120, v112
    v_fmac_f32 v53, v120, v113
    v_fmac_f32 v54, v120, v114
    v_fmac_f32 v55, v120, v115
    v_fmac_f32 v56, v120, v116
    v_fmac_f32 v57, v120, v117
    ds_read_b128 v[100:103], v9 offset:400
    ds_read_b128 v[104:107], v9 offset:416
    ds_read_b128 v[108:111], v9 offset:432
    ds_read_b128 v[112:115], v9 offset:448
    ds_read_b64 v[116:117], v9 offset:464
    v_and_b32 v120, 0xffff0000, v18
    s_waitcnt lgkmcnt(0)
    v_fmac_f32 v40, v120, v100
    v_fmac_f32 v41, v120, v101
    v_fmac_f32 v42, v120, v102
    v_fmac_f32 v43, v120, v103
    v_fmac_f32 v44, v120, v104
    v_fmac_f32 v45, v120, v105
    v_fmac_f32 v46, v120, v106
    v_fmac_f32 v47, v120, v107
    v_fmac_f32 v48, v120, v108
    v_fmac_f32 v49, v120, v109
    v_fmac_f32 v50, v120, v110
    v_fmac_f32 v51, v120, v111
    v_fmac_f32 v52, v120, v112
    v_fmac_f32 v53, v120, v113
    v_fmac_f32 v54, v120, v114
    v_fmac_f32 v55, v120, v115
    v_fmac_f32 v56, v120, v116
    v_fmac_f32 v57, v120, v117
    ds_read_b128 v[100:103], v9 offset:480
    ds_read_b128 v[104:107], v9 offset:496
    ds_read_b128 v[108:111], v9 offset:512
    ds_read_b128 v[112:115], v9 offset:528
    ds_read_b64 v[116:117], v9 offset:544
    v_lshlrev_b32 v120, 16, v19
    s_waitcnt lgkmcnt(0)
    v_fmac_f32 v40, v120, v100
    v_fmac_f32 v41, v120, v101
    v_fmac_f32 v42, v120, v102
    v_fmac_f32 v43, v120, v103
    v_fmac_f32 v44, v120, v104
    v_fmac_f32 v45, v120, v105
    v_fmac_f32 v46, v120, v106
    v_fmac_f32 v47, v120, v107
    v_fmac_f32 v48, v120, v108
    v_fmac_f32 v49, v120, v109
    v_fmac_f32 v50, v120, v110
    v_fmac_f32 v51, v120, v111
    v_fmac_f32 v52, v120, v112
    v_fmac_f32 v53, v120, v113
    v_fmac_f32 v54, v120, v114
    v_fmac_f32 v55, v120, v115
    v_fmac_f32 v56, v120, v116
    v_fmac_f32 v57, v120, v117
    ds_read_b128 v[100:103], v9 offset:560
    ds_read_b128 v[104:107], v9 offset:576
    ds_read_b128 v[108:111], v9 offset:592
    ds_read_b128 v[112:115], v9 offset:608
    ds_read_b64 v[116:117], v9 offset:624
    v_and_b32 v120, 0xffff0000, v19
    s_waitcnt lgkmcnt(0)
    v_fmac_f32 v40, v120, v100
    v_fmac_f32 v41, v120, v101
    v_fmac_f32 v42, v120, v102
    v_fmac_f32 v43, v120, v103
    v_fmac_f32 v44, v120, v104
    v_fmac_f32 v45, v120, v105
    v_fmac_f32 v46, v120, v106
    v_fmac_f32 v47, v120, v107
    v_fmac_f32 v48, v120, v108
    v_fmac_f32 v49, v120, v109
    v_fmac_f32 v50, v120, v110
    v_fmac_f32 v51, v120, v111
    v_fmac_f32 v52, v120, v112
    v_fmac_f32 v53, v120, v113
    v_fmac_f32 v54, v120, v114
    v_fmac_f32 v55, v120, v115
    v_fmac_f32 v56, v120, v116
    v_fmac_f32 v57, v120, v117
    ds_read_b128 v[100:103], v9 offset:640
    ds_read_b128 v[104:107], v9 offset:656
    ds_read_b128 v[108:111], v9 offset:672
    ds_read_b128 v[112:115], v9 offset:688
    ds_read_b64 v[116:117], v9 offset:704
    v_lshlrev_b32 v120, 16, v20
    s_waitcnt lgkmcnt(0)
    v_fmac_f32 v40, v120, v100
    v_fmac_f32 v41, v120, v101
    v_fmac_f32 v42, v120, v102
    v_fmac_f32 v43, v120, v103
    v_fmac_f32 v44, v120, v104
    v_fmac_f32 v45, v120, v105
    v_fmac_f32 v46, v120, v106
    v_fmac_f32 v47, v120, v107
    v_fmac_f32 v48, v120, v108
    v_fmac_f32 v49, v120, v109
    v_fmac_f32 v50, v120, v110
    v_fmac_f32 v51, v120, v111
    v_fmac_f32 v52, v120, v112
    v_fmac_f32 v53, v120, v113
    v_fmac_f32 v54, v120, v114
    v_fmac_f32 v55, v120, v115
    v_fmac_f32 v56, v120, v116
    v_fmac_f32 v57, v120, v117
    ds_read_b128 v[100:103], v9 offset:720
    ds_read_b128 v[104:107], v9 offset:736
    ds_read_b128 v[108:111], v9 offset:752
    ds_read_b128 v[112:115], v9 offset:768
    ds_read_b64 v[116:117], v9 offset:784
    v_and_b32 v120, 0xffff0000, v20
    s_waitcnt lgkmcnt(0)
    v_fmac_f32 v40, v120, v100
    v_fmac_f32 v41, v120, v101
    v_fmac_f32 v42, v120, v102
    v_fmac_f32 v43, v120, v103
    v_fmac_f32 v44, v120, v104
    v_fmac_f32 v45, v120, v105
    v_fmac_f32 v46, v120, v106
    v_fmac_f32 v47, v120, v107
    v_fmac_f32 v48, v120, v108
    v_fmac_f32 v49, v120, v109
    v_fmac_f32 v50, v120, v110
    v_fmac_f32 v51, v120, v111
    v_fmac_f32 v52, v120, v112
    v_fmac_f32 v53, v120, v113
    v_fmac_f32 v54, v120, v114
    v_fmac_f32 v55, v120, v115
    v_fmac_f32 v56, v120, v116
    v_fmac_f32 v57, v120, v117
    ds_read_b128 v[100:103], v9 offset:800
    ds_read_b128 v[104:107], v9 offset:816
    ds_read_b128 v[108:111], v9 offset:832
    ds_read_b128 v[112:115], v9 offset:848
    ds_read_b64 v[116:117], v9 offset:864
    v_lshlrev_b32 v120, 16, v21
    s_waitcnt lgkmcnt(0)
    v_fmac_f32 v40, v120, v100
    v_fmac_f32 v41, v120, v101
    v_fmac_f32 v42, v120, v102
    v_fmac_f32 v43, v120, v103
    v_fmac_f32 v44, v120, v104
    v_fmac_f32 v45, v120, v105
    v_fmac_f32 v46, v120, v106
    v_fmac_f32 v47, v120, v107
    v_fmac_f32 v48, v120, v108
    v_fmac_f32 v49, v120, v109
    v_fmac_f32 v50, v120, v110
    v_fmac_f32 v51, v120, v111
    v_fmac_f32 v52, v120, v112
    v_fmac_f32 v53, v120, v113
    v_fmac_f32 v54, v120, v114
    v_fmac_f32 v55, v120, v115
    v_fmac_f32 v56, v120, v116
    v_fmac_f32 v57, v120, v117
    ds_read_b128 v[100:103], v9 offset:880
    ds_read_b128 v[104:107], v9 offset:896
    ds_read_b128 v[108:111], v9 offset:912
    ds_read_b128 v[112:115], v9 offset:928
    ds_read_b64 v[116:117], v9 offset:944
    v_and_b32 v120, 0xffff0000, v21
    s_waitcnt lgkmcnt(0)
    v_fmac_f32 v40, v120, v100
    v_fmac_f32 v41, v120, v101
    v_fmac_f32 v42, v120, v102
    v_fmac_f32 v43, v120, v103
    v_fmac_f32 v44, v120, v104
    v_fmac_f32 v45, v120, v105
    v_fmac_f32 v46, v120, v106
    v_fmac_f32 v47, v120, v107
    v_fmac_f32 v48, v120, v108
    v_fmac_f32 v49, v120, v109
    v_fmac_f32 v50, v120, v110
    v_fmac_f32 v51, v120, v111
    v_fmac_f32 v52, v120, v112
    v_fmac_f32 v53, v120, v113
    v_fmac_f32 v54, v120, v114
    v_fmac_f32 v55, v120, v115
    v_fmac_f32 v56, v120, v116
    v_fmac_f32 v57, v120, v117
    ds_read_b128 v[100:103], v9 offset:960
    ds_read_b128 v[104:107], v9 offset:976
    ds_read_b128 v[108:111], v9 offset:992
    ds_read_b128 v[112:115], v9 offset:1008
    ds_read_b64 v[116:117], v9 offset:1024
    v_lshlrev_b32 v120, 16, v22
    s_waitcnt lgkmcnt(0)
    v_fmac_f32 v40, v120, v100
    v_fmac_f32 v41, v120, v101
    v_fmac_f32 v42, v120, v102
    v_fmac_f32 v43, v120, v103
    v_fmac_f32 v44, v120, v104
    v_fmac_f32 v45, v120, v105
    v_fmac_f32 v46, v120, v106
    v_fmac_f32 v47, v120, v107
    v_fmac_f32 v48, v120, v108
    v_fmac_f32 v49, v120, v109
    v_fmac_f32 v50, v120, v110
    v_fmac_f32 v51, v120, v111
    v_fmac_f32 v52, v120, v112
    v_fmac_f32 v53, v120, v113
    v_fmac_f32 v54, v120, v114
    v_fmac_f32 v55, v120, v115
    v_fmac_f32 v56, v120, v116
    v_fmac_f32 v57, v120, v117
    ds_read_b128 v[100:103], v9 offset:1040
    ds_read_b128 v[104:107], v9 offset:1056
    ds_read_b128 v[108:111], v9 offset:1072
    ds_read_b128 v[112:115], v9 offset:1088
    ds_read_b64 v[116:117], v9 offset:1104
    v_and_b32 v120, 0xffff0000, v22
    s_waitcnt lgkmcnt(0)
    v_fmac_f32 v40, v120, v100
    v_fmac_f32 v41, v120, v101
    v_fmac_f32 v42, v120, v102
    v_fmac_f32 v43, v120, v103
    v_fmac_f32 v44, v120, v104
    v_fmac_f32 v45, v120, v105
    v_fmac_f32 v46, v120, v106
    v_fmac_f32 v47, v120, v107
    v_fmac_f32 v48, v120, v108
    v_fmac_f32 v49, v120, v109
    v_fmac_f32 v50, v120, v110
    v_fmac_f32 v51, v120, v111
    v_fmac_f32 v52, v120, v112
    v_fmac_f32 v53, v120, v113
    v_fmac_f32 v54, v120, v114
    v_fmac_f32 v55, v120, v115
    v_fmac_f32 v56, v120, v116
    v_fmac_f32 v57, v120, v117
    ds_read_b128 v[100:103], v9 offset:1120
    ds_read_b128 v[104:107], v9 offset:1136
    ds_read_b128 v[108:111], v9 offset:1152
    ds_read_b128 v[112:115], v9 offset:1168
    ds_read_b64 v[116:117], v9 offset:1184
    v_lshlrev_b32 v120, 16, v23
    s_waitcnt lgkmcnt(0)
    v_fmac_f32 v40, v120, v100
    v_fmac_f32 v41, v120, v101
    v_fmac_f32 v42, v120, v102
    v_fmac_f32 v43, v120, v103
    v_fmac_f32 v44, v120, v104
    v_fmac_f32 v45, v120, v105
    v_fmac_f32 v46, v120, v106
    v_fmac_f32 v47, v120, v107
    v_fmac_f32 v48, v120, v108
    v_fmac_f32 v49, v120, v109
    v_fmac_f32 v50, v120, v110
    v_fmac_f32 v51, v120, v111
    v_fmac_f32 v52, v120, v112
    v_fmac_f32 v53, v120, v113
    v_fmac_f32 v54, v120, v114
    v_fmac_f32 v55, v120, v115
    v_fmac_f32 v56, v120, v116
    v_fmac_f32 v57, v120, v117
    ds_read_b128 v[100:103], v9 offset:1200
    ds_read_b128 v[104:107], v9 offset:1216
    ds_read_b128 v[108:111], v9 offset:1232
    ds_read_b128 v[112:115], v9 offset:1248
    ds_read_b64 v[116:117], v9 offset:1264
    v_and_b32 v120, 0xffff0000, v23
    s_waitcnt lgkmcnt(0)
    v_fmac_f32 v40, v120, v100
    v_fmac_f32 v41, v120, v101
    v_fmac_f32 v42, v120, v102
    v_fmac_f32 v43, v120, v103
    v_fmac_f32 v44, v120, v104
    v_fmac_f32 v45, v120, v105
    v_fmac_f32 v46, v120, v106
    v_fmac_f32 v47, v120, v107
    v_fmac_f32 v48, v120, v108
    v_fmac_f32 v49, v120, v109
    v_fmac_f32 v50, v120, v110
    v_fmac_f32 v51, v120, v111
    v_fmac_f32 v52, v120, v112
    v_fmac_f32 v53, v120, v113
    v_fmac_f32 v54, v120, v114
    v_fmac_f32 v55, v120, v115
    v_fmac_f32 v56, v120, v116
    v_fmac_f32 v57, v120, v117
    ds_read_b128 v[100:103], v9 offset:1280
    ds_read_b128 v[104:107], v9 offset:1296
    ds_read_b128 v[108:111], v9 offset:1312
    ds_read_b128 v[112:115], v9 offset:1328
    ds_read_b64 v[116:117], v9 offset:1344
    v_lshlrev_b32 v120, 16, v24
    s_waitcnt lgkmcnt(0)
    v_fmac_f32 v40, v120, v100
    v_fmac_f32 v41, v120, v101
    v_fmac_f32 v42, v120, v102
    v_fmac_f32 v43, v120, v103
    v_fmac_f32 v44, v120, v104
    v_fmac_f32 v45, v120, v105
    v_fmac_f32 v46, v120, v106
    v_fmac_f32 v47, v120, v107
    v_fmac_f32 v48, v120, v108
    v_fmac_f32 v49, v120, v109
    v_fmac_f32 v50, v120, v110
    v_fmac_f32 v51, v120, v111
    v_fmac_f32 v52, v120, v112
    v_fmac_f32 v53, v120, v113
    v_fmac_f32 v54, v120, v114
    v_fmac_f32 v55, v120, v115
    v_fmac_f32 v56, v120, v116
    v_fmac_f32 v57, v120, v117
    ds_read_b128 v[100:103], v9 offset:1360
    ds_read_b128 v[104:107], v9 offset:1376
    ds_read_b128 v[108:111], v9 offset:1392
    ds_read_b128 v[112:115], v9 offset:1408
    ds_read_b64 v[116:117], v9 offset:1424
    v_and_b32 v120, 0xffff0000, v24
    s_waitcnt lgkmcnt(0)
    v_fmac_f32 v40, v120, v100
    v_fmac_f32 v41, v120, v101
    v_fmac_f32 v42, v120, v102
    v_fmac_f32 v43, v120, v103
    v_fmac_f32 v44, v120, v104
    v_fmac_f32 v45, v120, v105
    v_fmac_f32 v46, v120, v106
    v_fmac_f32 v47, v120, v107
    v_fmac_f32 v48, v120, v108
    v_fmac_f32 v49, v120, v109
    v_fmac_f32 v50, v120, v110
    v_fmac_f32 v51, v120, v111
    v_fmac_f32 v52, v120, v112
    v_fmac_f32 v53, v120, v113
    v_fmac_f32 v54, v120, v114
    v_fmac_f32 v55, v120, v115
    v_fmac_f32 v56, v120, v116
    v_fmac_f32 v57, v120, v117
    v_cvt_pk_bf16_f32 v100, v40, v40
    v_lshlrev_b32 v40, 16, v100
    v_cvt_pk_bf16_f32 v100, v41, v41
    v_lshlrev_b32 v41, 16, v100
    v_cvt_pk_bf16_f32 v100, v42, v42
    v_lshlrev_b32 v42, 16, v100
    v_cvt_pk_bf16_f32 v100, v43, v43
    v_lshlrev_b32 v43, 16, v100
    v_cvt_pk_bf16_f32 v100, v44, v44
    v_lshlrev_b32 v44, 16, v100
    v_cvt_pk_bf16_f32 v100, v45, v45
    v_lshlrev_b32 v45, 16, v100
    v_cvt_pk_bf16_f32 v100, v46, v46
    v_lshlrev_b32 v46, 16, v100
    v_cvt_pk_bf16_f32 v100, v47, v47
    v_lshlrev_b32 v47, 16, v100
    v_cvt_pk_bf16_f32 v100, v48, v48
    v_lshlrev_b32 v48, 16, v100
    v_cvt_pk_bf16_f32 v100, v49, v49
    v_lshlrev_b32 v49, 16, v100
    v_cvt_pk_bf16_f32 v100, v50, v50
    v_lshlrev_b32 v50, 16, v100
    v_cvt_pk_bf16_f32 v100, v51, v51
    v_lshlrev_b32 v51, 16, v100
    v_cvt_pk_bf16_f32 v100, v52, v52
    v_lshlrev_b32 v52, 16, v100
    v_cvt_pk_bf16_f32 v100, v53, v53
    v_lshlrev_b32 v53, 16, v100
    v_cvt_pk_bf16_f32 v100, v54, v54
    v_lshlrev_b32 v54, 16, v100
    v_cvt_pk_bf16_f32 v100, v55, v55
    v_lshlrev_b32 v55, 16, v100
    v_cvt_pk_bf16_f32 v100, v56, v56
    v_lshlrev_b32 v56, 16, v100
    v_cvt_pk_bf16_f32 v100, v57, v57
    v_lshlrev_b32 v57, 16, v100
    v_max3_f32 v100, v40, v41, v42
    v_min3_f32 v101, v40, v41, v42
    v_max3_f32 v100, v100, v43, v44
    v_min3_f32 v101, v101, v43, v44
    v_max3_f32 v100, v100, v45, v46
    v_min3_f32 v101, v101, v45, v46
    v_max3_f32 v100, v100, v47, v48
    v_min3_f32 v101, v101, v47, v48
    v_max3_f32 v100, v100, v49, v50
    v_min3_f32 v101, v101, v49, v50
    v_max3_f32 v100, v100, v51, v52
    v_min3_f32 v101, v101, v51, v52
    v_max3_f32 v100, v100, v53, v54
    v_min3_f32 v101, v101, v53, v54
    v_max3_f32 v100, v100, v55, v56
    v_min3_f32 v101, v101, v55, v56
    v_max_f32 v100, v100, v57
    v_min_f32 v101, v101, v57
    v_sub_f32 v60, v40, v100
    v_sub_f32 v78, v101, v40
    v_sub_f32 v61, v41, v100
    v_sub_f32 v79, v101, v41
    v_sub_f32 v62, v42, v100
    v_sub_f32 v80, v101, v42
    v_sub_f32 v63, v43, v100
    v_sub_f32 v81, v101, v43
    v_sub_f32 v64, v44, v100
    v_sub_f32 v82, v101, v44
    v_sub_f32 v65, v45, v100
    v_sub_f32 v83, v101, v45
    v_sub_f32 v66, v46, v100
    v_sub_f32 v84, v101, v46
    v_sub_f32 v67, v47, v100
    v_sub_f32 v85, v101, v47
    v_sub_f32 v68, v48, v100
    v_sub_f32 v86, v101, v48
    v_sub_f32 v69, v49, v100
    v_sub_f32 v87, v101, v49
    v_sub_f32 v70, v50, v100
    v_sub_f32 v88, v101, v50
    v_sub_f32 v71, v51, v100
    v_sub_f32 v89, v101, v51
    v_sub_f32 v72, v52, v100
    v_sub_f32 v90, v101, v52
    v_sub_f32 v73, v53, v100
    v_sub_f32 v91, v101, v53
    v_sub_f32 v74, v54, v100
    v_sub_f32 v92, v101, v54
    v_sub_f32 v75, v55, v100
    v_sub_f32 v93, v101, v55
    v_sub_f32 v76, v56, v100
    v_sub_f32 v94, v101, v56
    v_sub_f32 v77, v57, v100
    v_sub_f32 v95, v101, v57
    v_mul_f32 v60, 0x3fb8aa3b, v60
    v_mul_f32 v61, 0x3fb8aa3b, v61
    v_mul_f32 v62, 0x3fb8aa3b, v62
    v_mul_f32 v63, 0x3fb8aa3b, v63
    v_mul_f32 v64, 0x3fb8aa3b, v64
    v_mul_f32 v65, 0x3fb8aa3b, v65
    v_mul_f32 v66, 0x3fb8aa3b, v66
    v_mul_f32 v67, 0x3fb8aa3b, v67
    v_mul_f32 v68, 0x3fb8aa3b, v68
    v_mul_f32 v69, 0x3fb8aa3b, v69
    v_mul_f32 v70, 0x3fb8aa3b, v70
    v_mul_f32 v71, 0x3fb8aa3b, v71
    v_mul_f32 v72, 0x3fb8aa3b, v72
    v_mul_f32 v73, 0x3fb8aa3b, v73
    v_mul_f32 v74, 0x3fb8aa3b, v74
    v_mul_f32 v75, 0x3fb8aa3b, v75
    v_mul_f32 v76, 0x3fb8aa3b, v76
    v_mul_f32 v77, 0x3fb8aa3b, v77
    v_mul_f32 v78, 0x3fb8aa3b, v78
    v_mul_f32 v79, 0x3fb8aa3b, v79
    v_mul_f32 v80, 0x3fb8aa3b, v80
    v_mul_f32 v81, 0x3fb8aa3b, v81
    v_mul_f32 v82, 0x3fb8aa3b, v82
    v_mul_f32 v83, 0x3fb8aa3b, v83
    v_mul_f32 v84, 0x3fb8aa3b, v84
    v_mul_f32 v85, 0x3fb8aa3b, v85
    v_mul_f32 v86, 0x3fb8aa3b, v86
    v_mul_f32 v87, 0x3fb8aa3b, v87
    v_mul_f32 v88, 0x3fb8aa3b, v88
    v_mul_f32 v89, 0x3fb8aa3b, v89
    v_mul_f32 v90, 0x3fb8aa3b, v90
    v_mul_f32 v91, 0x3fb8aa3b, v91
    v_mul_f32 v92, 0x3fb8aa3b, v92
    v_mul_f32 v93, 0x3fb8aa3b, v93
    v_mul_f32 v94, 0x3fb8aa3b, v94
    v_mul_f32 v95, 0x3fb8aa3b, v95
    v_exp_f32 v60, v60
    v_exp_f32 v61, v61
    v_exp_f32 v62, v62
    v_exp_f32 v63, v63
    v_exp_f32 v64, v64
    v_exp_f32 v65, v65
    v_exp_f32 v66, v66
    v_exp_f32 v67, v67
    v_exp_f32 v68, v68
    v_exp_f32 v69, v69
    v_exp_f32 v70, v70
    v_exp_f32 v71, v71
    v_exp_f32 v72, v72
    v_exp_f32 v73, v73
    v_exp_f32 v74, v74
    v_exp_f32 v75, v75
    v_exp_f32 v76, v76
    v_exp_f32 v77, v77
    v_exp_f32 v78, v78
    v_exp_f32 v79, v79
    v_exp_f32 v80, v80
    v_exp_f32 v81, v81
    v_exp_f32 v82, v82
    v_exp_f32 v83, v83
    v_exp_f32 v84, v84
    v_exp_f32 v85, v85
    v_exp_f32 v86, v86
    v_exp_f32 v87, v87
    v_exp_f32 v88, v88
    v_exp_f32 v89, v89
    v_exp_f32 v90, v90
    v_exp_f32 v91, v91
    v_exp_f32 v92, v92
    v_exp_f32 v93, v93
    v_exp_f32 v94, v94
    v_exp_f32 v95, v95
    v_add_f32 v102, v60, v61
    v_add_f32 v102, v102, v62
    v_add_f32 v102, v102, v63
    v_add_f32 v102, v102, v64
    v_add_f32 v102, v102, v65
    v_add_f32 v102, v102, v66
    v_add_f32 v102, v102, v67
    v_add_f32 v102, v102, v68
    v_add_f32 v102, v102, v69
    v_add_f32 v102, v102, v70
    v_add_f32 v102, v102, v71
    v_add_f32 v102, v102, v72
    v_add_f32 v102, v102, v73
    v_add_f32 v102, v102, v74
    v_add_f32 v102, v102, v75
    v_add_f32 v102, v102, v76
    v_add_f32 v102, v102, v77
    v_rcp_f32 v102, v102
    v_add_f32 v103, v78, v79
    v_add_f32 v103, v103, v80
    v_add_f32 v103, v103, v81
    v_add_f32 v103, v103, v82
    v_add_f32 v103, v103, v83
    v_add_f32 v103, v103, v84
    v_add_f32 v103, v103, v85
    v_add_f32 v103, v103, v86
    v_add_f32 v103, v103, v87
    v_add_f32 v103, v103, v88
    v_add_f32 v103, v103, v89
    v_add_f32 v103, v103, v90
    v_add_f32 v103, v103, v91
    v_add_f32 v103, v103, v92
    v_add_f32 v103, v103, v93
    v_add_f32 v103, v103, v94
    v_add_f32 v103, v103, v95
    v_rcp_f32 v103, v103
    s_nop 0
    v_mul_f32 v60, v60, v102
    v_mul_f32 v61, v61, v102
    v_mul_f32 v62, v62, v102
    v_mul_f32 v63, v63, v102
    v_mul_f32 v64, v64, v102
    v_mul_f32 v65, v65, v102
    v_mul_f32 v66, v66, v102
    v_mul_f32 v67, v67, v102
    v_mul_f32 v68, v68, v102
    v_mul_f32 v69, v69, v102
    v_mul_f32 v70, v70, v102
    v_mul_f32 v71, v71, v102
    v_mul_f32 v72, v72, v102
    v_mul_f32 v73, v73, v102
    v_mul_f32 v74, v74, v102
    v_mul_f32 v75, v75, v102
    v_mul_f32 v76, v76, v102
    v_mul_f32 v77, v77, v102
    v_mul_f32 v78, v78, v103
    v_mul_f32 v79, v79, v103
    v_mul_f32 v80, v80, v103
    v_mul_f32 v81, v81, v103
    v_mul_f32 v82, v82, v103
    v_mul_f32 v83, v83, v103
    v_mul_f32 v84, v84, v103
    v_mul_f32 v85, v85, v103
    v_mul_f32 v86, v86, v103
    v_mul_f32 v87, v87, v103
    v_mul_f32 v88, v88, v103
    v_mul_f32 v89, v89, v103
    v_mul_f32 v90, v90, v103
    v_mul_f32 v91, v91, v103
    v_mul_f32 v92, v92, v103
    v_mul_f32 v93, v93, v103
    v_mul_f32 v94, v94, v103
    v_mul_f32 v95, v95, v103
    v_cvt_pk_bf16_f32 v100, v60, v60
    v_lshlrev_b32 v60, 16, v100
    v_cvt_pk_bf16_f32 v100, v61, v61
    v_lshlrev_b32 v61, 16, v100
    v_cvt_pk_bf16_f32 v100, v62, v62
    v_lshlrev_b32 v62, 16, v100
    v_cvt_pk_bf16_f32 v100, v63, v63
    v_lshlrev_b32 v63, 16, v100
    v_cvt_pk_bf16_f32 v100, v64, v64
    v_lshlrev_b32 v64, 16, v100
    v_cvt_pk_bf16_f32 v100, v65, v65
    v_lshlrev_b32 v65, 16, v100
    v_cvt_pk_bf16_f32 v100, v66, v66
    v_lshlrev_b32 v66, 16, v100
    v_cvt_pk_bf16_f32 v100, v67, v67
    v_lshlrev_b32 v67, 16, v100
    v_cvt_pk_bf16_f32 v100, v68, v68
    v_lshlrev_b32 v68, 16, v100
    v_cvt_pk_bf16_f32 v100, v69, v69
    v_lshlrev_b32 v69, 16, v100
    v_cvt_pk_bf16_f32 v100, v70, v70
    v_lshlrev_b32 v70, 16, v100
    v_cvt_pk_bf16_f32 v100, v71, v71
    v_lshlrev_b32 v71, 16, v100
    v_cvt_pk_bf16_f32 v100, v72, v72
    v_lshlrev_b32 v72, 16, v100
    v_cvt_pk_bf16_f32 v100, v73, v73
    v_lshlrev_b32 v73, 16, v100
    v_cvt_pk_bf16_f32 v100, v74, v74
    v_lshlrev_b32 v74, 16, v100
    v_cvt_pk_bf16_f32 v100, v75, v75
    v_lshlrev_b32 v75, 16, v100
    v_cvt_pk_bf16_f32 v100, v76, v76
    v_lshlrev_b32 v76, 16, v100
    v_cvt_pk_bf16_f32 v100, v77, v77
    v_lshlrev_b32 v77, 16, v100
    v_cvt_pk_bf16_f32 v100, v78, v78
    v_lshlrev_b32 v78, 16, v100
    v_cvt_pk_bf16_f32 v100, v79, v79
    v_lshlrev_b32 v79, 16, v100
    v_cvt_pk_bf16_f32 v100, v80, v80
    v_lshlrev_b32 v80, 16, v100
    v_cvt_pk_bf16_f32 v100, v81, v81
    v_lshlrev_b32 v81, 16, v100
    v_cvt_pk_bf16_f32 v100, v82, v82
    v_lshlrev_b32 v82, 16, v100
    v_cvt_pk_bf16_f32 v100, v83, v83
    v_lshlrev_b32 v83, 16, v100
    v_cvt_pk_bf16_f32 v100, v84, v84
    v_lshlrev_b32 v84, 16, v100
    v_cvt_pk_bf16_f32 v100, v85, v85
    v_lshlrev_b32 v85, 16, v100
    v_cvt_pk_bf16_f32 v100, v86, v86
    v_lshlrev_b32 v86, 16, v100
    v_cvt_pk_bf16_f32 v100, v87, v87
    v_lshlrev_b32 v87, 16, v100
    v_cvt_pk_bf16_f32 v100, v88, v88
    v_lshlrev_b32 v88, 16, v100
    v_cvt_pk_bf16_f32 v100, v89, v89
    v_lshlrev_b32 v89, 16, v100
    v_cvt_pk_bf16_f32 v100, v90, v90
    v_lshlrev_b32 v90, 16, v100
    v_cvt_pk_bf16_f32 v100, v91, v91
    v_lshlrev_b32 v91, 16, v100
    v_cvt_pk_bf16_f32 v100, v92, v92
    v_lshlrev_b32 v92, 16, v100
    v_cvt_pk_bf16_f32 v100, v93, v93
    v_lshlrev_b32 v93, 16, v100
    v_cvt_pk_bf16_f32 v100, v94, v94
    v_lshlrev_b32 v94, 16, v100
    v_cvt_pk_bf16_f32 v100, v95, v95
    v_lshlrev_b32 v95, 16, v100
    v_lshlrev_b32 v1, 1, v0
    ds_write_b16_d16_hi v1, v60 offset:2048
    ds_write_b16_d16_hi v1, v61 offset:2576
    ds_write_b16_d16_hi v1, v62 offset:3104
    ds_write_b16_d16_hi v1, v63 offset:3632
    ds_write_b16_d16_hi v1, v64 offset:4160
    ds_write_b16_d16_hi v1, v65 offset:4688
    ds_write_b16_d16_hi v1, v66 offset:5216
    ds_write_b16_d16_hi v1, v67 offset:5744
    ds_write_b16_d16_hi v1, v68 offset:6272
    ds_write_b16_d16_hi v1, v69 offset:6800
    ds_write_b16_d16_hi v1, v70 offset:7328
    ds_write_b16_d16_hi v1, v71 offset:7856
    ds_write_b16_d16_hi v1, v72 offset:8384
    ds_write_b16_d16_hi v1, v73 offset:8912
    ds_write_b16_d16_hi v1, v74 offset:9440
    ds_write_b16_d16_hi v1, v75 offset:9968
    ds_write_b16_d16_hi v1, v76 offset:10496
    ds_write_b16_d16_hi v1, v77 offset:11024
    ds_write_b16_d16_hi v1, v78 offset:11552
    ds_write_b16_d16_hi v1, v79 offset:12080
    ds_write_b16_d16_hi v1, v80 offset:12608
    ds_write_b16_d16_hi v1, v81 offset:13136
    ds_write_b16_d16_hi v1, v82 offset:13664
    ds_write_b16_d16_hi v1, v83 offset:14192
    ds_write_b16_d16_hi v1, v84 offset:14720
    ds_write_b16_d16_hi v1, v85 offset:15248
    ds_write_b16_d16_hi v1, v86 offset:15776
    ds_write_b16_d16_hi v1, v87 offset:16304
    ds_write_b16_d16_hi v1, v88 offset:16832
    ds_write_b16_d16_hi v1, v89 offset:17360
    ds_write_b16_d16_hi v1, v90 offset:17888
    ds_write_b16_d16_hi v1, v91 offset:18416
    ds_write_b16_d16_hi v1, v92 offset:18944
    ds_write_b16_d16_hi v1, v93 offset:19472
    ds_write_b16_d16_hi v1, v94 offset:20000
    ds_write_b16_d16_hi v1, v95 offset:20528
    ds_write_b16 v1, v26 offset:27392
    ds_write_b16_d16_hi v1, v26 offset:27920
    ds_write_b16 v1, v27 offset:28448
    ds_write_b16_d16_hi v1, v27 offset:28976
    ds_write_b16 v1, v28 offset:29504
    ds_write_b16_d16_hi v1, v28 offset:30032
    ds_write_b16 v1, v29 offset:30560
    ds_write_b16_d16_hi v1, v29 offset:31088
    ds_write_b16 v1, v30 offset:31616
    ds_write_b16_d16_hi v1, v30 offset:32144
    ds_write_b16 v1, v31 offset:32672
    ds_write_b16_d16_hi v1, v31 offset:33200
    ds_write_b16 v1, v32 offset:33728
    ds_write_b16_d16_hi v1, v32 offset:34256
    ds_write_b16 v1, v33 offset:34784
    ds_write_b16_d16_hi v1, v33 offset:35312
    ds_write_b16 v1, v34 offset:35840
    ds_write_b16_d16_hi v1, v34 offset:36368
    v_mov_b32 v2, 0x3f80
    ds_write_b16 v1, v2 offset:36896
    s_waitcnt lgkmcnt(0)
    s_barrier
    v_and_b32 v1, 63, v0
    v_lshrrev_b32 v2, 6, v0
    v_and_b32 v3, 15, v1
    v_lshrrev_b32 v4, 4, v1
    v_mul_u32_u24 v5, 528, v3
    v_lshlrev_b32 v6, 7, v2
    v_add_u32 v5, v5, v6
    v_lshl_add_u32 v5, v4, 4, v5
    v_mov_b32 v40, 0
    v_mov_b32 v41, 0
    v_mov_b32 v42, 0
    v_mov_b32 v43, 0
    v_mov_b32 v44, 0
    v_mov_b32 v45, 0
    v_mov_b32 v46, 0
    v_mov_b32 v47, 0
    v_mov_b32 v48, 0
    v_mov_b32 v49, 0
    v_mov_b32 v50, 0
    v_mov_b32 v51, 0
    v_mov_b32 v52, 0
    v_mov_b32 v53, 0
    v_mov_b32 v54, 0
    v_mov_b32 v55, 0
    v_mov_b32 v56, 0
    v_mov_b32 v57, 0
    v_mov_b32 v58, 0
    v_mov_b32 v59, 0
    v_mov_b32 v60, 0
    v_mov_b32 v61, 0
    v_mov_b32 v62, 0
    v_mov_b32 v63, 0
    ds_read_b128 v[64:67], v5 offset:2048
    ds_read_b128 v[68:71], v5 offset:10496
    ds_read_b128 v[72:75], v5 offset:18944
    ds_read_b128 v[76:79], v5 offset:27392
    ds_read_b128 v[80:83], v5 offset:35840
    s_waitcnt lgkmcnt(0)
    v_mfma_f32_16x16x32_bf16 v[40:43], v[64:67], v[76:79], v[40:43]
    v_mfma_f32_16x16x32_bf16 v[44:47], v[64:67], v[80:83], v[44:47]
    v_mfma_f32_16x16x32_bf16 v[48:51], v[68:71], v[76:79], v[48:51]
    v_mfma_f32_16x16x32_bf16 v[52:55], v[68:71], v[80:83], v[52:55]
    v_mfma_f32_16x16x32_bf16 v[56:59], v[72:75], v[76:79], v[56:59]
    v_mfma_f32_16x16x32_bf16 v[60:63], v[72:75], v[80:83], v[60:63]
    ds_read_b128 v[64:67], v5 offset:2112
    ds_read_b128 v[68:71], v5 offset:10560
    ds_read_b128 v[72:75], v5 offset:19008
    ds_read_b128 v[76:79], v5 offset:27456
    ds_read_b128 v[80:83], v5 offset:35904
    s_waitcnt lgkmcnt(0)
    v_mfma_f32_16x16x32_bf16 v[40:43], v[64:67], v[76:79], v[40:43]
    v_mfma_f32_16x16x32_bf16 v[44:47], v[64:67], v[80:83], v[44:47]
    v_mfma_f32_16x16x32_bf16 v[48:51], v[68:71], v[76:79], v[48:51]
    v_mfma_f32_16x16x32_bf16 v[52:55], v[68:71], v[80:83], v[52:55]
    v_mfma_f32_16x16x32_bf16 v[56:59], v[72:75], v[76:79], v[56:59]
    v_mfma_f32_16x16x32_bf16 v[60:63], v[72:75], v[80:83], v[60:63]
    s_nop 15
    s_barrier
    v_lshlrev_b32 v5, 4, v1
    v_mul_u32_u24 v6, 6144, v2
    v_add_u32 v5, v5, v6
    ds_write_b128 v5, v[40:43] offset:2048
    ds_write_b128 v5, v[44:47] offset:3072
    ds_write_b128 v5, v[48:51] offset:4096
    ds_write_b128 v5, v[52:55] offset:5120
    ds_write_b128 v5, v[56:59] offset:6144
    ds_write_b128 v5, v[60:63] offset:7168
    s_waitcnt lgkmcnt(0)
    s_barrier
    v_lshlrev_b32 v5, 2, v0
    ds_read_b32 v64, v5 offset:2048
    ds_read_b32 v65, v5 offset:8192
    ds_read_b32 v66, v5 offset:14336
    ds_read_b32 v67, v5 offset:20480
    ds_read_b32 v68, v5 offset:3072
    ds_read_b32 v69, v5 offset:9216
    ds_read_b32 v70, v5 offset:15360
    ds_read_b32 v71, v5 offset:21504
    ds_read_b32 v72, v5 offset:4096
    ds_read_b32 v73, v5 offset:10240
    ds_read_b32 v74, v5 offset:16384
    ds_read_b32 v75, v5 offset:22528
    ds_read_b32 v76, v5 offset:5120
    ds_read_b32 v77, v5 offset:11264
    ds_read_b32 v78, v5 offset:17408
    ds_read_b32 v79, v5 offset:23552
    ds_read_b32 v80, v5 offset:6144
    ds_read_b32 v81, v5 offset:12288
    ds_read_b32 v82, v5 offset:18432
    ds_read_b32 v83, v5 offset:24576
    ds_read_b32 v84, v5 offset:7168
    ds_read_b32 v85, v5 offset:13312
    ds_read_b32 v86, v5 offset:19456
    ds_read_b32 v87, v5 offset:25600
    s_waitcnt lgkmcnt(0)
    v_add_f32 v64, v64, v65
    v_add_f32 v66, v66, v67
    v_add_f32 v64, v64, v66
    v_add_f32 v68, v68, v69
    v_add_f32 v70, v70, v71
    v_add_f32 v68, v68, v70
    v_add_f32 v72, v72, v73
    v_add_f32 v74, v74, v75
    v_add_f32 v72, v72, v74
    v_add_f32 v76, v76, v77
    v_add_f32 v78, v78, v79
    v_add_f32 v76, v76, v78
    v_add_f32 v80, v80, v81
    v_add_f32 v82, v82, v83
    v_add_f32 v80, v80, v82
    v_add_f32 v84, v84, v85
    v_add_f32 v86, v86, v87
    v_add_f32 v84, v84, v86
    s_add_u32 s16, s6, 83886080
    s_addc_u32 s17, s7, 0
    s_mov_b32 s18, 1572864
    s_mov_b32 s19, 0x00020000
    s_mul_i32 s24, s2, 6144
    s_add_u32 s25, s24, 4096
    buffer_store_dword v64, v5, s[16:19], s24 offen offset:0
    buffer_store_dword v68, v5, s[16:19], s24 offen offset:1024
    buffer_store_dword v72, v5, s[16:19], s24 offen offset:2048
    buffer_store_dword v76, v5, s[16:19], s24 offen offset:3072
    buffer_store_dword v80, v5, s[16:19], s25 offen offset:0
    buffer_store_dword v84, v5, s[16:19], s25 offen offset:1024
L_k_attn1_end:
    s_endpgm
L_k_l3_kernel_roleB:
    s_sub_u32 s2, s2, 256
    s_cmp_ge_u32 s2, 512
    s_cbranch_scc1 L_k_ffn1_end
    s_load_dwordx2 s[4:5], s[0:1], 88
    s_load_dwordx2 s[6:7], s[0:1], 40
    s_load_dwordx2 s[16:17], s[0:1], 88
    s_and_b32 s20, s2, 15
    s_lshr_b32 s21, s2, 4
    s_mov_b32 s22, s21
    s_mov_b32 s23, 0
    v_and_b32 v1, 63, v0
    v_lshrrev_b32 v2, 6, v0
    v_and_b32 v3, 15, v1
    v_lshrrev_b32 v4, 4, v1
    s_mul_i32 s24, s20, 128
    v_mul_u32_u24 v5, 32, v2
    v_add_u32 v5, v5, v3
    v_add_u32 v5, s24, v5
    v_add_u32 v6, 0, v5
    s_mov_b32 s25, 1152
    v_mul_lo_u32 v6, v6, s25
    v_lshlrev_b32 v7, 4, v4
    v_add_u32 v10, v6, v7
    v_add_u32 v6, 16, v5
    s_mov_b32 s25, 1152
    v_mul_lo_u32 v6, v6, s25
    v_lshlrev_b32 v7, 4, v4
    v_add_u32 v11, v6, v7
    v_add_u32 v6, 0, v0
    s_mov_b32 s25, 0x71c71c8
    v_mul_hi_u32 v7, v6, s25
    v_mul_u32_u24 v8, 36, v7
    v_sub_u32 v8, v6, v8
    s_mov_b32 s25, 9216
    v_mul_lo_u32 v9, v7, s25
    v_lshl_add_u32 v12, v8, 3, v9
    v_lshrrev_b32 v9, 3, v7
    v_mul_u32_u24 v9, 2432, v9
    v_and_b32 v6, 7, v7
    v_mul_u32_u24 v6, 288, v6
    v_add_u32 v9, v9, v6
    v_lshl_add_u32 v21, v8, 3, v9
    v_add_u32 v6, 256, v0
    s_mov_b32 s25, 0x71c71c8
    v_mul_hi_u32 v7, v6, s25
    v_mul_u32_u24 v8, 36, v7
    v_sub_u32 v8, v6, v8
    s_mov_b32 s25, 9216
    v_mul_lo_u32 v9, v7, s25
    v_lshl_add_u32 v13, v8, 3, v9
    v_lshrrev_b32 v9, 3, v7
    v_mul_u32_u24 v9, 2432, v9
    v_and_b32 v6, 7, v7
    v_mul_u32_u24 v6, 288, v6
    v_add_u32 v9, v9, v6
    v_lshl_add_u32 v22, v8, 3, v9
    v_add_u32 v6, 512, v0
    s_mov_b32 s25, 0x71c71c8
    v_mul_hi_u32 v7, v6, s25
    v_mul_u32_u24 v8, 36, v7
    v_sub_u32 v8, v6, v8
    s_mov_b32 s25, 9216
    v_mul_lo_u32 v9, v7, s25
    v_lshl_add_u32 v14, v8, 3, v9
    v_lshrrev_b32 v9, 3, v7
    v_mul_u32_u24 v9, 2432, v9
    v_and_b32 v6, 7, v7
    v_mul_u32_u24 v6, 288, v6
    v_add_u32 v9, v9, v6
    v_lshl_add_u32 v23, v8, 3, v9
    v_add_u32 v6, 768, v0
    s_mov_b32 s25, 0x71c71c8
    v_mul_hi_u32 v7, v6, s25
    v_mul_u32_u24 v8, 36, v7
    v_sub_u32 v8, v6, v8
    s_mov_b32 s25, 9216
    v_mul_lo_u32 v9, v7, s25
    v_lshl_add_u32 v15, v8, 3, v9
    v_lshrrev_b32 v9, 3, v7
    v_mul_u32_u24 v9, 2432, v9
    v_and_b32 v6, 7, v7
    v_mul_u32_u24 v6, 288, v6
    v_add_u32 v9, v9, v6
    v_lshl_add_u32 v24, v8, 3, v9
    v_add_u32 v6, 1024, v0
    s_mov_b32 s25, 0x71c71c8
    v_mul_hi_u32 v7, v6, s25
    v_mul_u32_u24 v8, 36, v7
    v_sub_u32 v8, v6, v8
    s_mov_b32 s25, 9216
    v_mul_lo_u32 v9, v7, s25
    v_lshl_add_u32 v16, v8, 3, v9
    v_lshrrev_b32 v9, 3, v7
    v_mul_u32_u24 v9, 2432, v9
    v_and_b32 v6, 7, v7
    v_mul_u32_u24 v6, 288, v6
    v_add_u32 v9, v9, v6
    v_lshl_add_u32 v25, v8, 3, v9
    v_add_u32 v6, 1280, v0
    s_mov_b32 s25, 0x71c71c8
    v_mul_hi_u32 v7, v6, s25
    v_mul_u32_u24 v8, 36, v7
    v_sub_u32 v8, v6, v8
    s_mov_b32 s25, 9216
    v_mul_lo_u32 v9, v7, s25
    v_lshl_add_u32 v17, v8, 3, v9
    v_lshrrev_b32 v9, 3, v7
    v_mul_u32_u24 v9, 2432, v9
    v_and_b32 v6, 7, v7
    v_mul_u32_u24 v6, 288, v6
    v_add_u32 v9, v9, v6
    v_lshl_add_u32 v26, v8, 3, v9
    v_add_u32 v6, 1536, v0
    s_mov_b32 s25, 0x71c71c8
    v_mul_hi_u32 v7, v6, s25
    v_mul_u32_u24 v8, 36, v7
    v_sub_u32 v8, v6, v8
    s_mov_b32 s25, 9216
    v_mul_lo_u32 v9, v7, s25
    v_lshl_add_u32 v18, v8, 3, v9
    v_lshrrev_b32 v9, 3, v7
    v_mul_u32_u24 v9, 2432, v9
    v_and_b32 v6, 7, v7
    v_mul_u32_u24 v6, 288, v6
    v_add_u32 v9, v9, v6
    v_lshl_add_u32 v27, v8, 3, v9
    v_add_u32 v6, 1792, v0
    s_mov_b32 s25, 0x71c71c8
    v_mul_hi_u32 v7, v6, s25
    v_mul_u32_u24 v8, 36, v7
    v_sub_u32 v8, v6, v8
    s_mov_b32 s25, 9216
    v_mul_lo_u32 v9, v7, s25
    v_lshl_add_u32 v19, v8, 3, v9
    v_lshrrev_b32 v9, 3, v7
    v_mul_u32_u24 v9, 2432, v9
    v_and_b32 v6, 7, v7
    v_mul_u32_u24 v6, 288, v6
    v_add_u32 v9, v9, v6
    v_lshl_add_u32 v28, v8, 3, v9
    v_add_u32 v6, 2048, v0
    s_mov_b32 s25, 0x71c71c8
    v_mul_hi_u32 v7, v6, s25
    v_mul_u32_u24 v8, 36, v7
    v_sub_u32 v8, v6, v8
    s_mov_b32 s25, 9216
    v_mul_lo_u32 v9, v7, s25
    v_lshl_add_u32 v20, v8, 3, v9
    v_lshrrev_b32 v9, 3, v7
    v_mul_u32_u24 v9, 2432, v9
    v_and_b32 v6, 7, v7
    v_mul_u32_u24 v6, 288, v6
    v_add_u32 v9, v9, v6
    v_lshl_add_u32 v29, v8, 3, v9
    v_mul_u32_u24 v30, 2432, v4
    v_lshrrev_b32 v6, 2, v3
    v_mul_u32_u24 v6, 288, v6
    v_add_u32 v30, v30, v6
    v_and_b32 v6, 3, v1
    v_lshl_add_u32 v30, v6, 3, v30
    s_waitcnt lgkmcnt(0)
    s_mov_b32 s8, s4
    s_mov_b32 s9, s5
    s_mov_b32 s10, 2359296
    s_mov_b32 s11, 0x00020000
    s_mul_i32 s26, s22, 288
    s_add_u32 s12, s6, s26
    s_addc_u32 s13, s7, 0
    s_sub_u32 s14, 5308416, s26
    s_mov_b32 s15, 0x00020000
    s_mul_i32 s27, s23, 1152
    s_mul_i32 s28, s23, 5308416
    v_mov_b32 v156, 0
    v_mov_b32 v157, 0
    v_mov_b32 v158, 0
    v_mov_b32 v159, 0
    v_mov_b32 v160, 0
    v_mov_b32 v161, 0
    v_mov_b32 v162, 0
    v_mov_b32 v163, 0
    v_mov_b32 v164, 0
    v_mov_b32 v165, 0
    v_mov_b32 v166, 0
    v_mov_b32 v167, 0
    v_mov_b32 v168, 0
    v_mov_b32 v169, 0
    v_mov_b32 v170, 0
    v_mov_b32 v171, 0
    v_mov_b32 v172, 0
    v_mov_b32 v173, 0
    v_mov_b32 v174, 0
    v_mov_b32 v175, 0
    v_mov_b32 v176, 0
    v_mov_b32 v177, 0
    v_mov_b32 v178, 0
    v_mov_b32 v179, 0
    v_mov_b32 v180, 0
    v_mov_b32 v181, 0
    v_mov_b32 v182, 0
    v_mov_b32 v183, 0
    v_mov_b32 v184, 0
    v_mov_b32 v185, 0
    v_mov_b32 v186, 0
    v_mov_b32 v187, 0
    v_mov_b32 v188, 0
    v_mov_b32 v189, 0
    v_mov_b32 v190, 0
    v_mov_b32 v191, 0
    v_mov_b32 v192, 0
    v_mov_b32 v193, 0
    v_mov_b32 v194, 0
    v_mov_b32 v195, 0
    v_mov_b32 v196, 0
    v_mov_b32 v197, 0
    v_mov_b32 v198, 0
    v_mov_b32 v199, 0
    v_mov_b32 v200, 0
    v_mov_b32 v201, 0
    v_mov_b32 v202, 0
    v_mov_b32 v203, 0
    v_mov_b32 v204, 0
    v_mov_b32 v205, 0
    v_mov_b32 v206, 0
    v_mov_b32 v207, 0
    v_mov_b32 v208, 0
    v_mov_b32 v209, 0
    v_mov_b32 v210, 0
    v_mov_b32 v211, 0
    v_mov_b32 v212, 0
    v_mov_b32 v213, 0
    v_mov_b32 v214, 0
    v_mov_b32 v215, 0
    v_mov_b32 v216, 0
    v_mov_b32 v217, 0
    v_mov_b32 v218, 0
    v_mov_b32 v219, 0
    v_mov_b32 v220, 0
    v_mov_b32 v221, 0
    v_mov_b32 v222, 0
    v_mov_b32 v223, 0
    v_mov_b32 v224, 0
    v_mov_b32 v225, 0
    v_mov_b32 v226, 0
    v_mov_b32 v227, 0
    s_add_u32 s29, s28, 0
    buffer_load_dwordx2 v[80:81], v12, s[12:15], s29 offen
    buffer_load_dwordx2 v[82:83], v13, s[12:15], s29 offen
    buffer_load_dwordx2 v[84:85], v14, s[12:15], s29 offen
    buffer_load_dwordx2 v[86:87], v15, s[12:15], s29 offen
    buffer_load_dwordx2 v[88:89], v16, s[12:15], s29 offen
    buffer_load_dwordx2 v[90:91], v17, s[12:15], s29 offen
    buffer_load_dwordx2 v[92:93], v18, s[12:15], s29 offen
    buffer_load_dwordx2 v[94:95], v19, s[12:15], s29 offen
    buffer_load_dwordx2 v[96:97], v20, s[12:15], s29 offen
    s_add_u32 s30, s27, 0
    buffer_load_dwordx4 v[32:35], v10, s[8:11], s30 offen offset:0
    buffer_load_dwordx4 v[36:39], v10, s[8:11], s30 offen offset:64
    buffer_load_dwordx4 v[40:43], v11, s[8:11], s30 offen offset:0
    buffer_load_dwordx4 v[44:47], v11, s[8:11], s30 offen offset:64
    s_add_u32 s29, s28, 589824
    buffer_load_dwordx2 v[98:99], v12, s[12:15], s29 offen
    buffer_load_dwordx2 v[100:101], v13, s[12:15], s29 offen
    buffer_load_dwordx2 v[102:103], v14, s[12:15], s29 offen
    buffer_load_dwordx2 v[104:105], v15, s[12:15], s29 offen
    buffer_load_dwordx2 v[106:107], v16, s[12:15], s29 offen
    buffer_load_dwordx2 v[108:109], v17, s[12:15], s29 offen
    buffer_load_dwordx2 v[110:111], v18, s[12:15], s29 offen
    buffer_load_dwordx2 v[112:113], v19, s[12:15], s29 offen
    buffer_load_dwordx2 v[114:115], v20, s[12:15], s29 offen
    s_add_u32 s30, s27, 128
    buffer_load_dwordx4 v[48:51], v10, s[8:11], s30 offen offset:0
    buffer_load_dwordx4 v[52:55], v10, s[8:11], s30 offen offset:64
    buffer_load_dwordx4 v[56:59], v11, s[8:11], s30 offen offset:0
    buffer_load_dwordx4 v[60:63], v11, s[8:11], s30 offen offset:64
    s_waitcnt vmcnt(17)
    ds_write_b64 v21, v[80:81] offset:0
    ds_write_b64 v22, v[82:83] offset:0
    ds_write_b64 v23, v[84:85] offset:0
    ds_write_b64 v24, v[86:87] offset:0
    ds_write_b64 v25, v[88:89] offset:0
    ds_write_b64 v26, v[90:91] offset:0
    ds_write_b64 v27, v[92:93] offset:0
    ds_write_b64 v28, v[94:95] offset:0
    ds_write_b64 v29, v[96:97] offset:0
    s_waitcnt lgkmcnt(0)
    s_barrier
    s_add_u32 s29, s28, 1179648
    buffer_load_dwordx2 v[80:81], v12, s[12:15], s29 offen
    buffer_load_dwordx2 v[82:83], v13, s[12:15], s29 offen
    buffer_load_dwordx2 v[84:85], v14, s[12:15], s29 offen
    buffer_load_dwordx2 v[86:87], v15, s[12:15], s29 offen
    buffer_load_dwordx2 v[88:89], v16, s[12:15], s29 offen
    buffer_load_dwordx2 v[90:91], v17, s[12:15], s29 offen
    buffer_load_dwordx2 v[92:93], v18, s[12:15], s29 offen
    buffer_load_dwordx2 v[94:95], v19, s[12:15], s29 offen
    buffer_load_dwordx2 v[96:97], v20, s[12:15], s29 offen
    s_add_u32 s30, s27, 256
    buffer_load_dwordx4 v[64:67], v10, s[8:11], s30 offen offset:0
    buffer_load_dwordx4 v[68:71], v10, s[8:11], s30 offen offset:64
    buffer_load_dwordx4 v[72:75], v11, s[8:11], s30 offen offset:0
    buffer_load_dwordx4 v[76:79], v11, s[8:11], s30 offen offset:64
    ds_read_b64_tr_b16 v[116:117], v30 offset:0
    ds_read_b64_tr_b16 v[118:119], v30 offset:1152
    ds_read_b64_tr_b16 v[120:121], v30 offset:32
    ds_read_b64_tr_b16 v[122:123], v30 offset:1184
    ds_read_b64_tr_b16 v[124:125], v30 offset:64
    ds_read_b64_tr_b16 v[126:127], v30 offset:1216
    ds_read_b64_tr_b16 v[128:129], v30 offset:96
    ds_read_b64_tr_b16 v[130:131], v30 offset:1248
    ds_read_b64_tr_b16 v[132:133], v30 offset:128
    ds_read_b64_tr_b16 v[134:135], v30 offset:1280
    ds_read_b64_tr_b16 v[136:137], v30 offset:160
    ds_read_b64_tr_b16 v[138:139], v30 offset:1312
    ds_read_b64_tr_b16 v[140:141], v30 offset:192
    ds_read_b64_tr_b16 v[142:143], v30 offset:1344
    ds_read_b64_tr_b16 v[144:145], v30 offset:224
    ds_read_b64_tr_b16 v[146:147], v30 offset:1376
    ds_read_b64_tr_b16 v[148:149], v30 offset:256
    ds_read_b64_tr_b16 v[150:151], v30 offset:1408
    s_waitcnt vmcnt(26)
    s_waitcnt lgkmcnt(0)
    v_mfma_f32_16x16x32_bf16 v[156:159], v[116:119], v[32:35], v[156:159]
    v_mfma_f32_16x16x32_bf16 v[192:195], v[116:119], v[40:43], v[192:195]
    v_mfma_f32_16x16x32_bf16 v[160:163], v[120:123], v[32:35], v[160:163]
    v_mfma_f32_16x16x32_bf16 v[196:199], v[120:123], v[40:43], v[196:199]
    v_mfma_f32_16x16x32_bf16 v[164:167], v[124:127], v[32:35], v[164:167]
    v_mfma_f32_16x16x32_bf16 v[200:203], v[124:127], v[40:43], v[200:203]
    v_mfma_f32_16x16x32_bf16 v[168:171], v[128:131], v[32:35], v[168:171]
    v_mfma_f32_16x16x32_bf16 v[204:207], v[128:131], v[40:43], v[204:207]
    v_mfma_f32_16x16x32_bf16 v[172:175], v[132:135], v[32:35], v[172:175]
    v_mfma_f32_16x16x32_bf16 v[208:211], v[132:135], v[40:43], v[208:211]
    v_mfma_f32_16x16x32_bf16 v[176:179], v[136:139], v[32:35], v[176:179]
    v_mfma_f32_16x16x32_bf16 v[212:215], v[136:139], v[40:43], v[212:215]
    v_mfma_f32_16x16x32_bf16 v[180:183], v[140:143], v[32:35], v[180:183]
    v_mfma_f32_16x16x32_bf16 v[216:219], v[140:143], v[40:43], v[216:219]
    v_mfma_f32_16x16x32_bf16 v[184:187], v[144:147], v[32:35], v[184:187]
    v_mfma_f32_16x16x32_bf16 v[220:223], v[144:147], v[40:43], v[220:223]
    v_mfma_f32_16x16x32_bf16 v[188:191], v[148:151], v[32:35], v[188:191]
    v_mfma_f32_16x16x32_bf16 v[224:227], v[148:151], v[40:43], v[224:227]
    ds_read_b64_tr_b16 v[116:117], v30 offset:9728
    ds_read_b64_tr_b16 v[118:119], v30 offset:10880
    ds_read_b64_tr_b16 v[120:121], v30 offset:9760
    ds_read_b64_tr_b16 v[122:123], v30 offset:10912
    ds_read_b64_tr_b16 v[124:125], v30 offset:9792
    ds_read_b64_tr_b16 v[126:127], v30 offset:10944
    ds_read_b64_tr_b16 v[128:129], v30 offset:9824
    ds_read_b64_tr_b16 v[130:131], v30 offset:10976
    ds_read_b64_tr_b16 v[132:133], v30 offset:9856
    ds_read_b64_tr_b16 v[134:135], v30 offset:11008
    ds_read_b64_tr_b16 v[136:137], v30 offset:9888
    ds_read_b64_tr_b16 v[138:139], v30 offset:11040
    ds_read_b64_tr_b16 v[140:141], v30 offset:9920
    ds_read_b64_tr_b16 v[142:143], v30 offset:11072
    ds_read_b64_tr_b16 v[144:145], v30 offset:9952
    ds_read_b64_tr_b16 v[146:147], v30 offset:11104
    ds_read_b64_tr_b16 v[148:149], v30 offset:9984
    ds_read_b64_tr_b16 v[150:151], v30 offset:11136
    s_waitcnt lgkmcnt(0)
    v_mfma_f32_16x16x32_bf16 v[156:159], v[116:119], v[36:39], v[156:159]
    v_mfma_f32_16x16x32_bf16 v[192:195], v[116:119], v[44:47], v[192:195]
    v_mfma_f32_16x16x32_bf16 v[160:163], v[120:123], v[36:39], v[160:163]
    v_mfma_f32_16x16x32_bf16 v[196:199], v[120:123], v[44:47], v[196:199]
    v_mfma_f32_16x16x32_bf16 v[164:167], v[124:127], v[36:39], v[164:167]
    v_mfma_f32_16x16x32_bf16 v[200:203], v[124:127], v[44:47], v[200:203]
    v_mfma_f32_16x16x32_bf16 v[168:171], v[128:131], v[36:39], v[168:171]
    v_mfma_f32_16x16x32_bf16 v[204:207], v[128:131], v[44:47], v[204:207]
    v_mfma_f32_16x16x32_bf16 v[172:175], v[132:135], v[36:39], v[172:175]
    v_mfma_f32_16x16x32_bf16 v[208:211], v[132:135], v[44:47], v[208:211]
    v_mfma_f32_16x16x32_bf16 v[176:179], v[136:139], v[36:39], v[176:179]
    v_mfma_f32_16x16x32_bf16 v[212:215], v[136:139], v[44:47], v[212:215]
    v_mfma_f32_16x16x32_bf16 v[180:183], v[140:143], v[36:39], v[180:183]
    v_mfma_f32_16x16x32_bf16 v[216:219], v[140:143], v[44:47], v[216:219]
    v_mfma_f32_16x16x32_bf16 v[184:187], v[144:147], v[36:39], v[184:187]
    v_mfma_f32_16x16x32_bf16 v[220:223], v[144:147], v[44:47], v[220:223]
    v_mfma_f32_16x16x32_bf16 v[188:191], v[148:151], v[36:39], v[188:191]
    v_mfma_f32_16x16x32_bf16 v[224:227], v[148:151], v[44:47], v[224:227]
    s_waitcnt vmcnt(17)
    ds_write_b64 v21, v[98:99] offset:19456
    ds_write_b64 v22, v[100:101] offset:19456
    ds_write_b64 v23, v[102:103] offset:19456
    ds_write_b64 v24, v[104:105] offset:19456
    ds_write_b64 v25, v[106:107] offset:19456
    ds_write_b64 v26, v[108:109] offset:19456
    ds_write_b64 v27, v[110:111] offset:19456
    ds_write_b64 v28, v[112:113] offset:19456
    ds_write_b64 v29, v[114:115] offset:19456
    s_waitcnt lgkmcnt(0)
    s_barrier
    s_add_u32 s29, s28, 1769472
    buffer_load_dwordx2 v[98:99], v12, s[12:15], s29 offen
    buffer_load_dwordx2 v[100:101], v13, s[12:15], s29 offen
    buffer_load_dwordx2 v[102:103], v14, s[12:15], s29 offen
    buffer_load_dwordx2 v[104:105], v15, s[12:15], s29 offen
    buffer_load_dwordx2 v[106:107], v16, s[12:15], s29 offen
    buffer_load_dwordx2 v[108:109], v17, s[12:15], s29 offen
    buffer_load_dwordx2 v[110:111], v18, s[12:15], s29 offen
    buffer_load_dwordx2 v[112:113], v19, s[12:15], s29 offen
    buffer_load_dwordx2 v[114:115], v20, s[12:15], s29 offen
    s_add_u32 s30, s27, 384
    buffer_load_dwordx4 v[32:35], v10, s[8:11], s30 offen offset:0
    buffer_load_dwordx4 v[36:39], v10, s[8:11], s30 offen offset:64
    buffer_load_dwordx4 v[40:43], v11, s[8:11], s30 offen offset:0
    buffer_load_dwordx4 v[44:47], v11, s[8:11], s30 offen offset:64
    ds_read_b64_tr_b16 v[116:117], v30 offset:19456
    ds_read_b64_tr_b16 v[118:119], v30 offset:20608
    ds_read_b64_tr_b16 v[120:121], v30 offset:19488
    ds_read_b64_tr_b16 v[122:123], v30 offset:20640
    ds_read_b64_tr_b16 v[124:125], v30 offset:19520
    ds_read_b64_tr_b16 v[126:127], v30 offset:20672
    ds_read_b64_tr_b16 v[128:129], v30 offset:19552
    ds_read_b64_tr_b16 v[130:131], v30 offset:20704
    ds_read_b64_tr_b16 v[132:133], v30 offset:19584
    ds_read_b64_tr_b16 v[134:135], v30 offset:20736
    ds_read_b64_tr_b16 v[136:137], v30 offset:19616
    ds_read_b64_tr_b16 v[138:139], v30 offset:20768
    ds_read_b64_tr_b16 v[140:141], v30 offset:19648
    ds_read_b64_tr_b16 v[142:143], v30 offset:20800
    ds_read_b64_tr_b16 v[144:145], v30 offset:19680
    ds_read_b64_tr_b16 v[146:147], v30 offset:20832
    ds_read_b64_tr_b16 v[148:149], v30 offset:19712
    ds_read_b64_tr_b16 v[150:151], v30 offset:20864
    s_waitcnt vmcnt(26)
    s_waitcnt lgkmcnt(0)
    v_mfma_f32_16x16x32_bf16 v[156:159], v[116:119], v[48:51], v[156:159]
    v_mfma_f32_16x16x32_bf16 v[192:195], v[116:119], v[56:59], v[192:195]
    v_mfma_f32_16x16x32_bf16 v[160:163], v[120:123], v[48:51], v[160:163]
    v_mfma_f32_16x16x32_bf16 v[196:199], v[120:123], v[56:59], v[196:199]
    v_mfma_f32_16x16x32_bf16 v[164:167], v[124:127], v[48:51], v[164:167]
    v_mfma_f32_16x16x32_bf16 v[200:203], v[124:127], v[56:59], v[200:203]
    v_mfma_f32_16x16x32_bf16 v[168:171], v[128:131], v[48:51], v[168:171]
    v_mfma_f32_16x16x32_bf16 v[204:207], v[128:131], v[56:59], v[204:207]
    v_mfma_f32_16x16x32_bf16 v[172:175], v[132:135], v[48:51], v[172:175]
    v_mfma_f32_16x16x32_bf16 v[208:211], v[132:135], v[56:59], v[208:211]
    v_mfma_f32_16x16x32_bf16 v[176:179], v[136:139], v[48:51], v[176:179]
    v_mfma_f32_16x16x32_bf16 v[212:215], v[136:139], v[56:59], v[212:215]
    v_mfma_f32_16x16x32_bf16 v[180:183], v[140:143], v[48:51], v[180:183]
    v_mfma_f32_16x16x32_bf16 v[216:219], v[140:143], v[56:59], v[216:219]
    v_mfma_f32_16x16x32_bf16 v[184:187], v[144:147], v[48:51], v[184:187]
    v_mfma_f32_16x16x32_bf16 v[220:223], v[144:147], v[56:59], v[220:223]
    v_mfma_f32_16x16x32_bf16 v[188:191], v[148:151], v[48:51], v[188:191]
    v_mfma_f32_16x16x32_bf16 v[224:227], v[148:151], v[56:59], v[224:227]
    ds_read_b64_tr_b16 v[116:117], v30 offset:29184
    ds_read_b64_tr_b16 v[118:119], v30 offset:30336
    ds_read_b64_tr_b16 v[120:121], v30 offset:29216
    ds_read_b64_tr_b16 v[122:123], v30 offset:30368
    ds_read_b64_tr_b16 v[124:125], v30 offset:29248
    ds_read_b64_tr_b16 v[126:127], v30 offset:30400
    ds_read_b64_tr_b16 v[128:129], v30 offset:29280
    ds_read_b64_tr_b16 v[130:131], v30 offset:30432
    ds_read_b64_tr_b16 v[132:133], v30 offset:29312
    ds_read_b64_tr_b16 v[134:135], v30 offset:30464
    ds_read_b64_tr_b16 v[136:137], v30 offset:29344
    ds_read_b64_tr_b16 v[138:139], v30 offset:30496
    ds_read_b64_tr_b16 v[140:141], v30 offset:29376
    ds_read_b64_tr_b16 v[142:143], v30 offset:30528
    ds_read_b64_tr_b16 v[144:145], v30 offset:29408
    ds_read_b64_tr_b16 v[146:147], v30 offset:30560
    ds_read_b64_tr_b16 v[148:149], v30 offset:29440
    ds_read_b64_tr_b16 v[150:151], v30 offset:30592
    s_waitcnt lgkmcnt(0)
    v_mfma_f32_16x16x32_bf16 v[156:159], v[116:119], v[52:55], v[156:159]
    v_mfma_f32_16x16x32_bf16 v[192:195], v[116:119], v[60:63], v[192:195]
    v_mfma_f32_16x16x32_bf16 v[160:163], v[120:123], v[52:55], v[160:163]
    v_mfma_f32_16x16x32_bf16 v[196:199], v[120:123], v[60:63], v[196:199]
    v_mfma_f32_16x16x32_bf16 v[164:167], v[124:127], v[52:55], v[164:167]
    v_mfma_f32_16x16x32_bf16 v[200:203], v[124:127], v[60:63], v[200:203]
    v_mfma_f32_16x16x32_bf16 v[168:171], v[128:131], v[52:55], v[168:171]
    v_mfma_f32_16x16x32_bf16 v[204:207], v[128:131], v[60:63], v[204:207]
    v_mfma_f32_16x16x32_bf16 v[172:175], v[132:135], v[52:55], v[172:175]
    v_mfma_f32_16x16x32_bf16 v[208:211], v[132:135], v[60:63], v[208:211]
    v_mfma_f32_16x16x32_bf16 v[176:179], v[136:139], v[52:55], v[176:179]
    v_mfma_f32_16x16x32_bf16 v[212:215], v[136:139], v[60:63], v[212:215]
    v_mfma_f32_16x16x32_bf16 v[180:183], v[140:143], v[52:55], v[180:183]
    v_mfma_f32_16x16x32_bf16 v[216:219], v[140:143], v[60:63], v[216:219]
    v_mfma_f32_16x16x32_bf16 v[184:187], v[144:147], v[52:55], v[184:187]
    v_mfma_f32_16x16x32_bf16 v[220:223], v[144:147], v[60:63], v[220:223]
    v_mfma_f32_16x16x32_bf16 v[188:191], v[148:151], v[52:55], v[188:191]
    v_mfma_f32_16x16x32_bf16 v[224:227], v[148:151], v[60:63], v[224:227]
    s_waitcnt vmcnt(17)
    ds_write_b64 v21, v[80:81] offset:0
    ds_write_b64 v22, v[82:83] offset:0
    ds_write_b64 v23, v[84:85] offset:0
    ds_write_b64 v24, v[86:87] offset:0
    ds_write_b64 v25, v[88:89] offset:0
    ds_write_b64 v26, v[90:91] offset:0
    ds_write_b64 v27, v[92:93] offset:0
    ds_write_b64 v28, v[94:95] offset:0
    ds_write_b64 v29, v[96:97] offset:0
    s_waitcnt lgkmcnt(0)
    s_barrier
    s_add_u32 s29, s28, 2359296
    buffer_load_dwordx2 v[80:81], v12, s[12:15], s29 offen
    buffer_load_dwordx2 v[82:83], v13, s[12:15], s29 offen
    buffer_load_dwordx2 v[84:85], v14, s[12:15], s29 offen
    buffer_load_dwordx2 v[86:87], v15, s[12:15], s29 offen
    buffer_load_dwordx2 v[88:89], v16, s[12:15], s29 offen
    buffer_load_dwordx2 v[90:91], v17, s[12:15], s29 offen
    buffer_load_dwordx2 v[92:93], v18, s[12:15], s29 offen
    buffer_load_dwordx2 v[94:95], v19, s[12:15], s29 offen
    buffer_load_dwordx2 v[96:97], v20, s[12:15], s29 offen
    s_add_u32 s30, s27, 512
    buffer_load_dwordx4 v[48:51], v10, s[8:11], s30 offen offset:0
    buffer_load_dwordx4 v[52:55], v10, s[8:11], s30 offen offset:64
    buffer_load_dwordx4 v[56:59], v11, s[8:11], s30 offen offset:0
    buffer_load_dwordx4 v[60:63], v11, s[8:11], s30 offen offset:64
    ds_read_b64_tr_b16 v[116:117], v30 offset:0
    ds_read_b64_tr_b16 v[118:119], v30 offset:1152
    ds_read_b64_tr_b16 v[120:121], v30 offset:32
    ds_read_b64_tr_b16 v[122:123], v30 offset:1184
    ds_read_b64_tr_b16 v[124:125], v30 offset:64
    ds_read_b64_tr_b16 v[126:127], v30 offset:1216
    ds_read_b64_tr_b16 v[128:129], v30 offset:96
    ds_read_b64_tr_b16 v[130:131], v30 offset:1248
    ds_read_b64_tr_b16 v[132:133], v30 offset:128
    ds_read_b64_tr_b16 v[134:135], v30 offset:1280
    ds_read_b64_tr_b16 v[136:137], v30 offset:160
    ds_read_b64_tr_b16 v[138:139], v30 offset:1312
    ds_read_b64_tr_b16 v[140:141], v30 offset:192
    ds_read_b64_tr_b16 v[142:143], v30 offset:1344
    ds_read_b64_tr_b16 v[144:145], v30 offset:224
    ds_read_b64_tr_b16 v[146:147], v30 offset:1376
    ds_read_b64_tr_b16 v[148:149], v30 offset:256
    ds_read_b64_tr_b16 v[150:151], v30 offset:1408
    s_waitcnt vmcnt(26)
    s_waitcnt lgkmcnt(0)
    v_mfma_f32_16x16x32_bf16 v[156:159], v[116:119], v[64:67], v[156:159]
    v_mfma_f32_16x16x32_bf16 v[192:195], v[116:119], v[72:75], v[192:195]
    v_mfma_f32_16x16x32_bf16 v[160:163], v[120:123], v[64:67], v[160:163]
    v_mfma_f32_16x16x32_bf16 v[196:199], v[120:123], v[72:75], v[196:199]
    v_mfma_f32_16x16x32_bf16 v[164:167], v[124:127], v[64:67], v[164:167]
    v_mfma_f32_16x16x32_bf16 v[200:203], v[124:127], v[72:75], v[200:203]
    v_mfma_f32_16x16x32_bf16 v[168:171], v[128:131], v[64:67], v[168:171]
    v_mfma_f32_16x16x32_bf16 v[204:207], v[128:131], v[72:75], v[204:207]
    v_mfma_f32_16x16x32_bf16 v[172:175], v[132:135], v[64:67], v[172:175]
    v_mfma_f32_16x16x32_bf16 v[208:211], v[132:135], v[72:75], v[208:211]
    v_mfma_f32_16x16x32_bf16 v[176:179], v[136:139], v[64:67], v[176:179]
    v_mfma_f32_16x16x32_bf16 v[212:215], v[136:139], v[72:75], v[212:215]
    v_mfma_f32_16x16x32_bf16 v[180:183], v[140:143], v[64:67], v[180:183]
    v_mfma_f32_16x16x32_bf16 v[216:219], v[140:143], v[72:75], v[216:219]
    v_mfma_f32_16x16x32_bf16 v[184:187], v[144:147], v[64:67], v[184:187]
    v_mfma_f32_16x16x32_bf16 v[220:223], v[144:147], v[72:75], v[220:223]
    v_mfma_f32_16x16x32_bf16 v[188:191], v[148:151], v[64:67], v[188:191]
    v_mfma_f32_16x16x32_bf16 v[224:227], v[148:151], v[72:75], v[224:227]
    ds_read_b64_tr_b16 v[116:117], v30 offset:9728
    ds_read_b64_tr_b16 v[118:119], v30 offset:10880
    ds_read_b64_tr_b16 v[120:121], v30 offset:9760
    ds_read_b64_tr_b16 v[122:123], v30 offset:10912
    ds_read_b64_tr_b16 v[124:125], v30 offset:9792
    ds_read_b64_tr_b16 v[126:127], v30 offset:10944
    ds_read_b64_tr_b16 v[128:129], v30 offset:9824
    ds_read_b64_tr_b16 v[130:131], v30 offset:10976
    ds_read_b64_tr_b16 v[132:133], v30 offset:9856
    ds_read_b64_tr_b16 v[134:135], v30 offset:11008
    ds_read_b64_tr_b16 v[136:137], v30 offset:9888
    ds_read_b64_tr_b16 v[138:139], v30 offset:11040
    ds_read_b64_tr_b16 v[140:141], v30 offset:9920
    ds_read_b64_tr_b16 v[142:143], v30 offset:11072
    ds_read_b64_tr_b16 v[144:145], v30 offset:9952
    ds_read_b64_tr_b16 v[146:147], v30 offset:11104
    ds_read_b64_tr_b16 v[148:149], v30 offset:9984
    ds_read_b64_tr_b16 v[150:151], v30 offset:11136
    s_waitcnt lgkmcnt(0)
    v_mfma_f32_16x16x32_bf16 v[156:159], v[116:119], v[68:71], v[156:159]
    v_mfma_f32_16x16x32_bf16 v[192:195], v[116:119], v[76:79], v[192:195]
    v_mfma_f32_16x16x32_bf16 v[160:163], v[120:123], v[68:71], v[160:163]
    v_mfma_f32_16x16x32_bf16 v[196:199], v[120:123], v[76:79], v[196:199]
    v_mfma_f32_16x16x32_bf16 v[164:167], v[124:127], v[68:71], v[164:167]
    v_mfma_f32_16x16x32_bf16 v[200:203], v[124:127], v[76:79], v[200:203]
    v_mfma_f32_16x16x32_bf16 v[168:171], v[128:131], v[68:71], v[168:171]
    v_mfma_f32_16x16x32_bf16 v[204:207], v[128:131], v[76:79], v[204:207]
    v_mfma_f32_16x16x32_bf16 v[172:175], v[132:135], v[68:71], v[172:175]
    v_mfma_f32_16x16x32_bf16 v[208:211], v[132:135], v[76:79], v[208:211]
    v_mfma_f32_16x16x32_bf16 v[176:179], v[136:139], v[68:71], v[176:179]
    v_mfma_f32_16x16x32_bf16 v[212:215], v[136:139], v[76:79], v[212:215]
    v_mfma_f32_16x16x32_bf16 v[180:183], v[140:143], v[68:71], v[180:183]
    v_mfma_f32_16x16x32_bf16 v[216:219], v[140:143], v[76:79], v[216:219]
    v_mfma_f32_16x16x32_bf16 v[184:187], v[144:147], v[68:71], v[184:187]
    v_mfma_f32_16x16x32_bf16 v[220:223], v[144:147], v[76:79], v[220:223]
    v_mfma_f32_16x16x32_bf16 v[188:191], v[148:151], v[68:71], v[188:191]
    v_mfma_f32_16x16x32_bf16 v[224:227], v[148:151], v[76:79], v[224:227]
    s_waitcnt vmcnt(17)
    ds_write_b64 v21, v[98:99] offset:19456
    ds_write_b64 v22, v[100:101] offset:19456
    ds_write_b64 v23, v[102:103] offset:19456
    ds_write_b64 v24, v[104:105] offset:19456
    ds_write_b64 v25, v[106:107] offset:19456
    ds_write_b64 v26, v[108:109] offset:19456
    ds_write_b64 v27, v[110:111] offset:19456
    ds_write_b64 v28, v[112:113] offset:19456
    ds_write_b64 v29, v[114:115] offset:19456
    s_waitcnt lgkmcnt(0)
    s_barrier
    s_add_u32 s29, s28, 2949120
    buffer_load_dwordx2 v[98:99], v12, s[12:15], s29 offen
    buffer_load_dwordx2 v[100:101], v13, s[12:15], s29 offen
    buffer_load_dwordx2 v[102:103], v14, s[12:15], s29 offen
    buffer_load_dwordx2 v[104:105], v15, s[12:15], s29 offen
    buffer_load_dwordx2 v[106:107], v16, s[12:15], s29 offen
    buffer_load_dwordx2 v[108:109], v17, s[12:15], s29 offen
    buffer_load_dwordx2 v[110:111], v18, s[12:15], s29 offen
    buffer_load_dwordx2 v[112:113], v19, s[12:15], s29 offen
    buffer_load_dwordx2 v[114:115], v20, s[12:15], s29 offen
    s_add_u32 s30, s27, 640
    buffer_load_dwordx4 v[64:67], v10, s[8:11], s30 offen offset:0
    buffer_load_dwordx4 v[68:71], v10, s[8:11], s30 offen offset:64
    buffer_load_dwordx4 v[72:75], v11, s[8:11], s30 offen offset:0
    buffer_load_dwordx4 v[76:79], v11, s[8:11], s30 offen offset:64
    ds_read_b64_tr_b16 v[116:117], v30 offset:19456
    ds_read_b64_tr_b16 v[118:119], v30 offset:20608
    ds_read_b64_tr_b16 v[120:121], v30 offset:19488
    ds_read_b64_tr_b16 v[122:123], v30 offset:20640
    ds_read_b64_tr_b16 v[124:125], v30 offset:19520
    ds_read_b64_tr_b16 v[126:127], v30 offset:20672
    ds_read_b64_tr_b16 v[128:129], v30 offset:19552
    ds_read_b64_tr_b16 v[130:131], v30 offset:20704
    ds_read_b64_tr_b16 v[132:133], v30 offset:19584
    ds_read_b64_tr_b16 v[134:135], v30 offset:20736
    ds_read_b64_tr_b16 v[136:137], v30 offset:19616
    ds_read_b64_tr_b16 v[138:139], v30 offset:20768
    ds_read_b64_tr_b16 v[140:141], v30 offset:19648
    ds_read_b64_tr_b16 v[142:143], v30 offset:20800
    ds_read_b64_tr_b16 v[144:145], v30 offset:19680
    ds_read_b64_tr_b16 v[146:147], v30 offset:20832
    ds_read_b64_tr_b16 v[148:149], v30 offset:19712
    ds_read_b64_tr_b16 v[150:151], v30 offset:20864
    s_waitcnt vmcnt(26)
    s_waitcnt lgkmcnt(0)
    v_mfma_f32_16x16x32_bf16 v[156:159], v[116:119], v[32:35], v[156:159]
    v_mfma_f32_16x16x32_bf16 v[192:195], v[116:119], v[40:43], v[192:195]
    v_mfma_f32_16x16x32_bf16 v[160:163], v[120:123], v[32:35], v[160:163]
    v_mfma_f32_16x16x32_bf16 v[196:199], v[120:123], v[40:43], v[196:199]
    v_mfma_f32_16x16x32_bf16 v[164:167], v[124:127], v[32:35], v[164:167]
    v_mfma_f32_16x16x32_bf16 v[200:203], v[124:127], v[40:43], v[200:203]
    v_mfma_f32_16x16x32_bf16 v[168:171], v[128:131], v[32:35], v[168:171]
    v_mfma_f32_16x16x32_bf16 v[204:207], v[128:131], v[40:43], v[204:207]
    v_mfma_f32_16x16x32_bf16 v[172:175], v[132:135], v[32:35], v[172:175]
    v_mfma_f32_16x16x32_bf16 v[208:211], v[132:135], v[40:43], v[208:211]
    v_mfma_f32_16x16x32_bf16 v[176:179], v[136:139], v[32:35], v[176:179]
    v_mfma_f32_16x16x32_bf16 v[212:215], v[136:139], v[40:43], v[212:215]
    v_mfma_f32_16x16x32_bf16 v[180:183], v[140:143], v[32:35], v[180:183]
    v_mfma_f32_16x16x32_bf16 v[216:219], v[140:143], v[40:43], v[216:219]
    v_mfma_f32_16x16x32_bf16 v[184:187], v[144:147], v[32:35], v[184:187]
    v_mfma_f32_16x16x32_bf16 v[220:223], v[144:147], v[40:43], v[220:223]
    v_mfma_f32_16x16x32_bf16 v[188:191], v[148:151], v[32:35], v[188:191]
    v_mfma_f32_16x16x32_bf16 v[224:227], v[148:151], v[40:43], v[224:227]
    ds_read_b64_tr_b16 v[116:117], v30 offset:29184
    ds_read_b64_tr_b16 v[118:119], v30 offset:30336
    ds_read_b64_tr_b16 v[120:121], v30 offset:29216
    ds_read_b64_tr_b16 v[122:123], v30 offset:30368
    ds_read_b64_tr_b16 v[124:125], v30 offset:29248
    ds_read_b64_tr_b16 v[126:127], v30 offset:30400
    ds_read_b64_tr_b16 v[128:129], v30 offset:29280
    ds_read_b64_tr_b16 v[130:131], v30 offset:30432
    ds_read_b64_tr_b16 v[132:133], v30 offset:29312
    ds_read_b64_tr_b16 v[134:135], v30 offset:30464
    ds_read_b64_tr_b16 v[136:137], v30 offset:29344
    ds_read_b64_tr_b16 v[138:139], v30 offset:30496
    ds_read_b64_tr_b16 v[140:141], v30 offset:29376
    ds_read_b64_tr_b16 v[142:143], v30 offset:30528
    ds_read_b64_tr_b16 v[144:145], v30 offset:29408
    ds_read_b64_tr_b16 v[146:147], v30 offset:30560
    ds_read_b64_tr_b16 v[148:149], v30 offset:29440
    ds_read_b64_tr_b16 v[150:151], v30 offset:30592
    s_waitcnt lgkmcnt(0)
    v_mfma_f32_16x16x32_bf16 v[156:159], v[116:119], v[36:39], v[156:159]
    v_mfma_f32_16x16x32_bf16 v[192:195], v[116:119], v[44:47], v[192:195]
    v_mfma_f32_16x16x32_bf16 v[160:163], v[120:123], v[36:39], v[160:163]
    v_mfma_f32_16x16x32_bf16 v[196:199], v[120:123], v[44:47], v[196:199]
    v_mfma_f32_16x16x32_bf16 v[164:167], v[124:127], v[36:39], v[164:167]
    v_mfma_f32_16x16x32_bf16 v[200:203], v[124:127], v[44:47], v[200:203]
    v_mfma_f32_16x16x32_bf16 v[168:171], v[128:131], v[36:39], v[168:171]
    v_mfma_f32_16x16x32_bf16 v[204:207], v[128:131], v[44:47], v[204:207]
    v_mfma_f32_16x16x32_bf16 v[172:175], v[132:135], v[36:39], v[172:175]
    v_mfma_f32_16x16x32_bf16 v[208:211], v[132:135], v[44:47], v[208:211]
    v_mfma_f32_16x16x32_bf16 v[176:179], v[136:139], v[36:39], v[176:179]
    v_mfma_f32_16x16x32_bf16 v[212:215], v[136:139], v[44:47], v[212:215]
    v_mfma_f32_16x16x32_bf16 v[180:183], v[140:143], v[36:39], v[180:183]
    v_mfma_f32_16x16x32_bf16 v[216:219], v[140:143], v[44:47], v[216:219]
    v_mfma_f32_16x16x32_bf16 v[184:187], v[144:147], v[36:39], v[184:187]
    v_mfma_f32_16x16x32_bf16 v[220:223], v[144:147], v[44:47], v[220:223]
    v_mfma_f32_16x16x32_bf16 v[188:191], v[148:151], v[36:39], v[188:191]
    v_mfma_f32_16x16x32_bf16 v[224:227], v[148:151], v[44:47], v[224:227]
    s_waitcnt vmcnt(17)
    ds_write_b64 v21, v[80:81] offset:0
    ds_write_b64 v22, v[82:83] offset:0
    ds_write_b64 v23, v[84:85] offset:0
    ds_write_b64 v24, v[86:87] offset:0
    ds_write_b64 v25, v[88:89] offset:0
    ds_write_b64 v26, v[90:91] offset:0
    ds_write_b64 v27, v[92:93] offset:0
    ds_write_b64 v28, v[94:95] offset:0
    ds_write_b64 v29, v[96:97] offset:0
    s_waitcnt lgkmcnt(0)
    s_barrier
    s_add_u32 s29, s28, 3538944
    buffer_load_dwordx2 v[80:81], v12, s[12:15], s29 offen
    buffer_load_dwordx2 v[82:83], v13, s[12:15], s29 offen
    buffer_load_dwordx2 v[84:85], v14, s[12:15], s29 offen
    buffer_load_dwordx2 v[86:87], v15, s[12:15], s29 offen
    buffer_load_dwordx2 v[88:89], v16, s[12:15], s29 offen
    buffer_load_dwordx2 v[90:91], v17, s[12:15], s29 offen
    buffer_load_dwordx2 v[92:93], v18, s[12:15], s29 offen
    buffer_load_dwordx2 v[94:95], v19, s[12:15], s29 offen
    buffer_load_dwordx2 v[96:97], v20, s[12:15], s29 offen
    s_add_u32 s30, s27, 768
    buffer_load_dwordx4 v[32:35], v10, s[8:11], s30 offen offset:0
    buffer_load_dwordx4 v[36:39], v10, s[8:11], s30 offen offset:64
    buffer_load_dwordx4 v[40:43], v11, s[8:11], s30 offen offset:0
    buffer_load_dwordx4 v[44:47], v11, s[8:11], s30 offen offset:64
    ds_read_b64_tr_b16 v[116:117], v30 offset:0
    ds_read_b64_tr_b16 v[118:119], v30 offset:1152
    ds_read_b64_tr_b16 v[120:121], v30 offset:32
    ds_read_b64_tr_b16 v[122:123], v30 offset:1184
    ds_read_b64_tr_b16 v[124:125], v30 offset:64
    ds_read_b64_tr_b16 v[126:127], v30 offset:1216
    ds_read_b64_tr_b16 v[128:129], v30 offset:96
    ds_read_b64_tr_b16 v[130:131], v30 offset:1248
    ds_read_b64_tr_b16 v[132:133], v30 offset:128
    ds_read_b64_tr_b16 v[134:135], v30 offset:1280
    ds_read_b64_tr_b16 v[136:137], v30 offset:160
    ds_read_b64_tr_b16 v[138:139], v30 offset:1312
    ds_read_b64_tr_b16 v[140:141], v30 offset:192
    ds_read_b64_tr_b16 v[142:143], v30 offset:1344
    ds_read_b64_tr_b16 v[144:145], v30 offset:224
    ds_read_b64_tr_b16 v[146:147], v30 offset:1376
    ds_read_b64_tr_b16 v[148:149], v30 offset:256
    ds_read_b64_tr_b16 v[150:151], v30 offset:1408
    s_waitcnt vmcnt(26)
    s_waitcnt lgkmcnt(0)
    v_mfma_f32_16x16x32_bf16 v[156:159], v[116:119], v[48:51], v[156:159]
    v_mfma_f32_16x16x32_bf16 v[192:195], v[116:119], v[56:59], v[192:195]
    v_mfma_f32_16x16x32_bf16 v[160:163], v[120:123], v[48:51], v[160:163]
    v_mfma_f32_16x16x32_bf16 v[196:199], v[120:123], v[56:59], v[196:199]
    v_mfma_f32_16x16x32_bf16 v[164:167], v[124:127], v[48:51], v[164:167]
    v_mfma_f32_16x16x32_bf16 v[200:203], v[124:127], v[56:59], v[200:203]
    v_mfma_f32_16x16x32_bf16 v[168:171], v[128:131], v[48:51], v[168:171]
    v_mfma_f32_16x16x32_bf16 v[204:207], v[128:131], v[56:59], v[204:207]
    v_mfma_f32_16x16x32_bf16 v[172:175], v[132:135], v[48:51], v[172:175]
    v_mfma_f32_16x16x32_bf16 v[208:211], v[132:135], v[56:59], v[208:211]
    v_mfma_f32_16x16x32_bf16 v[176:179], v[136:139], v[48:51], v[176:179]
    v_mfma_f32_16x16x32_bf16 v[212:215], v[136:139], v[56:59], v[212:215]
    v_mfma_f32_16x16x32_bf16 v[180:183], v[140:143], v[48:51], v[180:183]
    v_mfma_f32_16x16x32_bf16 v[216:219], v[140:143], v[56:59], v[216:219]
    v_mfma_f32_16x16x32_bf16 v[184:187], v[144:147], v[48:51], v[184:187]
    v_mfma_f32_16x16x32_bf16 v[220:223], v[144:147], v[56:59], v[220:223]
    v_mfma_f32_16x16x32_bf16 v[188:191], v[148:151], v[48:51], v[188:191]
    v_mfma_f32_16x16x32_bf16 v[224:227], v[148:151], v[56:59], v[224:227]
    ds_read_b64_tr_b16 v[116:117], v30 offset:9728
    ds_read_b64_tr_b16 v[118:119], v30 offset:10880
    ds_read_b64_tr_b16 v[120:121], v30 offset:9760
    ds_read_b64_tr_b16 v[122:123], v30 offset:10912
    ds_read_b64_tr_b16 v[124:125], v30 offset:9792
    ds_read_b64_tr_b16 v[126:127], v30 offset:10944
    ds_read_b64_tr_b16 v[128:129], v30 offset:9824
    ds_read_b64_tr_b16 v[130:131], v30 offset:10976
    ds_read_b64_tr_b16 v[132:133], v30 offset:9856
    ds_read_b64_tr_b16 v[134:135], v30 offset:11008
    ds_read_b64_tr_b16 v[136:137], v30 offset:9888
    ds_read_b64_tr_b16 v[138:139], v30 offset:11040
    ds_read_b64_tr_b16 v[140:141], v30 offset:9920
    ds_read_b64_tr_b16 v[142:143], v30 offset:11072
    ds_read_b64_tr_b16 v[144:145], v30 offset:9952
    ds_read_b64_tr_b16 v[146:147], v30 offset:11104
    ds_read_b64_tr_b16 v[148:149], v30 offset:9984
    ds_read_b64_tr_b16 v[150:151], v30 offset:11136
    s_waitcnt lgkmcnt(0)
    v_mfma_f32_16x16x32_bf16 v[156:159], v[116:119], v[52:55], v[156:159]
    v_mfma_f32_16x16x32_bf16 v[192:195], v[116:119], v[60:63], v[192:195]
    v_mfma_f32_16x16x32_bf16 v[160:163], v[120:123], v[52:55], v[160:163]
    v_mfma_f32_16x16x32_bf16 v[196:199], v[120:123], v[60:63], v[196:199]
    v_mfma_f32_16x16x32_bf16 v[164:167], v[124:127], v[52:55], v[164:167]
    v_mfma_f32_16x16x32_bf16 v[200:203], v[124:127], v[60:63], v[200:203]
    v_mfma_f32_16x16x32_bf16 v[168:171], v[128:131], v[52:55], v[168:171]
    v_mfma_f32_16x16x32_bf16 v[204:207], v[128:131], v[60:63], v[204:207]
    v_mfma_f32_16x16x32_bf16 v[172:175], v[132:135], v[52:55], v[172:175]
    v_mfma_f32_16x16x32_bf16 v[208:211], v[132:135], v[60:63], v[208:211]
    v_mfma_f32_16x16x32_bf16 v[176:179], v[136:139], v[52:55], v[176:179]
    v_mfma_f32_16x16x32_bf16 v[212:215], v[136:139], v[60:63], v[212:215]
    v_mfma_f32_16x16x32_bf16 v[180:183], v[140:143], v[52:55], v[180:183]
    v_mfma_f32_16x16x32_bf16 v[216:219], v[140:143], v[60:63], v[216:219]
    v_mfma_f32_16x16x32_bf16 v[184:187], v[144:147], v[52:55], v[184:187]
    v_mfma_f32_16x16x32_bf16 v[220:223], v[144:147], v[60:63], v[220:223]
    v_mfma_f32_16x16x32_bf16 v[188:191], v[148:151], v[52:55], v[188:191]
    v_mfma_f32_16x16x32_bf16 v[224:227], v[148:151], v[60:63], v[224:227]
    s_waitcnt vmcnt(17)
    ds_write_b64 v21, v[98:99] offset:19456
    ds_write_b64 v22, v[100:101] offset:19456
    ds_write_b64 v23, v[102:103] offset:19456
    ds_write_b64 v24, v[104:105] offset:19456
    ds_write_b64 v25, v[106:107] offset:19456
    ds_write_b64 v26, v[108:109] offset:19456
    ds_write_b64 v27, v[110:111] offset:19456
    ds_write_b64 v28, v[112:113] offset:19456
    ds_write_b64 v29, v[114:115] offset:19456
    s_waitcnt lgkmcnt(0)
    s_barrier
    s_add_u32 s29, s28, 4128768
    buffer_load_dwordx2 v[98:99], v12, s[12:15], s29 offen
    buffer_load_dwordx2 v[100:101], v13, s[12:15], s29 offen
    buffer_load_dwordx2 v[102:103], v14, s[12:15], s29 offen
    buffer_load_dwordx2 v[104:105], v15, s[12:15], s29 offen
    buffer_load_dwordx2 v[106:107], v16, s[12:15], s29 offen
    buffer_load_dwordx2 v[108:109], v17, s[12:15], s29 offen
    buffer_load_dwordx2 v[110:111], v18, s[12:15], s29 offen
    buffer_load_dwordx2 v[112:113], v19, s[12:15], s29 offen
    buffer_load_dwordx2 v[114:115], v20, s[12:15], s29 offen
    s_add_u32 s30, s27, 896
    buffer_load_dwordx4 v[48:51], v10, s[8:11], s30 offen offset:0
    buffer_load_dwordx4 v[52:55], v10, s[8:11], s30 offen offset:64
    buffer_load_dwordx4 v[56:59], v11, s[8:11], s30 offen offset:0
    buffer_load_dwordx4 v[60:63], v11, s[8:11], s30 offen offset:64
    ds_read_b64_tr_b16 v[116:117], v30 offset:19456
    ds_read_b64_tr_b16 v[118:119], v30 offset:20608
    ds_read_b64_tr_b16 v[120:121], v30 offset:19488
    ds_read_b64_tr_b16 v[122:123], v30 offset:20640
    ds_read_b64_tr_b16 v[124:125], v30 offset:19520
    ds_read_b64_tr_b16 v[126:127], v30 offset:20672
    ds_read_b64_tr_b16 v[128:129], v30 offset:19552
    ds_read_b64_tr_b16 v[130:131], v30 offset:20704
    ds_read_b64_tr_b16 v[132:133], v30 offset:19584
    ds_read_b64_tr_b16 v[134:135], v30 offset:20736
    ds_read_b64_tr_b16 v[136:137], v30 offset:19616
    ds_read_b64_tr_b16 v[138:139], v30 offset:20768
    ds_read_b64_tr_b16 v[140:141], v30 offset:19648
    ds_read_b64_tr_b16 v[142:143], v30 offset:20800
    ds_read_b64_tr_b16 v[144:145], v30 offset:19680
    ds_read_b64_tr_b16 v[146:147], v30 offset:20832
    ds_read_b64_tr_b16 v[148:149], v30 offset:19712
    ds_read_b64_tr_b16 v[150:151], v30 offset:20864
    s_waitcnt vmcnt(26)
    s_waitcnt lgkmcnt(0)
    v_mfma_f32_16x16x32_bf16 v[156:159], v[116:119], v[64:67], v[156:159]
    v_mfma_f32_16x16x32_bf16 v[192:195], v[116:119], v[72:75], v[192:195]
    v_mfma_f32_16x16x32_bf16 v[160:163], v[120:123], v[64:67], v[160:163]
    v_mfma_f32_16x16x32_bf16 v[196:199], v[120:123], v[72:75], v[196:199]
    v_mfma_f32_16x16x32_bf16 v[164:167], v[124:127], v[64:67], v[164:167]
    v_mfma_f32_16x16x32_bf16 v[200:203], v[124:127], v[72:75], v[200:203]
    v_mfma_f32_16x16x32_bf16 v[168:171], v[128:131], v[64:67], v[168:171]
    v_mfma_f32_16x16x32_bf16 v[204:207], v[128:131], v[72:75], v[204:207]
    v_mfma_f32_16x16x32_bf16 v[172:175], v[132:135], v[64:67], v[172:175]
    v_mfma_f32_16x16x32_bf16 v[208:211], v[132:135], v[72:75], v[208:211]
    v_mfma_f32_16x16x32_bf16 v[176:179], v[136:139], v[64:67], v[176:179]
    v_mfma_f32_16x16x32_bf16 v[212:215], v[136:139], v[72:75], v[212:215]
    v_mfma_f32_16x16x32_bf16 v[180:183], v[140:143], v[64:67], v[180:183]
    v_mfma_f32_16x16x32_bf16 v[216:219], v[140:143], v[72:75], v[216:219]
    v_mfma_f32_16x16x32_bf16 v[184:187], v[144:147], v[64:67], v[184:187]
    v_mfma_f32_16x16x32_bf16 v[220:223], v[144:147], v[72:75], v[220:223]
    v_mfma_f32_16x16x32_bf16 v[188:191], v[148:151], v[64:67], v[188:191]
    v_mfma_f32_16x16x32_bf16 v[224:227], v[148:151], v[72:75], v[224:227]
    ds_read_b64_tr_b16 v[116:117], v30 offset:29184
    ds_read_b64_tr_b16 v[118:119], v30 offset:30336
    ds_read_b64_tr_b16 v[120:121], v30 offset:29216
    ds_read_b64_tr_b16 v[122:123], v30 offset:30368
    ds_read_b64_tr_b16 v[124:125], v30 offset:29248
    ds_read_b64_tr_b16 v[126:127], v30 offset:30400
    ds_read_b64_tr_b16 v[128:129], v30 offset:29280
    ds_read_b64_tr_b16 v[130:131], v30 offset:30432
    ds_read_b64_tr_b16 v[132:133], v30 offset:29312
    ds_read_b64_tr_b16 v[134:135], v30 offset:30464
    ds_read_b64_tr_b16 v[136:137], v30 offset:29344
    ds_read_b64_tr_b16 v[138:139], v30 offset:30496
    ds_read_b64_tr_b16 v[140:141], v30 offset:29376
    ds_read_b64_tr_b16 v[142:143], v30 offset:30528
    ds_read_b64_tr_b16 v[144:145], v30 offset:29408
    ds_read_b64_tr_b16 v[146:147], v30 offset:30560
    ds_read_b64_tr_b16 v[148:149], v30 offset:29440
    ds_read_b64_tr_b16 v[150:151], v30 offset:30592
    s_waitcnt lgkmcnt(0)
    v_mfma_f32_16x16x32_bf16 v[156:159], v[116:119], v[68:71], v[156:159]
    v_mfma_f32_16x16x32_bf16 v[192:195], v[116:119], v[76:79], v[192:195]
    v_mfma_f32_16x16x32_bf16 v[160:163], v[120:123], v[68:71], v[160:163]
    v_mfma_f32_16x16x32_bf16 v[196:199], v[120:123], v[76:79], v[196:199]
    v_mfma_f32_16x16x32_bf16 v[164:167], v[124:127], v[68:71], v[164:167]
    v_mfma_f32_16x16x32_bf16 v[200:203], v[124:127], v[76:79], v[200:203]
    v_mfma_f32_16x16x32_bf16 v[168:171], v[128:131], v[68:71], v[168:171]
    v_mfma_f32_16x16x32_bf16 v[204:207], v[128:131], v[76:79], v[204:207]
    v_mfma_f32_16x16x32_bf16 v[172:175], v[132:135], v[68:71], v[172:175]
    v_mfma_f32_16x16x32_bf16 v[208:211], v[132:135], v[76:79], v[208:211]
    v_mfma_f32_16x16x32_bf16 v[176:179], v[136:139], v[68:71], v[176:179]
    v_mfma_f32_16x16x32_bf16 v[212:215], v[136:139], v[76:79], v[212:215]
    v_mfma_f32_16x16x32_bf16 v[180:183], v[140:143], v[68:71], v[180:183]
    v_mfma_f32_16x16x32_bf16 v[216:219], v[140:143], v[76:79], v[216:219]
    v_mfma_f32_16x16x32_bf16 v[184:187], v[144:147], v[68:71], v[184:187]
    v_mfma_f32_16x16x32_bf16 v[220:223], v[144:147], v[76:79], v[220:223]
    v_mfma_f32_16x16x32_bf16 v[188:191], v[148:151], v[68:71], v[188:191]
    v_mfma_f32_16x16x32_bf16 v[224:227], v[148:151], v[76:79], v[224:227]
    s_waitcnt vmcnt(17)
    ds_write_b64 v21, v[80:81] offset:0
    ds_write_b64 v22, v[82:83] offset:0
    ds_write_b64 v23, v[84:85] offset:0
    ds_write_b64 v24, v[86:87] offset:0
    ds_write_b64 v25, v[88:89] offset:0
    ds_write_b64 v26, v[90:91] offset:0
    ds_write_b64 v27, v[92:93] offset:0
    ds_write_b64 v28, v[94:95] offset:0
    ds_write_b64 v29, v[96:97] offset:0
    s_waitcnt lgkmcnt(0)
    s_barrier
    s_add_u32 s29, s28, 4718592
    buffer_load_dwordx2 v[80:81], v12, s[12:15], s29 offen
    buffer_load_dwordx2 v[82:83], v13, s[12:15], s29 offen
    buffer_load_dwordx2 v[84:85], v14, s[12:15], s29 offen
    buffer_load_dwordx2 v[86:87], v15, s[12:15], s29 offen
    buffer_load_dwordx2 v[88:89], v16, s[12:15], s29 offen
    buffer_load_dwordx2 v[90:91], v17, s[12:15], s29 offen
    buffer_load_dwordx2 v[92:93], v18, s[12:15], s29 offen
    buffer_load_dwordx2 v[94:95], v19, s[12:15], s29 offen
    buffer_load_dwordx2 v[96:97], v20, s[12:15], s29 offen
    s_add_u32 s30, s27, 1024
    buffer_load_dwordx4 v[64:67], v10, s[8:11], s30 offen offset:0
    buffer_load_dwordx4 v[68:71], v10, s[8:11], s30 offen offset:64
    buffer_load_dwordx4 v[72:75], v11, s[8:11], s30 offen offset:0
    buffer_load_dwordx4 v[76:79], v11, s[8:11], s30 offen offset:64
    ds_read_b64_tr_b16 v[116:117], v30 offset:0
    ds_read_b64_tr_b16 v[118:119], v30 offset:1152
    ds_read_b64_tr_b16 v[120:121], v30 offset:32
    ds_read_b64_tr_b16 v[122:123], v30 offset:1184
    ds_read_b64_tr_b16 v[124:125], v30 offset:64
    ds_read_b64_tr_b16 v[126:127], v30 offset:1216
    ds_read_b64_tr_b16 v[128:129], v30 offset:96
    ds_read_b64_tr_b16 v[130:131], v30 offset:1248
    ds_read_b64_tr_b16 v[132:133], v30 offset:128
    ds_read_b64_tr_b16 v[134:135], v30 offset:1280
    ds_read_b64_tr_b16 v[136:137], v30 offset:160
    ds_read_b64_tr_b16 v[138:139], v30 offset:1312
    ds_read_b64_tr_b16 v[140:141], v30 offset:192
    ds_read_b64_tr_b16 v[142:143], v30 offset:1344
    ds_read_b64_tr_b16 v[144:145], v30 offset:224
    ds_read_b64_tr_b16 v[146:147], v30 offset:1376
    ds_read_b64_tr_b16 v[148:149], v30 offset:256
    ds_read_b64_tr_b16 v[150:151], v30 offset:1408
    s_waitcnt vmcnt(26)
    s_waitcnt lgkmcnt(0)
    v_mfma_f32_16x16x32_bf16 v[156:159], v[116:119], v[32:35], v[156:159]
    v_mfma_f32_16x16x32_bf16 v[192:195], v[116:119], v[40:43], v[192:195]
    v_mfma_f32_16x16x32_bf16 v[160:163], v[120:123], v[32:35], v[160:163]
    v_mfma_f32_16x16x32_bf16 v[196:199], v[120:123], v[40:43], v[196:199]
    v_mfma_f32_16x16x32_bf16 v[164:167], v[124:127], v[32:35], v[164:167]
    v_mfma_f32_16x16x32_bf16 v[200:203], v[124:127], v[40:43], v[200:203]
    v_mfma_f32_16x16x32_bf16 v[168:171], v[128:131], v[32:35], v[168:171]
    v_mfma_f32_16x16x32_bf16 v[204:207], v[128:131], v[40:43], v[204:207]
    v_mfma_f32_16x16x32_bf16 v[172:175], v[132:135], v[32:35], v[172:175]
    v_mfma_f32_16x16x32_bf16 v[208:211], v[132:135], v[40:43], v[208:211]
    v_mfma_f32_16x16x32_bf16 v[176:179], v[136:139], v[32:35], v[176:179]
    v_mfma_f32_16x16x32_bf16 v[212:215], v[136:139], v[40:43], v[212:215]
    v_mfma_f32_16x16x32_bf16 v[180:183], v[140:143], v[32:35], v[180:183]
    v_mfma_f32_16x16x32_bf16 v[216:219], v[140:143], v[40:43], v[216:219]
    v_mfma_f32_16x16x32_bf16 v[184:187], v[144:147], v[32:35], v[184:187]
    v_mfma_f32_16x16x32_bf16 v[220:223], v[144:147], v[40:43], v[220:223]
    v_mfma_f32_16x16x32_bf16 v[188:191], v[148:151], v[32:35], v[188:191]
    v_mfma_f32_16x16x32_bf16 v[224:227], v[148:151], v[40:43], v[224:227]
    ds_read_b64_tr_b16 v[116:117], v30 offset:9728
    ds_read_b64_tr_b16 v[118:119], v30 offset:10880
    ds_read_b64_tr_b16 v[120:121], v30 offset:9760
    ds_read_b64_tr_b16 v[122:123], v30 offset:10912
    ds_read_b64_tr_b16 v[124:125], v30 offset:9792
    ds_read_b64_tr_b16 v[126:127], v30 offset:10944
    ds_read_b64_tr_b16 v[128:129], v30 offset:9824
    ds_read_b64_tr_b16 v[130:131], v30 offset:10976
    ds_read_b64_tr_b16 v[132:133], v30 offset:9856
    ds_read_b64_tr_b16 v[134:135], v30 offset:11008
    ds_read_b64_tr_b16 v[136:137], v30 offset:9888
    ds_read_b64_tr_b16 v[138:139], v30 offset:11040
    ds_read_b64_tr_b16 v[140:141], v30 offset:9920
    ds_read_b64_tr_b16 v[142:143], v30 offset:11072
    ds_read_b64_tr_b16 v[144:145], v30 offset:9952
    ds_read_b64_tr_b16 v[146:147], v30 offset:11104
    ds_read_b64_tr_b16 v[148:149], v30 offset:9984
    ds_read_b64_tr_b16 v[150:151], v30 offset:11136
    s_waitcnt lgkmcnt(0)
    v_mfma_f32_16x16x32_bf16 v[156:159], v[116:119], v[36:39], v[156:159]
    v_mfma_f32_16x16x32_bf16 v[192:195], v[116:119], v[44:47], v[192:195]
    v_mfma_f32_16x16x32_bf16 v[160:163], v[120:123], v[36:39], v[160:163]
    v_mfma_f32_16x16x32_bf16 v[196:199], v[120:123], v[44:47], v[196:199]
    v_mfma_f32_16x16x32_bf16 v[164:167], v[124:127], v[36:39], v[164:167]
    v_mfma_f32_16x16x32_bf16 v[200:203], v[124:127], v[44:47], v[200:203]
    v_mfma_f32_16x16x32_bf16 v[168:171], v[128:131], v[36:39], v[168:171]
    v_mfma_f32_16x16x32_bf16 v[204:207], v[128:131], v[44:47], v[204:207]
    v_mfma_f32_16x16x32_bf16 v[172:175], v[132:135], v[36:39], v[172:175]
    v_mfma_f32_16x16x32_bf16 v[208:211], v[132:135], v[44:47], v[208:211]
    v_mfma_f32_16x16x32_bf16 v[176:179], v[136:139], v[36:39], v[176:179]
    v_mfma_f32_16x16x32_bf16 v[212:215], v[136:139], v[44:47], v[212:215]
    v_mfma_f32_16x16x32_bf16 v[180:183], v[140:143], v[36:39], v[180:183]
    v_mfma_f32_16x16x32_bf16 v[216:219], v[140:143], v[44:47], v[216:219]
    v_mfma_f32_16x16x32_bf16 v[184:187], v[144:147], v[36:39], v[184:187]
    v_mfma_f32_16x16x32_bf16 v[220:223], v[144:147], v[44:47], v[220:223]
    v_mfma_f32_16x16x32_bf16 v[188:191], v[148:151], v[36:39], v[188:191]
    v_mfma_f32_16x16x32_bf16 v[224:227], v[148:151], v[44:47], v[224:227]
    s_waitcnt vmcnt(17)
    ds_write_b64 v21, v[98:99] offset:19456
    ds_write_b64 v22, v[100:101] offset:19456
    ds_write_b64 v23, v[102:103] offset:19456
    ds_write_b64 v24, v[104:105] offset:19456
    ds_write_b64 v25, v[106:107] offset:19456
    ds_write_b64 v26, v[108:109] offset:19456
    ds_write_b64 v27, v[110:111] offset:19456
    ds_write_b64 v28, v[112:113] offset:19456
    ds_write_b64 v29, v[114:115] offset:19456
    s_waitcnt lgkmcnt(0)
    s_barrier
    ds_read_b64_tr_b16 v[116:117], v30 offset:19456
    ds_read_b64_tr_b16 v[118:119], v30 offset:20608
    ds_read_b64_tr_b16 v[120:121], v30 offset:19488
    ds_read_b64_tr_b16 v[122:123], v30 offset:20640
    ds_read_b64_tr_b16 v[124:125], v30 offset:19520
    ds_read_b64_tr_b16 v[126:127], v30 offset:20672
    ds_read_b64_tr_b16 v[128:129], v30 offset:19552
    ds_read_b64_tr_b16 v[130:131], v30 offset:20704
    ds_read_b64_tr_b16 v[132:133], v30 offset:19584
    ds_read_b64_tr_b16 v[134:135], v30 offset:20736
    ds_read_b64_tr_b16 v[136:137], v30 offset:19616
    ds_read_b64_tr_b16 v[138:139], v30 offset:20768
    ds_read_b64_tr_b16 v[140:141], v30 offset:19648
    ds_read_b64_tr_b16 v[142:143], v30 offset:20800
    ds_read_b64_tr_b16 v[144:145], v30 offset:19680
    ds_read_b64_tr_b16 v[146:147], v30 offset:20832
    ds_read_b64_tr_b16 v[148:149], v30 offset:19712
    ds_read_b64_tr_b16 v[150:151], v30 offset:20864
    s_waitcnt vmcnt(13)
    s_waitcnt lgkmcnt(0)
    v_mfma_f32_16x16x32_bf16 v[156:159], v[116:119], v[48:51], v[156:159]
    v_mfma_f32_16x16x32_bf16 v[192:195], v[116:119], v[56:59], v[192:195]
    v_mfma_f32_16x16x32_bf16 v[160:163], v[120:123], v[48:51], v[160:163]
    v_mfma_f32_16x16x32_bf16 v[196:199], v[120:123], v[56:59], v[196:199]
    v_mfma_f32_16x16x32_bf16 v[164:167], v[124:127], v[48:51], v[164:167]
    v_mfma_f32_16x16x32_bf16 v[200:203], v[124:127], v[56:59], v[200:203]
    v_mfma_f32_16x16x32_bf16 v[168:171], v[128:131], v[48:51], v[168:171]
    v_mfma_f32_16x16x32_bf16 v[204:207], v[128:131], v[56:59], v[204:207]
    v_mfma_f32_16x16x32_bf16 v[172:175], v[132:135], v[48:51], v[172:175]
    v_mfma_f32_16x16x32_bf16 v[208:211], v[132:135], v[56:59], v[208:211]
    v_mfma_f32_16x16x32_bf16 v[176:179], v[136:139], v[48:51], v[176:179]
    v_mfma_f32_16x16x32_bf16 v[212:215], v[136:139], v[56:59], v[212:215]
    v_mfma_f32_16x16x32_bf16 v[180:183], v[140:143], v[48:51], v[180:183]
    v_mfma_f32_16x16x32_bf16 v[216:219], v[140:143], v[56:59], v[216:219]
    v_mfma_f32_16x16x32_bf16 v[184:187], v[144:147], v[48:51], v[184:187]
    v_mfma_f32_16x16x32_bf16 v[220:223], v[144:147], v[56:59], v[220:223]
    v_mfma_f32_16x16x32_bf16 v[188:191], v[148:151], v[48:51], v[188:191]
    v_mfma_f32_16x16x32_bf16 v[224:227], v[148:151], v[56:59], v[224:227]
    ds_read_b64_tr_b16 v[116:117], v30 offset:29184
    ds_read_b64_tr_b16 v[118:119], v30 offset:30336
    ds_read_b64_tr_b16 v[120:121], v30 offset:29216
    ds_read_b64_tr_b16 v[122:123], v30 offset:30368
    ds_read_b64_tr_b16 v[124:125], v30 offset:29248
    ds_read_b64_tr_b16 v[126:127], v30 offset:30400
    ds_read_b64_tr_b16 v[128:129], v30 offset:29280
    ds_read_b64_tr_b16 v[130:131], v30 offset:30432
    ds_read_b64_tr_b16 v[132:133], v30 offset:29312
    ds_read_b64_tr_b16 v[134:135], v30 offset:30464
    ds_read_b64_tr_b16 v[136:137], v30 offset:29344
    ds_read_b64_tr_b16 v[138:139], v30 offset:30496
    ds_read_b64_tr_b16 v[140:141], v30 offset:29376
    ds_read_b64_tr_b16 v[142:143], v30 offset:30528
    ds_read_b64_tr_b16 v[144:145], v30 offset:29408
    ds_read_b64_tr_b16 v[146:147], v30 offset:30560
    ds_read_b64_tr_b16 v[148:149], v30 offset:29440
    ds_read_b64_tr_b16 v[150:151], v30 offset:30592
    s_waitcnt lgkmcnt(0)
    v_mfma_f32_16x16x32_bf16 v[156:159], v[116:119], v[52:55], v[156:159]
    v_mfma_f32_16x16x32_bf16 v[192:195], v[116:119], v[60:63], v[192:195]
    v_mfma_f32_16x16x32_bf16 v[160:163], v[120:123], v[52:55], v[160:163]
    v_mfma_f32_16x16x32_bf16 v[196:199], v[120:123], v[60:63], v[196:199]
    v_mfma_f32_16x16x32_bf16 v[164:167], v[124:127], v[52:55], v[164:167]
    v_mfma_f32_16x16x32_bf16 v[200:203], v[124:127], v[60:63], v[200:203]
    v_mfma_f32_16x16x32_bf16 v[168:171], v[128:131], v[52:55], v[168:171]
    v_mfma_f32_16x16x32_bf16 v[204:207], v[128:131], v[60:63], v[204:207]
    v_mfma_f32_16x16x32_bf16 v[172:175], v[132:135], v[52:55], v[172:175]
    v_mfma_f32_16x16x32_bf16 v[208:211], v[132:135], v[60:63], v[208:211]
    v_mfma_f32_16x16x32_bf16 v[176:179], v[136:139], v[52:55], v[176:179]
    v_mfma_f32_16x16x32_bf16 v[212:215], v[136:139], v[60:63], v[212:215]
    v_mfma_f32_16x16x32_bf16 v[180:183], v[140:143], v[52:55], v[180:183]
    v_mfma_f32_16x16x32_bf16 v[216:219], v[140:143], v[60:63], v[216:219]
    v_mfma_f32_16x16x32_bf16 v[184:187], v[144:147], v[52:55], v[184:187]
    v_mfma_f32_16x16x32_bf16 v[220:223], v[144:147], v[60:63], v[220:223]
    v_mfma_f32_16x16x32_bf16 v[188:191], v[148:151], v[52:55], v[188:191]
    v_mfma_f32_16x16x32_bf16 v[224:227], v[148:151], v[60:63], v[224:227]
    s_waitcnt vmcnt(4)
    ds_write_b64 v21, v[80:81] offset:0
    ds_write_b64 v22, v[82:83] offset:0
    ds_write_b64 v23, v[84:85] offset:0
    ds_write_b64 v24, v[86:87] offset:0
    ds_write_b64 v25, v[88:89] offset:0
    ds_write_b64 v26, v[90:91] offset:0
    ds_write_b64 v27, v[92:93] offset:0
    ds_write_b64 v28, v[94:95] offset:0
    ds_write_b64 v29, v[96:97] offset:0
    s_waitcnt lgkmcnt(0)
    s_barrier
    ds_read_b64_tr_b16 v[116:117], v30 offset:0
    ds_read_b64_tr_b16 v[118:119], v30 offset:1152
    ds_read_b64_tr_b16 v[120:121], v30 offset:32
    ds_read_b64_tr_b16 v[122:123], v30 offset:1184
    ds_read_b64_tr_b16 v[124:125], v30 offset:64
    ds_read_b64_tr_b16 v[126:127], v30 offset:1216
    ds_read_b64_tr_b16 v[128:129], v30 offset:96
    ds_read_b64_tr_b16 v[130:131], v30 offset:1248
    ds_read_b64_tr_b16 v[132:133], v30 offset:128
    ds_read_b64_tr_b16 v[134:135], v30 offset:1280
    ds_read_b64_tr_b16 v[136:137], v30 offset:160
    ds_read_b64_tr_b16 v[138:139], v30 offset:1312
    ds_read_b64_tr_b16 v[140:141], v30 offset:192
    ds_read_b64_tr_b16 v[142:143], v30 offset:1344
    ds_read_b64_tr_b16 v[144:145], v30 offset:224
    ds_read_b64_tr_b16 v[146:147], v30 offset:1376
    ds_read_b64_tr_b16 v[148:149], v30 offset:256
    ds_read_b64_tr_b16 v[150:151], v30 offset:1408
    s_waitcnt vmcnt(0)
    s_waitcnt lgkmcnt(0)
    v_mfma_f32_16x16x32_bf16 v[156:159], v[116:119], v[64:67], v[156:159]
    v_mfma_f32_16x16x32_bf16 v[192:195], v[116:119], v[72:75], v[192:195]
    v_mfma_f32_16x16x32_bf16 v[160:163], v[120:123], v[64:67], v[160:163]
    v_mfma_f32_16x16x32_bf16 v[196:199], v[120:123], v[72:75], v[196:199]
    v_mfma_f32_16x16x32_bf16 v[164:167], v[124:127], v[64:67], v[164:167]
    v_mfma_f32_16x16x32_bf16 v[200:203], v[124:127], v[72:75], v[200:203]
    v_mfma_f32_16x16x32_bf16 v[168:171], v[128:131], v[64:67], v[168:171]
    v_mfma_f32_16x16x32_bf16 v[204:207], v[128:131], v[72:75], v[204:207]
    v_mfma_f32_16x16x32_bf16 v[172:175], v[132:135], v[64:67], v[172:175]
    v_mfma_f32_16x16x32_bf16 v[208:211], v[132:135], v[72:75], v[208:211]
    v_mfma_f32_16x16x32_bf16 v[176:179], v[136:139], v[64:67], v[176:179]
    v_mfma_f32_16x16x32_bf16 v[212:215], v[136:139], v[72:75], v[212:215]
    v_mfma_f32_16x16x32_bf16 v[180:183], v[140:143], v[64:67], v[180:183]
    v_mfma_f32_16x16x32_bf16 v[216:219], v[140:143], v[72:75], v[216:219]
    v_mfma_f32_16x16x32_bf16 v[184:187], v[144:147], v[64:67], v[184:187]
    v_mfma_f32_16x16x32_bf16 v[220:223], v[144:147], v[72:75], v[220:223]
    v_mfma_f32_16x16x32_bf16 v[188:191], v[148:151], v[64:67], v[188:191]
    v_mfma_f32_16x16x32_bf16 v[224:227], v[148:151], v[72:75], v[224:227]
    ds_read_b64_tr_b16 v[116:117], v30 offset:9728
    ds_read_b64_tr_b16 v[118:119], v30 offset:10880
    ds_read_b64_tr_b16 v[120:121], v30 offset:9760
    ds_read_b64_tr_b16 v[122:123], v30 offset:10912
    ds_read_b64_tr_b16 v[124:125], v30 offset:9792
    ds_read_b64_tr_b16 v[126:127], v30 offset:10944
    ds_read_b64_tr_b16 v[128:129], v30 offset:9824
    ds_read_b64_tr_b16 v[130:131], v30 offset:10976
    ds_read_b64_tr_b16 v[132:133], v30 offset:9856
    ds_read_b64_tr_b16 v[134:135], v30 offset:11008
    ds_read_b64_tr_b16 v[136:137], v30 offset:9888
    ds_read_b64_tr_b16 v[138:139], v30 offset:11040
    ds_read_b64_tr_b16 v[140:141], v30 offset:9920
    ds_read_b64_tr_b16 v[142:143], v30 offset:11072
    ds_read_b64_tr_b16 v[144:145], v30 offset:9952
    ds_read_b64_tr_b16 v[146:147], v30 offset:11104
    ds_read_b64_tr_b16 v[148:149], v30 offset:9984
    ds_read_b64_tr_b16 v[150:151], v30 offset:11136
    s_waitcnt lgkmcnt(0)
    v_mfma_f32_16x16x32_bf16 v[156:159], v[116:119], v[68:71], v[156:159]
    v_mfma_f32_16x16x32_bf16 v[192:195], v[116:119], v[76:79], v[192:195]
    v_mfma_f32_16x16x32_bf16 v[160:163], v[120:123], v[68:71], v[160:163]
    v_mfma_f32_16x16x32_bf16 v[196:199], v[120:123], v[76:79], v[196:199]
    v_mfma_f32_16x16x32_bf16 v[164:167], v[124:127], v[68:71], v[164:167]
    v_mfma_f32_16x16x32_bf16 v[200:203], v[124:127], v[76:79], v[200:203]
    v_mfma_f32_16x16x32_bf16 v[168:171], v[128:131], v[68:71], v[168:171]
    v_mfma_f32_16x16x32_bf16 v[204:207], v[128:131], v[76:79], v[204:207]
    v_mfma_f32_16x16x32_bf16 v[172:175], v[132:135], v[68:71], v[172:175]
    v_mfma_f32_16x16x32_bf16 v[208:211], v[132:135], v[76:79], v[208:211]
    v_mfma_f32_16x16x32_bf16 v[176:179], v[136:139], v[68:71], v[176:179]
    v_mfma_f32_16x16x32_bf16 v[212:215], v[136:139], v[76:79], v[212:215]
    v_mfma_f32_16x16x32_bf16 v[180:183], v[140:143], v[68:71], v[180:183]
    v_mfma_f32_16x16x32_bf16 v[216:219], v[140:143], v[76:79], v[216:219]
    v_mfma_f32_16x16x32_bf16 v[184:187], v[144:147], v[68:71], v[184:187]
    v_mfma_f32_16x16x32_bf16 v[220:223], v[144:147], v[76:79], v[220:223]
    v_mfma_f32_16x16x32_bf16 v[188:191], v[148:151], v[68:71], v[188:191]
    v_mfma_f32_16x16x32_bf16 v[224:227], v[148:151], v[76:79], v[224:227]
    s_nop 15
    s_nop 3
    s_add_u32 s32, s16, 16777216
    s_addc_u32 s33, s17, 0
    s_mov_b32 s34, 18874368
    s_mov_b32 s35, 0x00020000
    s_mul_i32 s31, s22, 288
    v_mul_u32_u24 v7, 8, v4
    v_add_u32 v7, s31, v7
    s_mov_b32 s25, 9216
    v_add_u32 v6, 0, v5
    v_mul_lo_u32 v6, v6, s25
    v_add_u32 v60, v6, v7
    v_add_u32 v6, 16, v5
    v_mul_lo_u32 v6, v6, s25
    v_add_u32 v61, v6, v7
    s_load_dwordx2 s[36:37], s[0:1], 48
    s_mul_i32 s31, s22, 288
    v_lshlrev_b32 v8, 3, v4
    s_waitcnt lgkmcnt(0)
    s_mov_b32 s40, s36
    s_mov_b32 s41, s37
    s_mov_b32 s42, 9216
    s_mov_b32 s43, 0x00020000
    buffer_load_dwordx2 v[64:65], v8, s[40:43], s31 offen offset:0
    buffer_load_dwordx2 v[66:67], v8, s[40:43], s31 offen offset:32
    buffer_load_dwordx2 v[68:69], v8, s[40:43], s31 offen offset:64
    buffer_load_dwordx2 v[70:71], v8, s[40:43], s31 offen offset:96
    buffer_load_dwordx2 v[72:73], v8, s[40:43], s31 offen offset:128
    buffer_load_dwordx2 v[74:75], v8, s[40:43], s31 offen offset:160
    buffer_load_dwordx2 v[76:77], v8, s[40:43], s31 offen offset:192
    buffer_load_dwordx2 v[78:79], v8, s[40:43], s31 offen offset:224
    buffer_load_dwordx2 v[80:81], v8, s[40:43], s31 offen offset:256
    s_waitcnt vmcnt(0)
    s_mov_b32 s44, 0xc0135761
    s_mov_b32 s45, 0xbdd2d3e8
    v_lshlrev_b32 v84, 16, v64
    v_and_b32 v85, 0xffff0000, v64
    v_lshlrev_b32 v86, 16, v65
    v_and_b32 v87, 0xffff0000, v65
    v_add_f32 v156, v156, v84
    v_add_f32 v157, v157, v85
    v_add_f32 v158, v158, v86
    v_add_f32 v159, v159, v87
    v_mul_f32 v88, v156, v156
    v_mul_f32 v89, v157, v157
    v_mul_f32 v90, v158, v158
    v_mul_f32 v91, v159, v159
    v_mov_b32 v92, s44
    v_mov_b32 v93, s44
    v_mov_b32 v94, s44
    v_mov_b32 v95, s44
    v_fmac_f32 v92, s45, v88
    v_fmac_f32 v93, s45, v89
    v_fmac_f32 v94, s45, v90
    v_fmac_f32 v95, s45, v91
    v_mul_f32 v92, v92, v156
    v_mul_f32 v93, v93, v157
    v_mul_f32 v94, v94, v158
    v_mul_f32 v95, v95, v159
    v_exp_f32 v92, v92
    v_exp_f32 v93, v93
    v_exp_f32 v94, v94
    v_exp_f32 v95, v95
    v_add_f32 v92, 1.0, v92
    v_add_f32 v93, 1.0, v93
    v_add_f32 v94, 1.0, v94
    v_add_f32 v95, 1.0, v95
    v_rcp_f32 v92, v92
    v_rcp_f32 v93, v93
    v_rcp_f32 v94, v94
    v_rcp_f32 v95, v95
    v_mul_f32 v156, v156, v92
    v_mul_f32 v157, v157, v93
    v_mul_f32 v158, v158, v94
    v_mul_f32 v159, v159, v95
    v_cvt_pk_bf16_f32 v156, v156, v157
    v_cvt_pk_bf16_f32 v157, v158, v159
    buffer_store_dwordx2 v[156:157], v60, s[32:35], 0 offen offset:0
    v_lshlrev_b32 v84, 16, v66
    v_and_b32 v85, 0xffff0000, v66
    v_lshlrev_b32 v86, 16, v67
    v_and_b32 v87, 0xffff0000, v67
    v_add_f32 v160, v160, v84
    v_add_f32 v161, v161, v85
    v_add_f32 v162, v162, v86
    v_add_f32 v163, v163, v87
    v_mul_f32 v88, v160, v160
    v_mul_f32 v89, v161, v161
    v_mul_f32 v90, v162, v162
    v_mul_f32 v91, v163, v163
    v_mov_b32 v92, s44
    v_mov_b32 v93, s44
    v_mov_b32 v94, s44
    v_mov_b32 v95, s44
    v_fmac_f32 v92, s45, v88
    v_fmac_f32 v93, s45, v89
    v_fmac_f32 v94, s45, v90
    v_fmac_f32 v95, s45, v91
    v_mul_f32 v92, v92, v160
    v_mul_f32 v93, v93, v161
    v_mul_f32 v94, v94, v162
    v_mul_f32 v95, v95, v163
    v_exp_f32 v92, v92
    v_exp_f32 v93, v93
    v_exp_f32 v94, v94
    v_exp_f32 v95, v95
    v_add_f32 v92, 1.0, v92
    v_add_f32 v93, 1.0, v93
    v_add_f32 v94, 1.0, v94
    v_add_f32 v95, 1.0, v95
    v_rcp_f32 v92, v92
    v_rcp_f32 v93, v93
    v_rcp_f32 v94, v94
    v_rcp_f32 v95, v95
    v_mul_f32 v160, v160, v92
    v_mul_f32 v161, v161, v93
    v_mul_f32 v162, v162, v94
    v_mul_f32 v163, v163, v95
    v_cvt_pk_bf16_f32 v160, v160, v161
    v_cvt_pk_bf16_f32 v161, v162, v163
    buffer_store_dwordx2 v[160:161], v60, s[32:35], 0 offen offset:32
    v_lshlrev_b32 v84, 16, v68
    v_and_b32 v85, 0xffff0000, v68
    v_lshlrev_b32 v86, 16, v69
    v_and_b32 v87, 0xffff0000, v69
    v_add_f32 v164, v164, v84
    v_add_f32 v165, v165, v85
    v_add_f32 v166, v166, v86
    v_add_f32 v167, v167, v87
    v_mul_f32 v88, v164, v164
    v_mul_f32 v89, v165, v165
    v_mul_f32 v90, v166, v166
    v_mul_f32 v91, v167, v167
    v_mov_b32 v92, s44
    v_mov_b32 v93, s44
    v_mov_b32 v94, s44
    v_mov_b32 v95, s44
    v_fmac_f32 v92, s45, v88
    v_fmac_f32 v93, s45, v89
    v_fmac_f32 v94, s45, v90
    v_fmac_f32 v95, s45, v91
    v_mul_f32 v92, v92, v164
    v_mul_f32 v93, v93, v165
    v_mul_f32 v94, v94, v166
    v_mul_f32 v95, v95, v167
    v_exp_f32 v92, v92
    v_exp_f32 v93, v93
    v_exp_f32 v94, v94
    v_exp_f32 v95, v95
    v_add_f32 v92, 1.0, v92
    v_add_f32 v93, 1.0, v93
    v_add_f32 v94, 1.0, v94
    v_add_f32 v95, 1.0, v95
    v_rcp_f32 v92, v92
    v_rcp_f32 v93, v93
    v_rcp_f32 v94, v94
    v_rcp_f32 v95, v95
    v_mul_f32 v164, v164, v92
    v_mul_f32 v165, v165, v93
    v_mul_f32 v166, v166, v94
    v_mul_f32 v167, v167, v95
    v_cvt_pk_bf16_f32 v164, v164, v165
    v_cvt_pk_bf16_f32 v165, v166, v167
    buffer_store_dwordx2 v[164:165], v60, s[32:35], 0 offen offset:64
    v_lshlrev_b32 v84, 16, v70
    v_and_b32 v85, 0xffff0000, v70
    v_lshlrev_b32 v86, 16, v71
    v_and_b32 v87, 0xffff0000, v71
    v_add_f32 v168, v168, v84
    v_add_f32 v169, v169, v85
    v_add_f32 v170, v170, v86
    v_add_f32 v171, v171, v87
    v_mul_f32 v88, v168, v168
    v_mul_f32 v89, v169, v169
    v_mul_f32 v90, v170, v170
    v_mul_f32 v91, v171, v171
    v_mov_b32 v92, s44
    v_mov_b32 v93, s44
    v_mov_b32 v94, s44
    v_mov_b32 v95, s44
    v_fmac_f32 v92, s45, v88
    v_fmac_f32 v93, s45, v89
    v_fmac_f32 v94, s45, v90
    v_fmac_f32 v95, s45, v91
    v_mul_f32 v92, v92, v168
    v_mul_f32 v93, v93, v169
    v_mul_f32 v94, v94, v170
    v_mul_f32 v95, v95, v171
    v_exp_f32 v92, v92
    v_exp_f32 v93, v93
    v_exp_f32 v94, v94
    v_exp_f32 v95, v95
    v_add_f32 v92, 1.0, v92
    v_add_f32 v93, 1.0, v93
    v_add_f32 v94, 1.0, v94
    v_add_f32 v95, 1.0, v95
    v_rcp_f32 v92, v92
    v_rcp_f32 v93, v93
    v_rcp_f32 v94, v94
    v_rcp_f32 v95, v95
    v_mul_f32 v168, v168, v92
    v_mul_f32 v169, v169, v93
    v_mul_f32 v170, v170, v94
    v_mul_f32 v171, v171, v95
    v_cvt_pk_bf16_f32 v168, v168, v169
    v_cvt_pk_bf16_f32 v169, v170, v171
    buffer_store_dwordx2 v[168:169], v60, s[32:35], 0 offen offset:96
    v_lshlrev_b32 v84, 16, v72
    v_and_b32 v85, 0xffff0000, v72
    v_lshlrev_b32 v86, 16, v73
    v_and_b32 v87, 0xffff0000, v73
    v_add_f32 v172, v172, v84
    v_add_f32 v173, v173, v85
    v_add_f32 v174, v174, v86
    v_add_f32 v175, v175, v87
    v_mul_f32 v88, v172, v172
    v_mul_f32 v89, v173, v173
    v_mul_f32 v90, v174, v174
    v_mul_f32 v91, v175, v175
    v_mov_b32 v92, s44
    v_mov_b32 v93, s44
    v_mov_b32 v94, s44
    v_mov_b32 v95, s44
    v_fmac_f32 v92, s45, v88
    v_fmac_f32 v93, s45, v89
    v_fmac_f32 v94, s45, v90
    v_fmac_f32 v95, s45, v91
    v_mul_f32 v92, v92, v172
    v_mul_f32 v93, v93, v173
    v_mul_f32 v94, v94, v174
    v_mul_f32 v95, v95, v175
    v_exp_f32 v92, v92
    v_exp_f32 v93, v93
    v_exp_f32 v94, v94
    v_exp_f32 v95, v95
    v_add_f32 v92, 1.0, v92
    v_add_f32 v93, 1.0, v93
    v_add_f32 v94, 1.0, v94
    v_add_f32 v95, 1.0, v95
    v_rcp_f32 v92, v92
    v_rcp_f32 v93, v93
    v_rcp_f32 v94, v94
    v_rcp_f32 v95, v95
    v_mul_f32 v172, v172, v92
    v_mul_f32 v173, v173, v93
    v_mul_f32 v174, v174, v94
    v_mul_f32 v175, v175, v95
    v_cvt_pk_bf16_f32 v172, v172, v173
    v_cvt_pk_bf16_f32 v173, v174, v175
    buffer_store_dwordx2 v[172:173], v60, s[32:35], 0 offen offset:128
    v_lshlrev_b32 v84, 16, v74
    v_and_b32 v85, 0xffff0000, v74
    v_lshlrev_b32 v86, 16, v75
    v_and_b32 v87, 0xffff0000, v75
    v_add_f32 v176, v176, v84
    v_add_f32 v177, v177, v85
    v_add_f32 v178, v178, v86
    v_add_f32 v179, v179, v87
    v_mul_f32 v88, v176, v176
    v_mul_f32 v89, v177, v177
    v_mul_f32 v90, v178, v178
    v_mul_f32 v91, v179, v179
    v_mov_b32 v92, s44
    v_mov_b32 v93, s44
    v_mov_b32 v94, s44
    v_mov_b32 v95, s44
    v_fmac_f32 v92, s45, v88
    v_fmac_f32 v93, s45, v89
    v_fmac_f32 v94, s45, v90
    v_fmac_f32 v95, s45, v91
    v_mul_f32 v92, v92, v176
    v_mul_f32 v93, v93, v177
    v_mul_f32 v94, v94, v178
    v_mul_f32 v95, v95, v179
    v_exp_f32 v92, v92
    v_exp_f32 v93, v93
    v_exp_f32 v94, v94
    v_exp_f32 v95, v95
    v_add_f32 v92, 1.0, v92
    v_add_f32 v93, 1.0, v93
    v_add_f32 v94, 1.0, v94
    v_add_f32 v95, 1.0, v95
    v_rcp_f32 v92, v92
    v_rcp_f32 v93, v93
    v_rcp_f32 v94, v94
    v_rcp_f32 v95, v95
    v_mul_f32 v176, v176, v92
    v_mul_f32 v177, v177, v93
    v_mul_f32 v178, v178, v94
    v_mul_f32 v179, v179, v95
    v_cvt_pk_bf16_f32 v176, v176, v177
    v_cvt_pk_bf16_f32 v177, v178, v179
    buffer_store_dwordx2 v[176:177], v60, s[32:35], 0 offen offset:160
    v_lshlrev_b32 v84, 16, v76
    v_and_b32 v85, 0xffff0000, v76
    v_lshlrev_b32 v86, 16, v77
    v_and_b32 v87, 0xffff0000, v77
    v_add_f32 v180, v180, v84
    v_add_f32 v181, v181, v85
    v_add_f32 v182, v182, v86
    v_add_f32 v183, v183, v87
    v_mul_f32 v88, v180, v180
    v_mul_f32 v89, v181, v181
    v_mul_f32 v90, v182, v182
    v_mul_f32 v91, v183, v183
    v_mov_b32 v92, s44
    v_mov_b32 v93, s44
    v_mov_b32 v94, s44
    v_mov_b32 v95, s44
    v_fmac_f32 v92, s45, v88
    v_fmac_f32 v93, s45, v89
    v_fmac_f32 v94, s45, v90
    v_fmac_f32 v95, s45, v91
    v_mul_f32 v92, v92, v180
    v_mul_f32 v93, v93, v181
    v_mul_f32 v94, v94, v182
    v_mul_f32 v95, v95, v183
    v_exp_f32 v92, v92
    v_exp_f32 v93, v93
    v_exp_f32 v94, v94
    v_exp_f32 v95, v95
    v_add_f32 v92, 1.0, v92
    v_add_f32 v93, 1.0, v93
    v_add_f32 v94, 1.0, v94
    v_add_f32 v95, 1.0, v95
    v_rcp_f32 v92, v92
    v_rcp_f32 v93, v93
    v_rcp_f32 v94, v94
    v_rcp_f32 v95, v95
    v_mul_f32 v180, v180, v92
    v_mul_f32 v181, v181, v93
    v_mul_f32 v182, v182, v94
    v_mul_f32 v183, v183, v95
    v_cvt_pk_bf16_f32 v180, v180, v181
    v_cvt_pk_bf16_f32 v181, v182, v183
    buffer_store_dwordx2 v[180:181], v60, s[32:35], 0 offen offset:192
    v_lshlrev_b32 v84, 16, v78
    v_and_b32 v85, 0xffff0000, v78
    v_lshlrev_b32 v86, 16, v79
    v_and_b32 v87, 0xffff0000, v79
    v_add_f32 v184, v184, v84
    v_add_f32 v185, v185, v85
    v_add_f32 v186, v186, v86
    v_add_f32 v187, v187, v87
    v_mul_f32 v88, v184, v184
    v_mul_f32 v89, v185, v185
    v_mul_f32 v90, v186, v186
    v_mul_f32 v91, v187, v187
    v_mov_b32 v92, s44
    v_mov_b32 v93, s44
    v_mov_b32 v94, s44
    v_mov_b32 v95, s44
    v_fmac_f32 v92, s45, v88
    v_fmac_f32 v93, s45, v89
    v_fmac_f32 v94, s45, v90
    v_fmac_f32 v95, s45, v91
    v_mul_f32 v92, v92, v184
    v_mul_f32 v93, v93, v185
    v_mul_f32 v94, v94, v186
    v_mul_f32 v95, v95, v187
    v_exp_f32 v92, v92
    v_exp_f32 v93, v93
    v_exp_f32 v94, v94
    v_exp_f32 v95, v95
    v_add_f32 v92, 1.0, v92
    v_add_f32 v93, 1.0, v93
    v_add_f32 v94, 1.0, v94
    v_add_f32 v95, 1.0, v95
    v_rcp_f32 v92, v92
    v_rcp_f32 v93, v93
    v_rcp_f32 v94, v94
    v_rcp_f32 v95, v95
    v_mul_f32 v184, v184, v92
    v_mul_f32 v185, v185, v93
    v_mul_f32 v186, v186, v94
    v_mul_f32 v187, v187, v95
    v_cvt_pk_bf16_f32 v184, v184, v185
    v_cvt_pk_bf16_f32 v185, v186, v187
    buffer_store_dwordx2 v[184:185], v60, s[32:35], 0 offen offset:224
    v_lshlrev_b32 v84, 16, v80
    v_and_b32 v85, 0xffff0000, v80
    v_lshlrev_b32 v86, 16, v81
    v_and_b32 v87, 0xffff0000, v81
    v_add_f32 v188, v188, v84
    v_add_f32 v189, v189, v85
    v_add_f32 v190, v190, v86
    v_add_f32 v191, v191, v87
    v_mul_f32 v88, v188, v188
    v_mul_f32 v89, v189, v189
    v_mul_f32 v90, v190, v190
    v_mul_f32 v91, v191, v191
    v_mov_b32 v92, s44
    v_mov_b32 v93, s44
    v_mov_b32 v94, s44
    v_mov_b32 v95, s44
    v_fmac_f32 v92, s45, v88
    v_fmac_f32 v93, s45, v89
    v_fmac_f32 v94, s45, v90
    v_fmac_f32 v95, s45, v91
    v_mul_f32 v92, v92, v188
    v_mul_f32 v93, v93, v189
    v_mul_f32 v94, v94, v190
    v_mul_f32 v95, v95, v191
    v_exp_f32 v92, v92
    v_exp_f32 v93, v93
    v_exp_f32 v94, v94
    v_exp_f32 v95, v95
    v_add_f32 v92, 1.0, v92
    v_add_f32 v93, 1.0, v93
    v_add_f32 v94, 1.0, v94
    v_add_f32 v95, 1.0, v95
    v_rcp_f32 v92, v92
    v_rcp_f32 v93, v93
    v_rcp_f32 v94, v94
    v_rcp_f32 v95, v95
    v_mul_f32 v188, v188, v92
    v_mul_f32 v189, v189, v93
    v_mul_f32 v190, v190, v94
    v_mul_f32 v191, v191, v95
    v_cvt_pk_bf16_f32 v188, v188, v189
    v_cvt_pk_bf16_f32 v189, v190, v191
    buffer_store_dwordx2 v[188:189], v60, s[32:35], 0 offen offset:256
    v_lshlrev_b32 v84, 16, v64
    v_and_b32 v85, 0xffff0000, v64
    v_lshlrev_b32 v86, 16, v65
    v_and_b32 v87, 0xffff0000, v65
    v_add_f32 v192, v192, v84
    v_add_f32 v193, v193, v85
    v_add_f32 v194, v194, v86
    v_add_f32 v195, v195, v87
    v_mul_f32 v88, v192, v192
    v_mul_f32 v89, v193, v193
    v_mul_f32 v90, v194, v194
    v_mul_f32 v91, v195, v195
    v_mov_b32 v92, s44
    v_mov_b32 v93, s44
    v_mov_b32 v94, s44
    v_mov_b32 v95, s44
    v_fmac_f32 v92, s45, v88
    v_fmac_f32 v93, s45, v89
    v_fmac_f32 v94, s45, v90
    v_fmac_f32 v95, s45, v91
    v_mul_f32 v92, v92, v192
    v_mul_f32 v93, v93, v193
    v_mul_f32 v94, v94, v194
    v_mul_f32 v95, v95, v195
    v_exp_f32 v92, v92
    v_exp_f32 v93, v93
    v_exp_f32 v94, v94
    v_exp_f32 v95, v95
    v_add_f32 v92, 1.0, v92
    v_add_f32 v93, 1.0, v93
    v_add_f32 v94, 1.0, v94
    v_add_f32 v95, 1.0, v95
    v_rcp_f32 v92, v92
    v_rcp_f32 v93, v93
    v_rcp_f32 v94, v94
    v_rcp_f32 v95, v95
    v_mul_f32 v192, v192, v92
    v_mul_f32 v193, v193, v93
    v_mul_f32 v194, v194, v94
    v_mul_f32 v195, v195, v95
    v_cvt_pk_bf16_f32 v192, v192, v193
    v_cvt_pk_bf16_f32 v193, v194, v195
    buffer_store_dwordx2 v[192:193], v61, s[32:35], 0 offen offset:0
    v_lshlrev_b32 v84, 16, v66
    v_and_b32 v85, 0xffff0000, v66
    v_lshlrev_b32 v86, 16, v67
    v_and_b32 v87, 0xffff0000, v67
    v_add_f32 v196, v196, v84
    v_add_f32 v197, v197, v85
    v_add_f32 v198, v198, v86
    v_add_f32 v199, v199, v87
    v_mul_f32 v88, v196, v196
    v_mul_f32 v89, v197, v197
    v_mul_f32 v90, v198, v198
    v_mul_f32 v91, v199, v199
    v_mov_b32 v92, s44
    v_mov_b32 v93, s44
    v_mov_b32 v94, s44
    v_mov_b32 v95, s44
    v_fmac_f32 v92, s45, v88
    v_fmac_f32 v93, s45, v89
    v_fmac_f32 v94, s45, v90
    v_fmac_f32 v95, s45, v91
    v_mul_f32 v92, v92, v196
    v_mul_f32 v93, v93, v197
    v_mul_f32 v94, v94, v198
    v_mul_f32 v95, v95, v199
    v_exp_f32 v92, v92
    v_exp_f32 v93, v93
    v_exp_f32 v94, v94
    v_exp_f32 v95, v95
    v_add_f32 v92, 1.0, v92
    v_add_f32 v93, 1.0, v93
    v_add_f32 v94, 1.0, v94
    v_add_f32 v95, 1.0, v95
    v_rcp_f32 v92, v92
    v_rcp_f32 v93, v93
    v_rcp_f32 v94, v94
    v_rcp_f32 v95, v95
    v_mul_f32 v196, v196, v92
    v_mul_f32 v197, v197, v93
    v_mul_f32 v198, v198, v94
    v_mul_f32 v199, v199, v95
    v_cvt_pk_bf16_f32 v196, v196, v197
    v_cvt_pk_bf16_f32 v197, v198, v199
    buffer_store_dwordx2 v[196:197], v61, s[32:35], 0 offen offset:32
    v_lshlrev_b32 v84, 16, v68
    v_and_b32 v85, 0xffff0000, v68
    v_lshlrev_b32 v86, 16, v69
    v_and_b32 v87, 0xffff0000, v69
    v_add_f32 v200, v200, v84
    v_add_f32 v201, v201, v85
    v_add_f32 v202, v202, v86
    v_add_f32 v203, v203, v87
    v_mul_f32 v88, v200, v200
    v_mul_f32 v89, v201, v201
    v_mul_f32 v90, v202, v202
    v_mul_f32 v91, v203, v203
    v_mov_b32 v92, s44
    v_mov_b32 v93, s44
    v_mov_b32 v94, s44
    v_mov_b32 v95, s44
    v_fmac_f32 v92, s45, v88
    v_fmac_f32 v93, s45, v89
    v_fmac_f32 v94, s45, v90
    v_fmac_f32 v95, s45, v91
    v_mul_f32 v92, v92, v200
    v_mul_f32 v93, v93, v201
    v_mul_f32 v94, v94, v202
    v_mul_f32 v95, v95, v203
    v_exp_f32 v92, v92
    v_exp_f32 v93, v93
    v_exp_f32 v94, v94
    v_exp_f32 v95, v95
    v_add_f32 v92, 1.0, v92
    v_add_f32 v93, 1.0, v93
    v_add_f32 v94, 1.0, v94
    v_add_f32 v95, 1.0, v95
    v_rcp_f32 v92, v92
    v_rcp_f32 v93, v93
    v_rcp_f32 v94, v94
    v_rcp_f32 v95, v95
    v_mul_f32 v200, v200, v92
    v_mul_f32 v201, v201, v93
    v_mul_f32 v202, v202, v94
    v_mul_f32 v203, v203, v95
    v_cvt_pk_bf16_f32 v200, v200, v201
    v_cvt_pk_bf16_f32 v201, v202, v203
    buffer_store_dwordx2 v[200:201], v61, s[32:35], 0 offen offset:64
    v_lshlrev_b32 v84, 16, v70
    v_and_b32 v85, 0xffff0000, v70
    v_lshlrev_b32 v86, 16, v71
    v_and_b32 v87, 0xffff0000, v71
    v_add_f32 v204, v204, v84
    v_add_f32 v205, v205, v85
    v_add_f32 v206, v206, v86
    v_add_f32 v207, v207, v87
    v_mul_f32 v88, v204, v204
    v_mul_f32 v89, v205, v205
    v_mul_f32 v90, v206, v206
    v_mul_f32 v91, v207, v207
    v_mov_b32 v92, s44
    v_mov_b32 v93, s44
    v_mov_b32 v94, s44
    v_mov_b32 v95, s44
    v_fmac_f32 v92, s45, v88
    v_fmac_f32 v93, s45, v89
    v_fmac_f32 v94, s45, v90
    v_fmac_f32 v95, s45, v91
    v_mul_f32 v92, v92, v204
    v_mul_f32 v93, v93, v205
    v_mul_f32 v94, v94, v206
    v_mul_f32 v95, v95, v207
    v_exp_f32 v92, v92
    v_exp_f32 v93, v93
    v_exp_f32 v94, v94
    v_exp_f32 v95, v95
    v_add_f32 v92, 1.0, v92
    v_add_f32 v93, 1.0, v93
    v_add_f32 v94, 1.0, v94
    v_add_f32 v95, 1.0, v95
    v_rcp_f32 v92, v92
    v_rcp_f32 v93, v93
    v_rcp_f32 v94, v94
    v_rcp_f32 v95, v95
    v_mul_f32 v204, v204, v92
    v_mul_f32 v205, v205, v93
    v_mul_f32 v206, v206, v94
    v_mul_f32 v207, v207, v95
    v_cvt_pk_bf16_f32 v204, v204, v205
    v_cvt_pk_bf16_f32 v205, v206, v207
    buffer_store_dwordx2 v[204:205], v61, s[32:35], 0 offen offset:96
    v_lshlrev_b32 v84, 16, v72
    v_and_b32 v85, 0xffff0000, v72
    v_lshlrev_b32 v86, 16, v73
    v_and_b32 v87, 0xffff0000, v73
    v_add_f32 v208, v208, v84
    v_add_f32 v209, v209, v85
    v_add_f32 v210, v210, v86
    v_add_f32 v211, v211, v87
    v_mul_f32 v88, v208, v208
    v_mul_f32 v89, v209, v209
    v_mul_f32 v90, v210, v210
    v_mul_f32 v91, v211, v211
    v_mov_b32 v92, s44
    v_mov_b32 v93, s44
    v_mov_b32 v94, s44
    v_mov_b32 v95, s44
    v_fmac_f32 v92, s45, v88
    v_fmac_f32 v93, s45, v89
    v_fmac_f32 v94, s45, v90
    v_fmac_f32 v95, s45, v91
    v_mul_f32 v92, v92, v208
    v_mul_f32 v93, v93, v209
    v_mul_f32 v94, v94, v210
    v_mul_f32 v95, v95, v211
    v_exp_f32 v92, v92
    v_exp_f32 v93, v93
    v_exp_f32 v94, v94
    v_exp_f32 v95, v95
    v_add_f32 v92, 1.0, v92
    v_add_f32 v93, 1.0, v93
    v_add_f32 v94, 1.0, v94
    v_add_f32 v95, 1.0, v95
    v_rcp_f32 v92, v92
    v_rcp_f32 v93, v93
    v_rcp_f32 v94, v94
    v_rcp_f32 v95, v95
    v_mul_f32 v208, v208, v92
    v_mul_f32 v209, v209, v93
    v_mul_f32 v210, v210, v94
    v_mul_f32 v211, v211, v95
    v_cvt_pk_bf16_f32 v208, v208, v209
    v_cvt_pk_bf16_f32 v209, v210, v211
    buffer_store_dwordx2 v[208:209], v61, s[32:35], 0 offen offset:128
    v_lshlrev_b32 v84, 16, v74
    v_and_b32 v85, 0xffff0000, v74
    v_lshlrev_b32 v86, 16, v75
    v_and_b32 v87, 0xffff0000, v75
    v_add_f32 v212, v212, v84
    v_add_f32 v213, v213, v85
    v_add_f32 v214, v214, v86
    v_add_f32 v215, v215, v87
    v_mul_f32 v88, v212, v212
    v_mul_f32 v89, v213, v213
    v_mul_f32 v90, v214, v214
    v_mul_f32 v91, v215, v215
    v_mov_b32 v92, s44
    v_mov_b32 v93, s44
    v_mov_b32 v94, s44
    v_mov_b32 v95, s44
    v_fmac_f32 v92, s45, v88
    v_fmac_f32 v93, s45, v89
    v_fmac_f32 v94, s45, v90
    v_fmac_f32 v95, s45, v91
    v_mul_f32 v92, v92, v212
    v_mul_f32 v93, v93, v213
    v_mul_f32 v94, v94, v214
    v_mul_f32 v95, v95, v215
    v_exp_f32 v92, v92
    v_exp_f32 v93, v93
    v_exp_f32 v94, v94
    v_exp_f32 v95, v95
    v_add_f32 v92, 1.0, v92
    v_add_f32 v93, 1.0, v93
    v_add_f32 v94, 1.0, v94
    v_add_f32 v95, 1.0, v95
    v_rcp_f32 v92, v92
    v_rcp_f32 v93, v93
    v_rcp_f32 v94, v94
    v_rcp_f32 v95, v95
    v_mul_f32 v212, v212, v92
    v_mul_f32 v213, v213, v93
    v_mul_f32 v214, v214, v94
    v_mul_f32 v215, v215, v95
    v_cvt_pk_bf16_f32 v212, v212, v213
    v_cvt_pk_bf16_f32 v213, v214, v215
    buffer_store_dwordx2 v[212:213], v61, s[32:35], 0 offen offset:160
    v_lshlrev_b32 v84, 16, v76
    v_and_b32 v85, 0xffff0000, v76
    v_lshlrev_b32 v86, 16, v77
    v_and_b32 v87, 0xffff0000, v77
    v_add_f32 v216, v216, v84
    v_add_f32 v217, v217, v85
    v_add_f32 v218, v218, v86
    v_add_f32 v219, v219, v87
    v_mul_f32 v88, v216, v216
    v_mul_f32 v89, v217, v217
    v_mul_f32 v90, v218, v218
    v_mul_f32 v91, v219, v219
    v_mov_b32 v92, s44
    v_mov_b32 v93, s44
    v_mov_b32 v94, s44
    v_mov_b32 v95, s44
    v_fmac_f32 v92, s45, v88
    v_fmac_f32 v93, s45, v89
    v_fmac_f32 v94, s45, v90
    v_fmac_f32 v95, s45, v91
    v_mul_f32 v92, v92, v216
    v_mul_f32 v93, v93, v217
    v_mul_f32 v94, v94, v218
    v_mul_f32 v95, v95, v219
    v_exp_f32 v92, v92
    v_exp_f32 v93, v93
    v_exp_f32 v94, v94
    v_exp_f32 v95, v95
    v_add_f32 v92, 1.0, v92
    v_add_f32 v93, 1.0, v93
    v_add_f32 v94, 1.0, v94
    v_add_f32 v95, 1.0, v95
    v_rcp_f32 v92, v92
    v_rcp_f32 v93, v93
    v_rcp_f32 v94, v94
    v_rcp_f32 v95, v95
    v_mul_f32 v216, v216, v92
    v_mul_f32 v217, v217, v93
    v_mul_f32 v218, v218, v94
    v_mul_f32 v219, v219, v95
    v_cvt_pk_bf16_f32 v216, v216, v217
    v_cvt_pk_bf16_f32 v217, v218, v219
    buffer_store_dwordx2 v[216:217], v61, s[32:35], 0 offen offset:192
    v_lshlrev_b32 v84, 16, v78
    v_and_b32 v85, 0xffff0000, v78
    v_lshlrev_b32 v86, 16, v79
    v_and_b32 v87, 0xffff0000, v79
    v_add_f32 v220, v220, v84
    v_add_f32 v221, v221, v85
    v_add_f32 v222, v222, v86
    v_add_f32 v223, v223, v87
    v_mul_f32 v88, v220, v220
    v_mul_f32 v89, v221, v221
    v_mul_f32 v90, v222, v222
    v_mul_f32 v91, v223, v223
    v_mov_b32 v92, s44
    v_mov_b32 v93, s44
    v_mov_b32 v94, s44
    v_mov_b32 v95, s44
    v_fmac_f32 v92, s45, v88
    v_fmac_f32 v93, s45, v89
    v_fmac_f32 v94, s45, v90
    v_fmac_f32 v95, s45, v91
    v_mul_f32 v92, v92, v220
    v_mul_f32 v93, v93, v221
    v_mul_f32 v94, v94, v222
    v_mul_f32 v95, v95, v223
    v_exp_f32 v92, v92
    v_exp_f32 v93, v93
    v_exp_f32 v94, v94
    v_exp_f32 v95, v95
    v_add_f32 v92, 1.0, v92
    v_add_f32 v93, 1.0, v93
    v_add_f32 v94, 1.0, v94
    v_add_f32 v95, 1.0, v95
    v_rcp_f32 v92, v92
    v_rcp_f32 v93, v93
    v_rcp_f32 v94, v94
    v_rcp_f32 v95, v95
    v_mul_f32 v220, v220, v92
    v_mul_f32 v221, v221, v93
    v_mul_f32 v222, v222, v94
    v_mul_f32 v223, v223, v95
    v_cvt_pk_bf16_f32 v220, v220, v221
    v_cvt_pk_bf16_f32 v221, v222, v223
    buffer_store_dwordx2 v[220:221], v61, s[32:35], 0 offen offset:224
    v_lshlrev_b32 v84, 16, v80
    v_and_b32 v85, 0xffff0000, v80
    v_lshlrev_b32 v86, 16, v81
    v_and_b32 v87, 0xffff0000, v81
    v_add_f32 v224, v224, v84
    v_add_f32 v225, v225, v85
    v_add_f32 v226, v226, v86
    v_add_f32 v227, v227, v87
    v_mul_f32 v88, v224, v224
    v_mul_f32 v89, v225, v225
    v_mul_f32 v90, v226, v226
    v_mul_f32 v91, v227, v227
    v_mov_b32 v92, s44
    v_mov_b32 v93, s44
    v_mov_b32 v94, s44
    v_mov_b32 v95, s44
    v_fmac_f32 v92, s45, v88
    v_fmac_f32 v93, s45, v89
    v_fmac_f32 v94, s45, v90
    v_fmac_f32 v95, s45, v91
    v_mul_f32 v92, v92, v224
    v_mul_f32 v93, v93, v225
    v_mul_f32 v94, v94, v226
    v_mul_f32 v95, v95, v227
    v_exp_f32 v92, v92
    v_exp_f32 v93, v93
    v_exp_f32 v94, v94
    v_exp_f32 v95, v95
    v_add_f32 v92, 1.0, v92
    v_add_f32 v93, 1.0, v93
    v_add_f32 v94, 1.0, v94
    v_add_f32 v95, 1.0, v95
    v_rcp_f32 v92, v92
    v_rcp_f32 v93, v93
    v_rcp_f32 v94, v94
    v_rcp_f32 v95, v95
    v_mul_f32 v224, v224, v92
    v_mul_f32 v225, v225, v93
    v_mul_f32 v226, v226, v94
    v_mul_f32 v227, v227, v95
    v_cvt_pk_bf16_f32 v224, v224, v225
    v_cvt_pk_bf16_f32 v225, v226, v227
    buffer_store_dwordx2 v[224:225], v61, s[32:35], 0 offen offset:256
L_k_ffn1_end:
    s_endpgm
.globl k_l4_kernel
.p2align 8
.type k_l4_kernel,@function
k_l4_kernel:
    s_cmp_ge_u32 s2, 256
    s_cbranch_scc1 L_k_l4_kernel_roleB
    s_cmp_ge_u32 s2, 256
    s_cbranch_scc1 L_k_attn2_end
    s_load_dwordx2 s[4:5], s[0:1], 16
    s_load_dwordx2 s[6:7], s[0:1], 88
    s_and_b32 s20, s2, 31
    s_lshr_b32 s21, s2, 5
    s_waitcnt lgkmcnt(0)
    s_mov_b32 s8, s4
    s_mov_b32 s9, s5
    s_mov_b32 s10, 20736
    s_mov_b32 s11, 0x00020000
    s_mul_i32 s24, s20, 648
    v_cmp_gt_u32 vcc, 162, v0
    s_and_saveexec_b64 s[12:13], vcc
    v_lshlrev_b32 v1, 2, v0
    buffer_load_dword v2, v1, s[8:11], s24 offen
    v_lshlrev_b32 v3, 1, v0
    s_mov_b32 s25, 0xe38e38f
    v_mul_hi_u32 v4, v3, s25
    v_mul_u32_u24 v5, 18, v4
    v_sub_u32 v5, v3, v5
    v_mul_u32_u24 v4, 80, v4
    v_lshl_add_u32 v4, v5, 2, v4
    s_waitcnt vmcnt(0)
    v_lshlrev_b32 v6, 16, v2
    v_and_b32 v7, 0xffff0000, v2
    ds_write_b64 v4, v[6:7]
    s_mov_b64 exec, s[12:13]
    s_add_u32 s16, s6, 83886080
    s_addc_u32 s17, s7, 0
    s_mov_b32 s18, 1572864
    s_mov_b32 s19, 0x00020000
    v_lshlrev_b32 v1, 2, v0
    s_mul_i32 s24, s20, 6144
    s_add_u32 s24, s24, 0
    s_add_u32 s25, s24, 4096
    buffer_load_dword v16, v1, s[16:19], s24 offen offset:0
    buffer_load_dword v17, v1, s[16:19], s24 offen offset:1024
    buffer_load_dword v18, v1, s[16:19], s24 offen offset:2048
    buffer_load_dword v19, v1, s[16:19], s24 offen offset:3072
    buffer_load_dword v20, v1, s[16:19], s25 offen offset:0
    buffer_load_dword v21, v1, s[16:19], s25 offen offset:1024
    s_mul_i32 s24, s20, 6144
    s_add_u32 s24, s24, 196608
    s_add_u32 s25, s24, 4096
    buffer_load_dword v22, v1, s[16:19], s24 offen offset:0
    buffer_load_dword v23, v1, s[16:19], s24 offen offset:1024
    buffer_load_dword v24, v1, s[16:19], s24 offen offset:2048
    buffer_load_dword v25, v1, s[16:19], s24 offen offset:3072
    buffer_load_dword v26, v1, s[16:19], s25 offen offset:0
    buffer_load_dword v27, v1, s[16:19], s25 offen offset:1024
    s_mul_i32 s24, s20, 6144
    s_add_u32 s24, s24, 393216
    s_add_u32 s25, s24, 4096
    buffer_load_dword v28, v1, s[16:19], s24 offen offset:0
    buffer_load_dword v29, v1, s[16:19], s24 offen offset:1024
    buffer_load_dword v30, v1, s[16:19], s24 offen offset:2048
    buffer_load_dword v31, v1, s[16:19], s24 offen offset:3072
    buffer_load_dword v32, v1, s[16:19], s25 offen offset:0
    buffer_load_dword v33, v1, s[16:19], s25 offen offset:1024
    s_mul_i32 s24, s20, 6144
    s_add_u32 s24, s24, 589824
    s_add_u32 s25, s24, 4096
    buffer_load_dword v34, v1, s[16:19], s24 offen offset:0
    buffer_load_dword v35, v1, s[16:19], s24 offen offset:1024
    buffer_load_dword v36, v1, s[16:19], s24 offen offset:2048
    buffer_load_dword v37, v1, s[16:19], s24 offen offset:3072
    buffer_load_dword v38, v1, s[16:19], s25 offen offset:0
    buffer_load_dword v39, v1, s[16:19], s25 offen offset:1024
    s_mul_i32 s24, s20, 6144
    s_add_u32 s24, s24, 786432
    s_add_u32 s25, s24, 4096
    buffer_load_dword v40, v1, s[16:19], s24 offen offset:0
    buffer_load_dword v41, v1, s[16:19], s24 offen offset:1024
    buffer_load_dword v42, v1, s[16:19], s24 offen offset:2048
    buffer_load_dword v43, v1, s[16:19], s24 offen offset:3072
    buffer_load_dword v44, v1, s[16:19], s25 offen offset:0
    buffer_load_dword v45, v1, s[16:19], s25 offen offset:1024
    s_mul_i32 s24, s20, 6144
    s_add_u32 s24, s24, 983040
    s_add_u32 s25, s24, 4096
    buffer_load_dword v46, v1, s[16:19], s24 offen offset:0
    buffer_load_dword v47, v1, s[16:19], s24 offen offset:1024
    buffer_load_dword v48, v1, s[16:19], s24 offen offset:2048
    buffer_load_dword v49, v1, s[16:19], s24 offen offset:3072
    buffer_load_dword v50, v1, s[16:19], s25 offen offset:0
    buffer_load_dword v51, v1, s[16:19], s25 offen offset:1024
    s_mul_i32 s24, s20, 6144
    s_add_u32 s24, s24, 1179648
    s_add_u32 s25, s24, 4096
    buffer_load_dword v52, v1, s[16:19], s24 offen offset:0
    buffer_load_dword v53, v1, s[16:19], s24 offen offset:1024
    buffer_load_dword v54, v1, s[16:19], s24 offen offset:2048
    buffer_load_dword v55, v1, s[16:19], s24 offen offset:3072
    buffer_load_dword v56, v1, s[16:19], s25 offen offset:0
    buffer_load_dword v57, v1, s[16:19], s25 offen offset:1024
    s_mul_i32 s24, s20, 6144
    s_add_u32 s24, s24, 1376256
    s_add_u32 s25, s24, 4096
    buffer_load_dword v58, v1, s[16:19], s24 offen offset:0
    buffer_load_dword v59, v1, s[16:19], s24 offen offset:1024
    buffer_load_dword v60, v1, s[16:19], s24 offen offset:2048
    buffer_load_dword v61, v1, s[16:19], s24 offen offset:3072
    buffer_load_dword v62, v1, s[16:19], s25 offen offset:0
    buffer_load_dword v63, v1, s[16:19], s25 offen offset:1024
    s_waitcnt vmcnt(0)
    v_add_f32 v16, v16, v22
    v_add_f32 v16, v16, v28
    v_add_f32 v16, v16, v34
    v_add_f32 v16, v16, v40
    v_add_f32 v16, v16, v46
    v_add_f32 v16, v16, v52
    v_add_f32 v16, v16, v58
    v_cvt_pk_bf16_f32 v2, v16, v16
    v_lshlrev_b32 v16, 16, v2
    v_add_f32 v17, v17, v23
    v_add_f32 v17, v17, v29
    v_add_f32 v17, v17, v35
    v_add_f32 v17, v17, v41
    v_add_f32 v17, v17, v47
    v_add_f32 v17, v17, v53
    v_add_f32 v17, v17, v59
    v_cvt_pk_bf16_f32 v2, v17, v17
    v_lshlrev_b32 v17, 16, v2
    v_add_f32 v18, v18, v24
    v_add_f32 v18, v18, v30
    v_add_f32 v18, v18, v36
    v_add_f32 v18, v18, v42
    v_add_f32 v18, v18, v48
    v_add_f32 v18, v18, v54
    v_add_f32 v18, v18, v60
    v_cvt_pk_bf16_f32 v2, v18, v18
    v_lshlrev_b32 v18, 16, v2
    v_add_f32 v19, v19, v25
    v_add_f32 v19, v19, v31
    v_add_f32 v19, v19, v37
    v_add_f32 v19, v19, v43
    v_add_f32 v19, v19, v49
    v_add_f32 v19, v19, v55
    v_add_f32 v19, v19, v61
    v_cvt_pk_bf16_f32 v2, v19, v19
    v_lshlrev_b32 v19, 16, v2
    v_add_f32 v20, v20, v26
    v_add_f32 v20, v20, v32
    v_add_f32 v20, v20, v38
    v_add_f32 v20, v20, v44
    v_add_f32 v20, v20, v50
    v_add_f32 v20, v20, v56
    v_add_f32 v20, v20, v62
    v_cvt_pk_bf16_f32 v2, v20, v20
    v_lshlrev_b32 v20, 16, v2
    v_add_f32 v21, v21, v27
    v_add_f32 v21, v21, v33
    v_add_f32 v21, v21, v39
    v_add_f32 v21, v21, v45
    v_add_f32 v21, v21, v51
    v_add_f32 v21, v21, v57
    v_add_f32 v21, v21, v63
    v_cvt_pk_bf16_f32 v2, v21, v21
    v_lshlrev_b32 v21, 16, v2
    v_lshrrev_b32 v2, 2, v0
    v_and_b32 v3, 3, v0
    v_lshrrev_b32 v4, 4, v2
    v_lshl_add_u32 v4, v4, 2, v3
    v_and_b32 v5, 15, v2
    v_add_u32 v6, 0, v4
    v_add_u32 v7, 0, v5
    v_cmp_gt_u32 vcc, 36, v6
    v_cmp_gt_u32 s[12:13], 19, v7
    s_and_b64 vcc, vcc, s[12:13]
    s_and_saveexec_b64 s[12:13], vcc
    v_mul_u32_u24 v6, 80, v6
    v_lshl_add_u32 v6, v7, 2, v6
    ds_write_b32 v6, v16 offset:2048
    s_mov_b64 exec, s[12:13]
    v_add_u32 v6, 0, v4
    v_add_u32 v7, 16, v5
    v_cmp_gt_u32 vcc, 36, v6
    v_cmp_gt_u32 s[12:13], 19, v7
    s_and_b64 vcc, vcc, s[12:13]
    s_and_saveexec_b64 s[12:13], vcc
    v_mul_u32_u24 v6, 80, v6
    v_lshl_add_u32 v6, v7, 2, v6
    ds_write_b32 v6, v17 offset:2048
    s_mov_b64 exec, s[12:13]
    v_add_u32 v6, 16, v4
    v_add_u32 v7, 0, v5
    v_cmp_gt_u32 vcc, 36, v6
    v_cmp_gt_u32 s[12:13], 19, v7
    s_and_b64 vcc, vcc, s[12:13]
    s_and_saveexec_b64 s[12:13], vcc
    v_mul_u32_u24 v6, 80, v6
    v_lshl_add_u32 v6, v7, 2, v6
    ds_write_b32 v6, v18 offset:2048
    s_mov_b64 exec, s[12:13]
    v_add_u32 v6, 16, v4
    v_add_u32 v7, 16, v5
    v_cmp_gt_u32 vcc, 36, v6
    v_cmp_gt_u32 s[12:13], 19, v7
    s_and_b64 vcc, vcc, s[12:13]
    s_and_saveexec_b64 s[12:13], vcc
    v_mul_u32_u24 v6, 80, v6
    v_lshl_add_u32 v6, v7, 2, v6
    ds_write_b32 v6, v19 offset:2048
    s_mov_b64 exec, s[12:13]
    v_add_u32 v6, 32, v4
    v_add_u32 v7, 0, v5
    v_cmp_gt_u32 vcc, 36, v6
    v_cmp_gt_u32 s[12:13], 19, v7
    s_and_b64 vcc, vcc, s[12:13]
    s_and_saveexec_b64 s[12:13], vcc
    v_mul_u32_u24 v6, 80, v6
    v_lshl_add_u32 v6, v7, 2, v6
    ds_write_b32 v6, v20 offset:2048
    s_mov_b64 exec, s[12:13]
    v_add_u32 v6, 32, v4
    v_add_u32 v7, 16, v5
    v_cmp_gt_u32 vcc, 36, v6
    v_cmp_gt_u32 s[12:13], 19, v7
    s_and_b64 vcc, vcc, s[12:13]
    s_and_saveexec_b64 s[12:13], vcc
    v_mul_u32_u24 v6, 80, v6
    v_lshl_add_u32 v6, v7, 2, v6
    ds_write_b32 v6, v21 offset:2048
    s_mov_b64 exec, s[12:13]
    s_add_u32 s12, s6, 4194304
    s_addc_u32 s13, s7, 0
    s_mov_b32 s14, 7077888
    s_mov_b32 s15, 0x00020000
    s_lshl_b32 s24, s21, 8
    v_add_u32 v1, s24, v0
    s_mov_b32 s25, 3456
    v_mul_lo_u32 v2, v1, s25
    s_mul_i32 s26, s20, 36
    buffer_load_dword v16, v2, s[12:15], s26 offen offset:0
    buffer_load_dword v17, v2, s[12:15], s26 offen offset:4
    buffer_load_dword v18, v2, s[12:15], s26 offen offset:8
    buffer_load_dword v19, v2, s[12:15], s26 offen offset:12
    buffer_load_dword v20, v2, s[12:15], s26 offen offset:16
    buffer_load_dword v21, v2, s[12:15], s26 offen offset:20
    buffer_load_dword v22, v2, s[12:15], s26 offen offset:24
    buffer_load_dword v23, v2, s[12:15], s26 offen offset:28
    buffer_load_dword v24, v2, s[12:15], s26 offen offset:32
    v_mov_b32 v9, 0
    s_waitcnt vmcnt(0) lgkmcnt(0)
    s_barrier
    v_mov_b32 v40, 0
    v_mov_b32 v41, 0
    v_mov_b32 v42, 0
    v_mov_b32 v43, 0
    v_mov_b32 v44, 0
    v_mov_b32 v45, 0
    v_mov_b32 v46, 0
    v_mov_b32 v47, 0
    v_mov_b32 v48, 0
    v_mov_b32 v49, 0
    v_mov_b32 v50, 0
    v_mov_b32 v51, 0
    v_mov_b32 v52, 0
    v_mov_b32 v53, 0
    v_mov_b32 v54, 0
    v_mov_b32 v55, 0
    v_mov_b32 v56, 0
    v_mov_b32 v57, 0
    ds_read_b128 v[100:103], v9 offset:0
    ds_read_b128 v[104:107], v9 offset:16
    ds_read_b128 v[108:111], v9 offset:32
    ds_read_b128 v[112:115], v9 offset:48
    ds_read_b64 v[116:117], v9 offset:64
    v_lshlrev_b32 v120, 16, v16
    s_waitcnt lgkmcnt(0)
    v_fmac_f32 v40, v120, v100
    v_fmac_f32 v41, v120, v101
    v_fmac_f32 v42, v120, v102
    v_fmac_f32 v43, v120, v103
    v_fmac_f32 v44, v120, v104
    v_fmac_f32 v45, v120, v105
    v_fmac_f32 v46, v120, v106
    v_fmac_f32 v47, v120, v107
    v_fmac_f32 v48, v120, v108
    v_fmac_f32 v49, v120, v109
    v_fmac_f32 v50, v120, v110
    v_fmac_f32 v51, v120, v111
    v_fmac_f32 v52, v120, v112
    v_fmac_f32 v53, v120, v113
    v_fmac_f32 v54, v120, v114
    v_fmac_f32 v55, v120, v115
    v_fmac_f32 v56, v120, v116
    v_fmac_f32 v57, v120, v117
    ds_read_b128 v[100:103], v9 offset:80
    ds_read_b128 v[104:107], v9 offset:96
    ds_read_b128 v[108:111], v9 offset:112
    ds_read_b128 v[112:115], v9 offset:128
    ds_read_b64 v[116:117], v9 offset:144
    v_and_b32 v120, 0xffff0000, v16
    s_waitcnt lgkmcnt(0)
    v_fmac_f32 v40, v120, v100
    v_fmac_f32 v41, v120, v101
    v_fmac_f32 v42, v120, v102
    v_fmac_f32 v43, v120, v103
    v_fmac_f32 v44, v120, v104
    v_fmac_f32 v45, v120, v105
    v_fmac_f32 v46, v120, v106
    v_fmac_f32 v47, v120, v107
    v_fmac_f32 v48, v120, v108
    v_fmac_f32 v49, v120, v109
    v_fmac_f32 v50, v120, v110
    v_fmac_f32 v51, v120, v111
    v_fmac_f32 v52, v120, v112
    v_fmac_f32 v53, v120, v113
    v_fmac_f32 v54, v120, v114
    v_fmac_f32 v55, v120, v115
    v_fmac_f32 v56, v120, v116
    v_fmac_f32 v57, v120, v117
    ds_read_b128 v[100:103], v9 offset:160
    ds_read_b128 v[104:107], v9 offset:176
    ds_read_b128 v[108:111], v9 offset:192
    ds_read_b128 v[112:115], v9 offset:208
    ds_read_b64 v[116:117], v9 offset:224
    v_lshlrev_b32 v120, 16, v17
    s_waitcnt lgkmcnt(0)
    v_fmac_f32 v40, v120, v100
    v_fmac_f32 v41, v120, v101
    v_fmac_f32 v42, v120, v102
    v_fmac_f32 v43, v120, v103
    v_fmac_f32 v44, v120, v104
    v_fmac_f32 v45, v120, v105
    v_fmac_f32 v46, v120, v106
    v_fmac_f32 v47, v120, v107
    v_fmac_f32 v48, v120, v108
    v_fmac_f32 v49, v120, v109
    v_fmac_f32 v50, v120, v110
    v_fmac_f32 v51, v120, v111
    v_fmac_f32 v52, v120, v112
    v_fmac_f32 v53, v120, v113
    v_fmac_f32 v54, v120, v114
    v_fmac_f32 v55, v120, v115
    v_fmac_f32 v56, v120, v116
    v_fmac_f32 v57, v120, v117
    ds_read_b128 v[100:103], v9 offset:240
    ds_read_b128 v[104:107], v9 offset:256
    ds_read_b128 v[108:111], v9 offset:272
    ds_read_b128 v[112:115], v9 offset:288
    ds_read_b64 v[116:117], v9 offset:304
    v_and_b32 v120, 0xffff0000, v17
    s_waitcnt lgkmcnt(0)
    v_fmac_f32 v40, v120, v100
    v_fmac_f32 v41, v120, v101
    v_fmac_f32 v42, v120, v102
    v_fmac_f32 v43, v120, v103
    v_fmac_f32 v44, v120, v104
    v_fmac_f32 v45, v120, v105
    v_fmac_f32 v46, v120, v106
    v_fmac_f32 v47, v120, v107
    v_fmac_f32 v48, v120, v108
    v_fmac_f32 v49, v120, v109
    v_fmac_f32 v50, v120, v110
    v_fmac_f32 v51, v120, v111
    v_fmac_f32 v52, v120, v112
    v_fmac_f32 v53, v120, v113
    v_fmac_f32 v54, v120, v114
    v_fmac_f32 v55, v120, v115
    v_fmac_f32 v56, v120, v116
    v_fmac_f32 v57, v120, v117
    ds_read_b128 v[100:103], v9 offset:320
    ds_read_b128 v[104:107], v9 offset:336
    ds_read_b128 v[108:111], v9 offset:352
    ds_read_b128 v[112:115], v9 offset:368
    ds_read_b64 v[116:117], v9 offset:384
    v_lshlrev_b32 v120, 16, v18
    s_waitcnt lgkmcnt(0)
    v_fmac_f32 v40, v120, v100
    v_fmac_f32 v41, v120, v101
    v_fmac_f32 v42, v120, v102
    v_fmac_f32 v43, v120, v103
    v_fmac_f32 v44, v120, v104
    v_fmac_f32 v45, v120, v105
    v_fmac_f32 v46, v120, v106
    v_fmac_f32 v47, v120, v107
    v_fmac_f32 v48, v120, v108
    v_fmac_f32 v49, v120, v109
    v_fmac_f32 v50, v120, v110
    v_fmac_f32 v51, v120, v111
    v_fmac_f32 v52, v120, v112
    v_fmac_f32 v53, v120, v113
    v_fmac_f32 v54, v120, v114
    v_fmac_f32 v55, v120, v115
    v_fmac_f32 v56, v120, v116
    v_fmac_f32 v57, v120, v117
    ds_read_b128 v[100:103], v9 offset:400
    ds_read_b128 v[104:107], v9 offset:416
    ds_read_b128 v[108:111], v9 offset:432
    ds_read_b128 v[112:115], v9 offset:448
    ds_read_b64 v[116:117], v9 offset:464
    v_and_b32 v120, 0xffff0000, v18
    s_waitcnt lgkmcnt(0)
    v_fmac_f32 v40, v120, v100
    v_fmac_f32 v41, v120, v101
    v_fmac_f32 v42, v120, v102
    v_fmac_f32 v43, v120, v103
    v_fmac_f32 v44, v120, v104
    v_fmac_f32 v45, v120, v105
    v_fmac_f32 v46, v120, v106
    v_fmac_f32 v47, v120, v107
    v_fmac_f32 v48, v120, v108
    v_fmac_f32 v49, v120, v109
    v_fmac_f32 v50, v120, v110
    v_fmac_f32 v51, v120, v111
    v_fmac_f32 v52, v120, v112
    v_fmac_f32 v53, v120, v113
    v_fmac_f32 v54, v120, v114
    v_fmac_f32 v55, v120, v115
    v_fmac_f32 v56, v120, v116
    v_fmac_f32 v57, v120, v117
    ds_read_b128 v[100:103], v9 offset:480
    ds_read_b128 v[104:107], v9 offset:496
    ds_read_b128 v[108:111], v9 offset:512
    ds_read_b128 v[112:115], v9 offset:528
    ds_read_b64 v[116:117], v9 offset:544
    v_lshlrev_b32 v120, 16, v19
    s_waitcnt lgkmcnt(0)
    v_fmac_f32 v40, v120, v100
    v_fmac_f32 v41, v120, v101
    v_fmac_f32 v42, v120, v102
    v_fmac_f32 v43, v120, v103
    v_fmac_f32 v44, v120, v104
    v_fmac_f32 v45, v120, v105
    v_fmac_f32 v46, v120, v106
    v_fmac_f32 v47, v120, v107
    v_fmac_f32 v48, v120, v108
    v_fmac_f32 v49, v120, v109
    v_fmac_f32 v50, v120, v110
    v_fmac_f32 v51, v120, v111
    v_fmac_f32 v52, v120, v112
    v_fmac_f32 v53, v120, v113
    v_fmac_f32 v54, v120, v114
    v_fmac_f32 v55, v120, v115
    v_fmac_f32 v56, v120, v116
    v_fmac_f32 v57, v120, v117
    ds_read_b128 v[100:103], v9 offset:560
    ds_read_b128 v[104:107], v9 offset:576
    ds_read_b128 v[108:111], v9 offset:592
    ds_read_b128 v[112:115], v9 offset:608
    ds_read_b64 v[116:117], v9 offset:624
    v_and_b32 v120, 0xffff0000, v19
    s_waitcnt lgkmcnt(0)
    v_fmac_f32 v40, v120, v100
    v_fmac_f32 v41, v120, v101
    v_fmac_f32 v42, v120, v102
    v_fmac_f32 v43, v120, v103
    v_fmac_f32 v44, v120, v104
    v_fmac_f32 v45, v120, v105
    v_fmac_f32 v46, v120, v106
    v_fmac_f32 v47, v120, v107
    v_fmac_f32 v48, v120, v108
    v_fmac_f32 v49, v120, v109
    v_fmac_f32 v50, v120, v110
    v_fmac_f32 v51, v120, v111
    v_fmac_f32 v52, v120, v112
    v_fmac_f32 v53, v120, v113
    v_fmac_f32 v54, v120, v114
    v_fmac_f32 v55, v120, v115
    v_fmac_f32 v56, v120, v116
    v_fmac_f32 v57, v120, v117
    ds_read_b128 v[100:103], v9 offset:640
    ds_read_b128 v[104:107], v9 offset:656
    ds_read_b128 v[108:111], v9 offset:672
    ds_read_b128 v[112:115], v9 offset:688
    ds_read_b64 v[116:117], v9 offset:704
    v_lshlrev_b32 v120, 16, v20
    s_waitcnt lgkmcnt(0)
    v_fmac_f32 v40, v120, v100
    v_fmac_f32 v41, v120, v101
    v_fmac_f32 v42, v120, v102
    v_fmac_f32 v43, v120, v103
    v_fmac_f32 v44, v120, v104
    v_fmac_f32 v45, v120, v105
    v_fmac_f32 v46, v120, v106
    v_fmac_f32 v47, v120, v107
    v_fmac_f32 v48, v120, v108
    v_fmac_f32 v49, v120, v109
    v_fmac_f32 v50, v120, v110
    v_fmac_f32 v51, v120, v111
    v_fmac_f32 v52, v120, v112
    v_fmac_f32 v53, v120, v113
    v_fmac_f32 v54, v120, v114
    v_fmac_f32 v55, v120, v115
    v_fmac_f32 v56, v120, v116
    v_fmac_f32 v57, v120, v117
    ds_read_b128 v[100:103], v9 offset:720
    ds_read_b128 v[104:107], v9 offset:736
    ds_read_b128 v[108:111], v9 offset:752
    ds_read_b128 v[112:115], v9 offset:768
    ds_read_b64 v[116:117], v9 offset:784
    v_and_b32 v120, 0xffff0000, v20
    s_waitcnt lgkmcnt(0)
    v_fmac_f32 v40, v120, v100
    v_fmac_f32 v41, v120, v101
    v_fmac_f32 v42, v120, v102
    v_fmac_f32 v43, v120, v103
    v_fmac_f32 v44, v120, v104
    v_fmac_f32 v45, v120, v105
    v_fmac_f32 v46, v120, v106
    v_fmac_f32 v47, v120, v107
    v_fmac_f32 v48, v120, v108
    v_fmac_f32 v49, v120, v109
    v_fmac_f32 v50, v120, v110
    v_fmac_f32 v51, v120, v111
    v_fmac_f32 v52, v120, v112
    v_fmac_f32 v53, v120, v113
    v_fmac_f32 v54, v120, v114
    v_fmac_f32 v55, v120, v115
    v_fmac_f32 v56, v120, v116
    v_fmac_f32 v57, v120, v117
    ds_read_b128 v[100:103], v9 offset:800
    ds_read_b128 v[104:107], v9 offset:816
    ds_read_b128 v[108:111], v9 offset:832
    ds_read_b128 v[112:115], v9 offset:848
    ds_read_b64 v[116:117], v9 offset:864
    v_lshlrev_b32 v120, 16, v21
    s_waitcnt lgkmcnt(0)
    v_fmac_f32 v40, v120, v100
    v_fmac_f32 v41, v120, v101
    v_fmac_f32 v42, v120, v102
    v_fmac_f32 v43, v120, v103
    v_fmac_f32 v44, v120, v104
    v_fmac_f32 v45, v120, v105
    v_fmac_f32 v46, v120, v106
    v_fmac_f32 v47, v120, v107
    v_fmac_f32 v48, v120, v108
    v_fmac_f32 v49, v120, v109
    v_fmac_f32 v50, v120, v110
    v_fmac_f32 v51, v120, v111
    v_fmac_f32 v52, v120, v112
    v_fmac_f32 v53, v120, v113
    v_fmac_f32 v54, v120, v114
    v_fmac_f32 v55, v120, v115
    v_fmac_f32 v56, v120, v116
    v_fmac_f32 v57, v120, v117
    ds_read_b128 v[100:103], v9 offset:880
    ds_read_b128 v[104:107], v9 offset:896
    ds_read_b128 v[108:111], v9 offset:912
    ds_read_b128 v[112:115], v9 offset:928
    ds_read_b64 v[116:117], v9 offset:944
    v_and_b32 v120, 0xffff0000, v21
    s_waitcnt lgkmcnt(0)
    v_fmac_f32 v40, v120, v100
    v_fmac_f32 v41, v120, v101
    v_fmac_f32 v42, v120, v102
    v_fmac_f32 v43, v120, v103
    v_fmac_f32 v44, v120, v104
    v_fmac_f32 v45, v120, v105
    v_fmac_f32 v46, v120, v106
    v_fmac_f32 v47, v120, v107
    v_fmac_f32 v48, v120, v108
    v_fmac_f32 v49, v120, v109
    v_fmac_f32 v50, v120, v110
    v_fmac_f32 v51, v120, v111
    v_fmac_f32 v52, v120, v112
    v_fmac_f32 v53, v120, v113
    v_fmac_f32 v54, v120, v114
    v_fmac_f32 v55, v120, v115
    v_fmac_f32 v56, v120, v116
    v_fmac_f32 v57, v120, v117
    ds_read_b128 v[100:103], v9 offset:960
    ds_read_b128 v[104:107], v9 offset:976
    ds_read_b128 v[108:111], v9 offset:992
    ds_read_b128 v[112:115], v9 offset:1008
    ds_read_b64 v[116:117], v9 offset:1024
    v_lshlrev_b32 v120, 16, v22
    s_waitcnt lgkmcnt(0)
    v_fmac_f32 v40, v120, v100
    v_fmac_f32 v41, v120, v101
    v_fmac_f32 v42, v120, v102
    v_fmac_f32 v43, v120, v103
    v_fmac_f32 v44, v120, v104
    v_fmac_f32 v45, v120, v105
    v_fmac_f32 v46, v120, v106
    v_fmac_f32 v47, v120, v107
    v_fmac_f32 v48, v120, v108
    v_fmac_f32 v49, v120, v109
    v_fmac_f32 v50, v120, v110
    v_fmac_f32 v51, v120, v111
    v_fmac_f32 v52, v120, v112
    v_fmac_f32 v53, v120, v113
    v_fmac_f32 v54, v120, v114
    v_fmac_f32 v55, v120, v115
    v_fmac_f32 v56, v120, v116
    v_fmac_f32 v57, v120, v117
    ds_read_b128 v[100:103], v9 offset:1040
    ds_read_b128 v[104:107], v9 offset:1056
    ds_read_b128 v[108:111], v9 offset:1072
    ds_read_b128 v[112:115], v9 offset:1088
    ds_read_b64 v[116:117], v9 offset:1104
    v_and_b32 v120, 0xffff0000, v22
    s_waitcnt lgkmcnt(0)
    v_fmac_f32 v40, v120, v100
    v_fmac_f32 v41, v120, v101
    v_fmac_f32 v42, v120, v102
    v_fmac_f32 v43, v120, v103
    v_fmac_f32 v44, v120, v104
    v_fmac_f32 v45, v120, v105
    v_fmac_f32 v46, v120, v106
    v_fmac_f32 v47, v120, v107
    v_fmac_f32 v48, v120, v108
    v_fmac_f32 v49, v120, v109
    v_fmac_f32 v50, v120, v110
    v_fmac_f32 v51, v120, v111
    v_fmac_f32 v52, v120, v112
    v_fmac_f32 v53, v120, v113
    v_fmac_f32 v54, v120, v114
    v_fmac_f32 v55, v120, v115
    v_fmac_f32 v56, v120, v116
    v_fmac_f32 v57, v120, v117
    ds_read_b128 v[100:103], v9 offset:1120
    ds_read_b128 v[104:107], v9 offset:1136
    ds_read_b128 v[108:111], v9 offset:1152
    ds_read_b128 v[112:115], v9 offset:1168
    ds_read_b64 v[116:117], v9 offset:1184
    v_lshlrev_b32 v120, 16, v23
    s_waitcnt lgkmcnt(0)
    v_fmac_f32 v40, v120, v100
    v_fmac_f32 v41, v120, v101
    v_fmac_f32 v42, v120, v102
    v_fmac_f32 v43, v120, v103
    v_fmac_f32 v44, v120, v104
    v_fmac_f32 v45, v120, v105
    v_fmac_f32 v46, v120, v106
    v_fmac_f32 v47, v120, v107
    v_fmac_f32 v48, v120, v108
    v_fmac_f32 v49, v120, v109
    v_fmac_f32 v50, v120, v110
    v_fmac_f32 v51, v120, v111
    v_fmac_f32 v52, v120, v112
    v_fmac_f32 v53, v120, v113
    v_fmac_f32 v54, v120, v114
    v_fmac_f32 v55, v120, v115
    v_fmac_f32 v56, v120, v116
    v_fmac_f32 v57, v120, v117
    ds_read_b128 v[100:103], v9 offset:1200
    ds_read_b128 v[104:107], v9 offset:1216
    ds_read_b128 v[108:111], v9 offset:1232
    ds_read_b128 v[112:115], v9 offset:1248
    ds_read_b64 v[116:117], v9 offset:1264
    v_and_b32 v120, 0xffff0000, v23
    s_waitcnt lgkmcnt(0)
    v_fmac_f32 v40, v120, v100
    v_fmac_f32 v41, v120, v101
    v_fmac_f32 v42, v120, v102
    v_fmac_f32 v43, v120, v103
    v_fmac_f32 v44, v120, v104
    v_fmac_f32 v45, v120, v105
    v_fmac_f32 v46, v120, v106
    v_fmac_f32 v47, v120, v107
    v_fmac_f32 v48, v120, v108
    v_fmac_f32 v49, v120, v109
    v_fmac_f32 v50, v120, v110
    v_fmac_f32 v51, v120, v111
    v_fmac_f32 v52, v120, v112
    v_fmac_f32 v53, v120, v113
    v_fmac_f32 v54, v120, v114
    v_fmac_f32 v55, v120, v115
    v_fmac_f32 v56, v120, v116
    v_fmac_f32 v57, v120, v117
    ds_read_b128 v[100:103], v9 offset:1280
    ds_read_b128 v[104:107], v9 offset:1296
    ds_read_b128 v[108:111], v9 offset:1312
    ds_read_b128 v[112:115], v9 offset:1328
    ds_read_b64 v[116:117], v9 offset:1344
    v_lshlrev_b32 v120, 16, v24
    s_waitcnt lgkmcnt(0)
    v_fmac_f32 v40, v120, v100
    v_fmac_f32 v41, v120, v101
    v_fmac_f32 v42, v120, v102
    v_fmac_f32 v43, v120, v103
    v_fmac_f32 v44, v120, v104
    v_fmac_f32 v45, v120, v105
    v_fmac_f32 v46, v120, v106
    v_fmac_f32 v47, v120, v107
    v_fmac_f32 v48, v120, v108
    v_fmac_f32 v49, v120, v109
    v_fmac_f32 v50, v120, v110
    v_fmac_f32 v51, v120, v111
    v_fmac_f32 v52, v120, v112
    v_fmac_f32 v53, v120, v113
    v_fmac_f32 v54, v120, v114
    v_fmac_f32 v55, v120, v115
    v_fmac_f32 v56, v120, v116
    v_fmac_f32 v57, v120, v117
    ds_read_b128 v[100:103], v9 offset:1360
    ds_read_b128 v[104:107], v9 offset:1376
    ds_read_b128 v[108:111], v9 offset:1392
    ds_read_b128 v[112:115], v9 offset:1408
    ds_read_b64 v[116:117], v9 offset:1424
    v_and_b32 v120, 0xffff0000, v24
    s_waitcnt lgkmcnt(0)
    v_fmac_f32 v40, v120, v100
    v_fmac_f32 v41, v120, v101
    v_fmac_f32 v42, v120, v102
    v_fmac_f32 v43, v120, v103
    v_fmac_f32 v44, v120, v104
    v_fmac_f32 v45, v120, v105
    v_fmac_f32 v46, v120, v106
    v_fmac_f32 v47, v120, v107
    v_fmac_f32 v48, v120, v108
    v_fmac_f32 v49, v120, v109
    v_fmac_f32 v50, v120, v110
    v_fmac_f32 v51, v120, v111
    v_fmac_f32 v52, v120, v112
    v_fmac_f32 v53, v120, v113
    v_fmac_f32 v54, v120, v114
    v_fmac_f32 v55, v120, v115
    v_fmac_f32 v56, v120, v116
    v_fmac_f32 v57, v120, v117
    v_cvt_pk_bf16_f32 v100, v40, v40
    v_lshlrev_b32 v40, 16, v100
    v_cvt_pk_bf16_f32 v100, v41, v41
    v_lshlrev_b32 v41, 16, v100
    v_cvt_pk_bf16_f32 v100, v42, v42
    v_lshlrev_b32 v42, 16, v100
    v_cvt_pk_bf16_f32 v100, v43, v43
    v_lshlrev_b32 v43, 16, v100
    v_cvt_pk_bf16_f32 v100, v44, v44
    v_lshlrev_b32 v44, 16, v100
    v_cvt_pk_bf16_f32 v100, v45, v45
    v_lshlrev_b32 v45, 16, v100
    v_cvt_pk_bf16_f32 v100, v46, v46
    v_lshlrev_b32 v46, 16, v100
    v_cvt_pk_bf16_f32 v100, v47, v47
    v_lshlrev_b32 v47, 16, v100
    v_cvt_pk_bf16_f32 v100, v48, v48
    v_lshlrev_b32 v48, 16, v100
    v_cvt_pk_bf16_f32 v100, v49, v49
    v_lshlrev_b32 v49, 16, v100
    v_cvt_pk_bf16_f32 v100, v50, v50
    v_lshlrev_b32 v50, 16, v100
    v_cvt_pk_bf16_f32 v100, v51, v51
    v_lshlrev_b32 v51, 16, v100
    v_cvt_pk_bf16_f32 v100, v52, v52
    v_lshlrev_b32 v52, 16, v100
    v_cvt_pk_bf16_f32 v100, v53, v53
    v_lshlrev_b32 v53, 16, v100
    v_cvt_pk_bf16_f32 v100, v54, v54
    v_lshlrev_b32 v54, 16, v100
    v_cvt_pk_bf16_f32 v100, v55, v55
    v_lshlrev_b32 v55, 16, v100
    v_cvt_pk_bf16_f32 v100, v56, v56
    v_lshlrev_b32 v56, 16, v100
    v_cvt_pk_bf16_f32 v100, v57, v57
    v_lshlrev_b32 v57, 16, v100
    v_max3_f32 v100, v40, v41, v42
    v_min3_f32 v101, v40, v41, v42
    v_max3_f32 v100, v100, v43, v44
    v_min3_f32 v101, v101, v43, v44
    v_max3_f32 v100, v100, v45, v46
    v_min3_f32 v101, v101, v45, v46
    v_max3_f32 v100, v100, v47, v48
    v_min3_f32 v101, v101, v47, v48
    v_max3_f32 v100, v100, v49, v50
    v_min3_f32 v101, v101, v49, v50
    v_max3_f32 v100, v100, v51, v52
    v_min3_f32 v101, v101, v51, v52
    v_max3_f32 v100, v100, v53, v54
    v_min3_f32 v101, v101, v53, v54
    v_max3_f32 v100, v100, v55, v56
    v_min3_f32 v101, v101, v55, v56
    v_max_f32 v100, v100, v57
    v_min_f32 v101, v101, v57
    v_sub_f32 v60, v40, v100
    v_sub_f32 v78, v101, v40
    v_sub_f32 v61, v41, v100
    v_sub_f32 v79, v101, v41
    v_sub_f32 v62, v42, v100
    v_sub_f32 v80, v101, v42
    v_sub_f32 v63, v43, v100
    v_sub_f32 v81, v101, v43
    v_sub_f32 v64, v44, v100
    v_sub_f32 v82, v101, v44
    v_sub_f32 v65, v45, v100
    v_sub_f32 v83, v101, v45
    v_sub_f32 v66, v46, v100
    v_sub_f32 v84, v101, v46
    v_sub_f32 v67, v47, v100
    v_sub_f32 v85, v101, v47
    v_sub_f32 v68, v48, v100
    v_sub_f32 v86, v101, v48
    v_sub_f32 v69, v49, v100
    v_sub_f32 v87, v101, v49
    v_sub_f32 v70, v50, v100
    v_sub_f32 v88, v101, v50
    v_sub_f32 v71, v51, v100
    v_sub_f32 v89, v101, v51
    v_sub_f32 v72, v52, v100
    v_sub_f32 v90, v101, v52
    v_sub_f32 v73, v53, v100
    v_sub_f32 v91, v101, v53
    v_sub_f32 v74, v54, v100
    v_sub_f32 v92, v101, v54
    v_sub_f32 v75, v55, v100
    v_sub_f32 v93, v101, v55
    v_sub_f32 v76, v56, v100
    v_sub_f32 v94, v101, v56
    v_sub_f32 v77, v57, v100
    v_sub_f32 v95, v101, v57
    v_mul_f32 v60, 0x3fb8aa3b, v60
    v_mul_f32 v61, 0x3fb8aa3b, v61
    v_mul_f32 v62, 0x3fb8aa3b, v62
    v_mul_f32 v63, 0x3fb8aa3b, v63
    v_mul_f32 v64, 0x3fb8aa3b, v64
    v_mul_f32 v65, 0x3fb8aa3b, v65
    v_mul_f32 v66, 0x3fb8aa3b, v66
    v_mul_f32 v67, 0x3fb8aa3b, v67
    v_mul_f32 v68, 0x3fb8aa3b, v68
    v_mul_f32 v69, 0x3fb8aa3b, v69
    v_mul_f32 v70, 0x3fb8aa3b, v70
    v_mul_f32 v71, 0x3fb8aa3b, v71
    v_mul_f32 v72, 0x3fb8aa3b, v72
    v_mul_f32 v73, 0x3fb8aa3b, v73
    v_mul_f32 v74, 0x3fb8aa3b, v74
    v_mul_f32 v75, 0x3fb8aa3b, v75
    v_mul_f32 v76, 0x3fb8aa3b, v76
    v_mul_f32 v77, 0x3fb8aa3b, v77
    v_mul_f32 v78, 0x3fb8aa3b, v78
    v_mul_f32 v79, 0x3fb8aa3b, v79
    v_mul_f32 v80, 0x3fb8aa3b, v80
    v_mul_f32 v81, 0x3fb8aa3b, v81
    v_mul_f32 v82, 0x3fb8aa3b, v82
    v_mul_f32 v83, 0x3fb8aa3b, v83
    v_mul_f32 v84, 0x3fb8aa3b, v84
    v_mul_f32 v85, 0x3fb8aa3b, v85
    v_mul_f32 v86, 0x3fb8aa3b, v86
    v_mul_f32 v87, 0x3fb8aa3b, v87
    v_mul_f32 v88, 0x3fb8aa3b, v88
    v_mul_f32 v89, 0x3fb8aa3b, v89
    v_mul_f32 v90, 0x3fb8aa3b, v90
    v_mul_f32 v91, 0x3fb8aa3b, v91
    v_mul_f32 v92, 0x3fb8aa3b, v92
    v_mul_f32 v93, 0x3fb8aa3b, v93
    v_mul_f32 v94, 0x3fb8aa3b, v94
    v_mul_f32 v95, 0x3fb8aa3b, v95
    v_exp_f32 v60, v60
    v_exp_f32 v61, v61
    v_exp_f32 v62, v62
    v_exp_f32 v63, v63
    v_exp_f32 v64, v64
    v_exp_f32 v65, v65
    v_exp_f32 v66, v66
    v_exp_f32 v67, v67
    v_exp_f32 v68, v68
    v_exp_f32 v69, v69
    v_exp_f32 v70, v70
    v_exp_f32 v71, v71
    v_exp_f32 v72, v72
    v_exp_f32 v73, v73
    v_exp_f32 v74, v74
    v_exp_f32 v75, v75
    v_exp_f32 v76, v76
    v_exp_f32 v77, v77
    v_exp_f32 v78, v78
    v_exp_f32 v79, v79
    v_exp_f32 v80, v80
    v_exp_f32 v81, v81
    v_exp_f32 v82, v82
    v_exp_f32 v83, v83
    v_exp_f32 v84, v84
    v_exp_f32 v85, v85
    v_exp_f32 v86, v86
    v_exp_f32 v87, v87
    v_exp_f32 v88, v88
    v_exp_f32 v89, v89
    v_exp_f32 v90, v90
    v_exp_f32 v91, v91
    v_exp_f32 v92, v92
    v_exp_f32 v93, v93
    v_exp_f32 v94, v94
    v_exp_f32 v95, v95
    v_add_f32 v102, v60, v61
    v_add_f32 v102, v102, v62
    v_add_f32 v102, v102, v63
    v_add_f32 v102, v102, v64
    v_add_f32 v102, v102, v65
    v_add_f32 v102, v102, v66
    v_add_f32 v102, v102, v67
    v_add_f32 v102, v102, v68
    v_add_f32 v102, v102, v69
    v_add_f32 v102, v102, v70
    v_add_f32 v102, v102, v71
    v_add_f32 v102, v102, v72
    v_add_f32 v102, v102, v73
    v_add_f32 v102, v102, v74
    v_add_f32 v102, v102, v75
    v_add_f32 v102, v102, v76
    v_add_f32 v102, v102, v77
    v_rcp_f32 v102, v102
    v_add_f32 v103, v78, v79
    v_add_f32 v103, v103, v80
    v_add_f32 v103, v103, v81
    v_add_f32 v103, v103, v82
    v_add_f32 v103, v103, v83
    v_add_f32 v103, v103, v84
    v_add_f32 v103, v103, v85
    v_add_f32 v103, v103, v86
    v_add_f32 v103, v103, v87
    v_add_f32 v103, v103, v88
    v_add_f32 v103, v103, v89
    v_add_f32 v103, v103, v90
    v_add_f32 v103, v103, v91
    v_add_f32 v103, v103, v92
    v_add_f32 v103, v103, v93
    v_add_f32 v103, v103, v94
    v_add_f32 v103, v103, v95
    v_rcp_f32 v103, v103
    s_nop 0
    v_mul_f32 v60, v60, v102
    v_mul_f32 v61, v61, v102
    v_mul_f32 v62, v62, v102
    v_mul_f32 v63, v63, v102
    v_mul_f32 v64, v64, v102
    v_mul_f32 v65, v65, v102
    v_mul_f32 v66, v66, v102
    v_mul_f32 v67, v67, v102
    v_mul_f32 v68, v68, v102
    v_mul_f32 v69, v69, v102
    v_mul_f32 v70, v70, v102
    v_mul_f32 v71, v71, v102
    v_mul_f32 v72, v72, v102
    v_mul_f32 v73, v73, v102
    v_mul_f32 v74, v74, v102
    v_mul_f32 v75, v75, v102
    v_mul_f32 v76, v76, v102
    v_mul_f32 v77, v77, v102
    v_mul_f32 v78, v78, v103
    v_mul_f32 v79, v79, v103
    v_mul_f32 v80, v80, v103
    v_mul_f32 v81, v81, v103
    v_mul_f32 v82, v82, v103
    v_mul_f32 v83, v83, v103
    v_mul_f32 v84, v84, v103
    v_mul_f32 v85, v85, v103
    v_mul_f32 v86, v86, v103
    v_mul_f32 v87, v87, v103
    v_mul_f32 v88, v88, v103
    v_mul_f32 v89, v89, v103
    v_mul_f32 v90, v90, v103
    v_mul_f32 v91, v91, v103
    v_mul_f32 v92, v92, v103
    v_mul_f32 v93, v93, v103
    v_mul_f32 v94, v94, v103
    v_mul_f32 v95, v95, v103
    v_cvt_pk_bf16_f32 v100, v60, v60
    v_lshlrev_b32 v60, 16, v100
    v_cvt_pk_bf16_f32 v100, v61, v61
    v_lshlrev_b32 v61, 16, v100
    v_cvt_pk_bf16_f32 v100, v62, v62
    v_lshlrev_b32 v62, 16, v100
    v_cvt_pk_bf16_f32 v100, v63, v63
    v_lshlrev_b32 v63, 16, v100
    v_cvt_pk_bf16_f32 v100, v64, v64
    v_lshlrev_b32 v64, 16, v100
    v_cvt_pk_bf16_f32 v100, v65, v65
    v_lshlrev_b32 v65, 16, v100
    v_cvt_pk_bf16_f32 v100, v66, v66
    v_lshlrev_b32 v66, 16, v100
    v_cvt_pk_bf16_f32 v100, v67, v67
    v_lshlrev_b32 v67, 16, v100
    v_cvt_pk_bf16_f32 v100, v68, v68
    v_lshlrev_b32 v68, 16, v100
    v_cvt_pk_bf16_f32 v100, v69, v69
    v_lshlrev_b32 v69, 16, v100
    v_cvt_pk_bf16_f32 v100, v70, v70
    v_lshlrev_b32 v70, 16, v100
    v_cvt_pk_bf16_f32 v100, v71, v71
    v_lshlrev_b32 v71, 16, v100
    v_cvt_pk_bf16_f32 v100, v72, v72
    v_lshlrev_b32 v72, 16, v100
    v_cvt_pk_bf16_f32 v100, v73, v73
    v_lshlrev_b32 v73, 16, v100
    v_cvt_pk_bf16_f32 v100, v74, v74
    v_lshlrev_b32 v74, 16, v100
    v_cvt_pk_bf16_f32 v100, v75, v75
    v_lshlrev_b32 v75, 16, v100
    v_cvt_pk_bf16_f32 v100, v76, v76
    v_lshlrev_b32 v76, 16, v100
    v_cvt_pk_bf16_f32 v100, v77, v77
    v_lshlrev_b32 v77, 16, v100
    v_cvt_pk_bf16_f32 v100, v78, v78
    v_lshlrev_b32 v78, 16, v100
    v_cvt_pk_bf16_f32 v100, v79, v79
    v_lshlrev_b32 v79, 16, v100
    v_cvt_pk_bf16_f32 v100, v80, v80
    v_lshlrev_b32 v80, 16, v100
    v_cvt_pk_bf16_f32 v100, v81, v81
    v_lshlrev_b32 v81, 16, v100
    v_cvt_pk_bf16_f32 v100, v82, v82
    v_lshlrev_b32 v82, 16, v100
    v_cvt_pk_bf16_f32 v100, v83, v83
    v_lshlrev_b32 v83, 16, v100
    v_cvt_pk_bf16_f32 v100, v84, v84
    v_lshlrev_b32 v84, 16, v100
    v_cvt_pk_bf16_f32 v100, v85, v85
    v_lshlrev_b32 v85, 16, v100
    v_cvt_pk_bf16_f32 v100, v86, v86
    v_lshlrev_b32 v86, 16, v100
    v_cvt_pk_bf16_f32 v100, v87, v87
    v_lshlrev_b32 v87, 16, v100
    v_cvt_pk_bf16_f32 v100, v88, v88
    v_lshlrev_b32 v88, 16, v100
    v_cvt_pk_bf16_f32 v100, v89, v89
    v_lshlrev_b32 v89, 16, v100
    v_cvt_pk_bf16_f32 v100, v90, v90
    v_lshlrev_b32 v90, 16, v100
    v_cvt_pk_bf16_f32 v100, v91, v91
    v_lshlrev_b32 v91, 16, v100
    v_cvt_pk_bf16_f32 v100, v92, v92
    v_lshlrev_b32 v92, 16, v100
    v_cvt_pk_bf16_f32 v100, v93, v93
    v_lshlrev_b32 v93, 16, v100
    v_cvt_pk_bf16_f32 v100, v94, v94
    v_lshlrev_b32 v94, 16, v100
    v_cvt_pk_bf16_f32 v100, v95, v95
    v_lshlrev_b32 v95, 16, v100
    v_mov_b32 v40, 0
    v_mov_b32 v41, 0
    v_mov_b32 v42, 0
    v_mov_b32 v43, 0
    v_mov_b32 v44, 0
    v_mov_b32 v45, 0
    v_mov_b32 v46, 0
    v_mov_b32 v47, 0
    v_mov_b32 v48, 0
    v_mov_b32 v49, 0
    v_mov_b32 v50, 0
    v_mov_b32 v51, 0
    v_mov_b32 v52, 0
    v_mov_b32 v53, 0
    v_mov_b32 v54, 0
    v_mov_b32 v55, 0
    v_mov_b32 v56, 0
    v_mov_b32 v57, 0
    v_mov_b32 v58, 0
    ds_read_b128 v[100:103], v9 offset:2048
    ds_read_b128 v[104:107], v9 offset:2064
    ds_read_b128 v[108:111], v9 offset:2080
    ds_read_b128 v[112:115], v9 offset:2096
    ds_read_b96 v[116:118], v9 offset:2112
    s_waitcnt lgkmcnt(0)
    v_fmac_f32 v40, v60, v100
    v_fmac_f32 v41, v60, v101
    v_fmac_f32 v42, v60, v102
    v_fmac_f32 v43, v60, v103
    v_fmac_f32 v44, v60, v104
    v_fmac_f32 v45, v60, v105
    v_fmac_f32 v46, v60, v106
    v_fmac_f32 v47, v60, v107
    v_fmac_f32 v48, v60, v108
    v_fmac_f32 v49, v60, v109
    v_fmac_f32 v50, v60, v110
    v_fmac_f32 v51, v60, v111
    v_fmac_f32 v52, v60, v112
    v_fmac_f32 v53, v60, v113
    v_fmac_f32 v54, v60, v114
    v_fmac_f32 v55, v60, v115
    v_fmac_f32 v56, v60, v116
    v_fmac_f32 v57, v60, v117
    v_fmac_f32 v58, v60, v118
    ds_read_b128 v[100:103], v9 offset:2128
    ds_read_b128 v[104:107], v9 offset:2144
    ds_read_b128 v[108:111], v9 offset:2160
    ds_read_b128 v[112:115], v9 offset:2176
    ds_read_b96 v[116:118], v9 offset:2192
    s_waitcnt lgkmcnt(0)
    v_fmac_f32 v40, v61, v100
    v_fmac_f32 v41, v61, v101
    v_fmac_f32 v42, v61, v102
    v_fmac_f32 v43, v61, v103
    v_fmac_f32 v44, v61, v104
    v_fmac_f32 v45, v61, v105
    v_fmac_f32 v46, v61, v106
    v_fmac_f32 v47, v61, v107
    v_fmac_f32 v48, v61, v108
    v_fmac_f32 v49, v61, v109
    v_fmac_f32 v50, v61, v110
    v_fmac_f32 v51, v61, v111
    v_fmac_f32 v52, v61, v112
    v_fmac_f32 v53, v61, v113
    v_fmac_f32 v54, v61, v114
    v_fmac_f32 v55, v61, v115
    v_fmac_f32 v56, v61, v116
    v_fmac_f32 v57, v61, v117
    v_fmac_f32 v58, v61, v118
    ds_read_b128 v[100:103], v9 offset:2208
    ds_read_b128 v[104:107], v9 offset:2224
    ds_read_b128 v[108:111], v9 offset:2240
    ds_read_b128 v[112:115], v9 offset:2256
    ds_read_b96 v[116:118], v9 offset:2272
    s_waitcnt lgkmcnt(0)
    v_fmac_f32 v40, v62, v100
    v_fmac_f32 v41, v62, v101
    v_fmac_f32 v42, v62, v102
    v_fmac_f32 v43, v62, v103
    v_fmac_f32 v44, v62, v104
    v_fmac_f32 v45, v62, v105
    v_fmac_f32 v46, v62, v106
    v_fmac_f32 v47, v62, v107
    v_fmac_f32 v48, v62, v108
    v_fmac_f32 v49, v62, v109
    v_fmac_f32 v50, v62, v110
    v_fmac_f32 v51, v62, v111
    v_fmac_f32 v52, v62, v112
    v_fmac_f32 v53, v62, v113
    v_fmac_f32 v54, v62, v114
    v_fmac_f32 v55, v62, v115
    v_fmac_f32 v56, v62, v116
    v_fmac_f32 v57, v62, v117
    v_fmac_f32 v58, v62, v118
    ds_read_b128 v[100:103], v9 offset:2288
    ds_read_b128 v[104:107], v9 offset:2304
    ds_read_b128 v[108:111], v9 offset:2320
    ds_read_b128 v[112:115], v9 offset:2336
    ds_read_b96 v[116:118], v9 offset:2352
    s_waitcnt lgkmcnt(0)
    v_fmac_f32 v40, v63, v100
    v_fmac_f32 v41, v63, v101
    v_fmac_f32 v42, v63, v102
    v_fmac_f32 v43, v63, v103
    v_fmac_f32 v44, v63, v104
    v_fmac_f32 v45, v63, v105
    v_fmac_f32 v46, v63, v106
    v_fmac_f32 v47, v63, v107
    v_fmac_f32 v48, v63, v108
    v_fmac_f32 v49, v63, v109
    v_fmac_f32 v50, v63, v110
    v_fmac_f32 v51, v63, v111
    v_fmac_f32 v52, v63, v112
    v_fmac_f32 v53, v63, v113
    v_fmac_f32 v54, v63, v114
    v_fmac_f32 v55, v63, v115
    v_fmac_f32 v56, v63, v116
    v_fmac_f32 v57, v63, v117
    v_fmac_f32 v58, v63, v118
    ds_read_b128 v[100:103], v9 offset:2368
    ds_read_b128 v[104:107], v9 offset:2384
    ds_read_b128 v[108:111], v9 offset:2400
    ds_read_b128 v[112:115], v9 offset:2416
    ds_read_b96 v[116:118], v9 offset:2432
    s_waitcnt lgkmcnt(0)
    v_fmac_f32 v40, v64, v100
    v_fmac_f32 v41, v64, v101
    v_fmac_f32 v42, v64, v102
    v_fmac_f32 v43, v64, v103
    v_fmac_f32 v44, v64, v104
    v_fmac_f32 v45, v64, v105
    v_fmac_f32 v46, v64, v106
    v_fmac_f32 v47, v64, v107
    v_fmac_f32 v48, v64, v108
    v_fmac_f32 v49, v64, v109
    v_fmac_f32 v50, v64, v110
    v_fmac_f32 v51, v64, v111
    v_fmac_f32 v52, v64, v112
    v_fmac_f32 v53, v64, v113
    v_fmac_f32 v54, v64, v114
    v_fmac_f32 v55, v64, v115
    v_fmac_f32 v56, v64, v116
    v_fmac_f32 v57, v64, v117
    v_fmac_f32 v58, v64, v118
    ds_read_b128 v[100:103], v9 offset:2448
    ds_read_b128 v[104:107], v9 offset:2464
    ds_read_b128 v[108:111], v9 offset:2480
    ds_read_b128 v[112:115], v9 offset:2496
    ds_read_b96 v[116:118], v9 offset:2512
    s_waitcnt lgkmcnt(0)
    v_fmac_f32 v40, v65, v100
    v_fmac_f32 v41, v65, v101
    v_fmac_f32 v42, v65, v102
    v_fmac_f32 v43, v65, v103
    v_fmac_f32 v44, v65, v104
    v_fmac_f32 v45, v65, v105
    v_fmac_f32 v46, v65, v106
    v_fmac_f32 v47, v65, v107
    v_fmac_f32 v48, v65, v108
    v_fmac_f32 v49, v65, v109
    v_fmac_f32 v50, v65, v110
    v_fmac_f32 v51, v65, v111
    v_fmac_f32 v52, v65, v112
    v_fmac_f32 v53, v65, v113
    v_fmac_f32 v54, v65, v114
    v_fmac_f32 v55, v65, v115
    v_fmac_f32 v56, v65, v116
    v_fmac_f32 v57, v65, v117
    v_fmac_f32 v58, v65, v118
    ds_read_b128 v[100:103], v9 offset:2528
    ds_read_b128 v[104:107], v9 offset:2544
    ds_read_b128 v[108:111], v9 offset:2560
    ds_read_b128 v[112:115], v9 offset:2576
    ds_read_b96 v[116:118], v9 offset:2592
    s_waitcnt lgkmcnt(0)
    v_fmac_f32 v40, v66, v100
    v_fmac_f32 v41, v66, v101
    v_fmac_f32 v42, v66, v102
    v_fmac_f32 v43, v66, v103
    v_fmac_f32 v44, v66, v104
    v_fmac_f32 v45, v66, v105
    v_fmac_f32 v46, v66, v106
    v_fmac_f32 v47, v66, v107
    v_fmac_f32 v48, v66, v108
    v_fmac_f32 v49, v66, v109
    v_fmac_f32 v50, v66, v110
    v_fmac_f32 v51, v66, v111
    v_fmac_f32 v52, v66, v112
    v_fmac_f32 v53, v66, v113
    v_fmac_f32 v54, v66, v114
    v_fmac_f32 v55, v66, v115
    v_fmac_f32 v56, v66, v116
    v_fmac_f32 v57, v66, v117
    v_fmac_f32 v58, v66, v118
    ds_read_b128 v[100:103], v9 offset:2608
    ds_read_b128 v[104:107], v9 offset:2624
    ds_read_b128 v[108:111], v9 offset:2640
    ds_read_b128 v[112:115], v9 offset:2656
    ds_read_b96 v[116:118], v9 offset:2672
    s_waitcnt lgkmcnt(0)
    v_fmac_f32 v40, v67, v100
    v_fmac_f32 v41, v67, v101
    v_fmac_f32 v42, v67, v102
    v_fmac_f32 v43, v67, v103
    v_fmac_f32 v44, v67, v104
    v_fmac_f32 v45, v67, v105
    v_fmac_f32 v46, v67, v106
    v_fmac_f32 v47, v67, v107
    v_fmac_f32 v48, v67, v108
    v_fmac_f32 v49, v67, v109
    v_fmac_f32 v50, v67, v110
    v_fmac_f32 v51, v67, v111
    v_fmac_f32 v52, v67, v112
    v_fmac_f32 v53, v67, v113
    v_fmac_f32 v54, v67, v114
    v_fmac_f32 v55, v67, v115
    v_fmac_f32 v56, v67, v116
    v_fmac_f32 v57, v67, v117
    v_fmac_f32 v58, v67, v118
    ds_read_b128 v[100:103], v9 offset:2688
    ds_read_b128 v[104:107], v9 offset:2704
    ds_read_b128 v[108:111], v9 offset:2720
    ds_read_b128 v[112:115], v9 offset:2736
    ds_read_b96 v[116:118], v9 offset:2752
    s_waitcnt lgkmcnt(0)
    v_fmac_f32 v40, v68, v100
    v_fmac_f32 v41, v68, v101
    v_fmac_f32 v42, v68, v102
    v_fmac_f32 v43, v68, v103
    v_fmac_f32 v44, v68, v104
    v_fmac_f32 v45, v68, v105
    v_fmac_f32 v46, v68, v106
    v_fmac_f32 v47, v68, v107
    v_fmac_f32 v48, v68, v108
    v_fmac_f32 v49, v68, v109
    v_fmac_f32 v50, v68, v110
    v_fmac_f32 v51, v68, v111
    v_fmac_f32 v52, v68, v112
    v_fmac_f32 v53, v68, v113
    v_fmac_f32 v54, v68, v114
    v_fmac_f32 v55, v68, v115
    v_fmac_f32 v56, v68, v116
    v_fmac_f32 v57, v68, v117
    v_fmac_f32 v58, v68, v118
    ds_read_b128 v[100:103], v9 offset:2768
    ds_read_b128 v[104:107], v9 offset:2784
    ds_read_b128 v[108:111], v9 offset:2800
    ds_read_b128 v[112:115], v9 offset:2816
    ds_read_b96 v[116:118], v9 offset:2832
    s_waitcnt lgkmcnt(0)
    v_fmac_f32 v40, v69, v100
    v_fmac_f32 v41, v69, v101
    v_fmac_f32 v42, v69, v102
    v_fmac_f32 v43, v69, v103
    v_fmac_f32 v44, v69, v104
    v_fmac_f32 v45, v69, v105
    v_fmac_f32 v46, v69, v106
    v_fmac_f32 v47, v69, v107
    v_fmac_f32 v48, v69, v108
    v_fmac_f32 v49, v69, v109
    v_fmac_f32 v50, v69, v110
    v_fmac_f32 v51, v69, v111
    v_fmac_f32 v52, v69, v112
    v_fmac_f32 v53, v69, v113
    v_fmac_f32 v54, v69, v114
    v_fmac_f32 v55, v69, v115
    v_fmac_f32 v56, v69, v116
    v_fmac_f32 v57, v69, v117
    v_fmac_f32 v58, v69, v118
    ds_read_b128 v[100:103], v9 offset:2848
    ds_read_b128 v[104:107], v9 offset:2864
    ds_read_b128 v[108:111], v9 offset:2880
    ds_read_b128 v[112:115], v9 offset:2896
    ds_read_b96 v[116:118], v9 offset:2912
    s_waitcnt lgkmcnt(0)
    v_fmac_f32 v40, v70, v100
    v_fmac_f32 v41, v70, v101
    v_fmac_f32 v42, v70, v102
    v_fmac_f32 v43, v70, v103
    v_fmac_f32 v44, v70, v104
    v_fmac_f32 v45, v70, v105
    v_fmac_f32 v46, v70, v106
    v_fmac_f32 v47, v70, v107
    v_fmac_f32 v48, v70, v108
    v_fmac_f32 v49, v70, v109
    v_fmac_f32 v50, v70, v110
    v_fmac_f32 v51, v70, v111
    v_fmac_f32 v52, v70, v112
    v_fmac_f32 v53, v70, v113
    v_fmac_f32 v54, v70, v114
    v_fmac_f32 v55, v70, v115
    v_fmac_f32 v56, v70, v116
    v_fmac_f32 v57, v70, v117
    v_fmac_f32 v58, v70, v118
    ds_read_b128 v[100:103], v9 offset:2928
    ds_read_b128 v[104:107], v9 offset:2944
    ds_read_b128 v[108:111], v9 offset:2960
    ds_read_b128 v[112:115], v9 offset:2976
    ds_read_b96 v[116:118], v9 offset:2992
    s_waitcnt lgkmcnt(0)
    v_fmac_f32 v40, v71, v100
    v_fmac_f32 v41, v71, v101
    v_fmac_f32 v42, v71, v102
    v_fmac_f32 v43, v71, v103
    v_fmac_f32 v44, v71, v104
    v_fmac_f32 v45, v71, v105
    v_fmac_f32 v46, v71, v106
    v_fmac_f32 v47, v71, v107
    v_fmac_f32 v48, v71, v108
    v_fmac_f32 v49, v71, v109
    v_fmac_f32 v50, v71, v110
    v_fmac_f32 v51, v71, v111
    v_fmac_f32 v52, v71, v112
    v_fmac_f32 v53, v71, v113
    v_fmac_f32 v54, v71, v114
    v_fmac_f32 v55, v71, v115
    v_fmac_f32 v56, v71, v116
    v_fmac_f32 v57, v71, v117
    v_fmac_f32 v58, v71, v118
    ds_read_b128 v[100:103], v9 offset:3008
    ds_read_b128 v[104:107], v9 offset:3024
    ds_read_b128 v[108:111], v9 offset:3040
    ds_read_b128 v[112:115], v9 offset:3056
    ds_read_b96 v[116:118], v9 offset:3072
    s_waitcnt lgkmcnt(0)
    v_fmac_f32 v40, v72, v100
    v_fmac_f32 v41, v72, v101
    v_fmac_f32 v42, v72, v102
    v_fmac_f32 v43, v72, v103
    v_fmac_f32 v44, v72, v104
    v_fmac_f32 v45, v72, v105
    v_fmac_f32 v46, v72, v106
    v_fmac_f32 v47, v72, v107
    v_fmac_f32 v48, v72, v108
    v_fmac_f32 v49, v72, v109
    v_fmac_f32 v50, v72, v110
    v_fmac_f32 v51, v72, v111
    v_fmac_f32 v52, v72, v112
    v_fmac_f32 v53, v72, v113
    v_fmac_f32 v54, v72, v114
    v_fmac_f32 v55, v72, v115
    v_fmac_f32 v56, v72, v116
    v_fmac_f32 v57, v72, v117
    v_fmac_f32 v58, v72, v118
    ds_read_b128 v[100:103], v9 offset:3088
    ds_read_b128 v[104:107], v9 offset:3104
    ds_read_b128 v[108:111], v9 offset:3120
    ds_read_b128 v[112:115], v9 offset:3136
    ds_read_b96 v[116:118], v9 offset:3152
    s_waitcnt lgkmcnt(0)
    v_fmac_f32 v40, v73, v100
    v_fmac_f32 v41, v73, v101
    v_fmac_f32 v42, v73, v102
    v_fmac_f32 v43, v73, v103
    v_fmac_f32 v44, v73, v104
    v_fmac_f32 v45, v73, v105
    v_fmac_f32 v46, v73, v106
    v_fmac_f32 v47, v73, v107
    v_fmac_f32 v48, v73, v108
    v_fmac_f32 v49, v73, v109
    v_fmac_f32 v50, v73, v110
    v_fmac_f32 v51, v73, v111
    v_fmac_f32 v52, v73, v112
    v_fmac_f32 v53, v73, v113
    v_fmac_f32 v54, v73, v114
    v_fmac_f32 v55, v73, v115
    v_fmac_f32 v56, v73, v116
    v_fmac_f32 v57, v73, v117
    v_fmac_f32 v58, v73, v118
    ds_read_b128 v[100:103], v9 offset:3168
    ds_read_b128 v[104:107], v9 offset:3184
    ds_read_b128 v[108:111], v9 offset:3200
    ds_read_b128 v[112:115], v9 offset:3216
    ds_read_b96 v[116:118], v9 offset:3232
    s_waitcnt lgkmcnt(0)
    v_fmac_f32 v40, v74, v100
    v_fmac_f32 v41, v74, v101
    v_fmac_f32 v42, v74, v102
    v_fmac_f32 v43, v74, v103
    v_fmac_f32 v44, v74, v104
    v_fmac_f32 v45, v74, v105
    v_fmac_f32 v46, v74, v106
    v_fmac_f32 v47, v74, v107
    v_fmac_f32 v48, v74, v108
    v_fmac_f32 v49, v74, v109
    v_fmac_f32 v50, v74, v110
    v_fmac_f32 v51, v74, v111
    v_fmac_f32 v52, v74, v112
    v_fmac_f32 v53, v74, v113
    v_fmac_f32 v54, v74, v114
    v_fmac_f32 v55, v74, v115
    v_fmac_f32 v56, v74, v116
    v_fmac_f32 v57, v74, v117
    v_fmac_f32 v58, v74, v118
    ds_read_b128 v[100:103], v9 offset:3248
    ds_read_b128 v[104:107], v9 offset:3264
    ds_read_b128 v[108:111], v9 offset:3280
    ds_read_b128 v[112:115], v9 offset:3296
    ds_read_b96 v[116:118], v9 offset:3312
    s_waitcnt lgkmcnt(0)
    v_fmac_f32 v40, v75, v100
    v_fmac_f32 v41, v75, v101
    v_fmac_f32 v42, v75, v102
    v_fmac_f32 v43, v75, v103
    v_fmac_f32 v44, v75, v104
    v_fmac_f32 v45, v75, v105
    v_fmac_f32 v46, v75, v106
    v_fmac_f32 v47, v75, v107
    v_fmac_f32 v48, v75, v108
    v_fmac_f32 v49, v75, v109
    v_fmac_f32 v50, v75, v110
    v_fmac_f32 v51, v75, v111
    v_fmac_f32 v52, v75, v112
    v_fmac_f32 v53, v75, v113
    v_fmac_f32 v54, v75, v114
    v_fmac_f32 v55, v75, v115
    v_fmac_f32 v56, v75, v116
    v_fmac_f32 v57, v75, v117
    v_fmac_f32 v58, v75, v118
    ds_read_b128 v[100:103], v9 offset:3328
    ds_read_b128 v[104:107], v9 offset:3344
    ds_read_b128 v[108:111], v9 offset:3360
    ds_read_b128 v[112:115], v9 offset:3376
    ds_read_b96 v[116:118], v9 offset:3392
    s_waitcnt lgkmcnt(0)
    v_fmac_f32 v40, v76, v100
    v_fmac_f32 v41, v76, v101
    v_fmac_f32 v42, v76, v102
    v_fmac_f32 v43, v76, v103
    v_fmac_f32 v44, v76, v104
    v_fmac_f32 v45, v76, v105
    v_fmac_f32 v46, v76, v106
    v_fmac_f32 v47, v76, v107
    v_fmac_f32 v48, v76, v108
    v_fmac_f32 v49, v76, v109
    v_fmac_f32 v50, v76, v110
    v_fmac_f32 v51, v76, v111
    v_fmac_f32 v52, v76, v112
    v_fmac_f32 v53, v76, v113
    v_fmac_f32 v54, v76, v114
    v_fmac_f32 v55, v76, v115
    v_fmac_f32 v56, v76, v116
    v_fmac_f32 v57, v76, v117
    v_fmac_f32 v58, v76, v118
    ds_read_b128 v[100:103], v9 offset:3408
    ds_read_b128 v[104:107], v9 offset:3424
    ds_read_b128 v[108:111], v9 offset:3440
    ds_read_b128 v[112:115], v9 offset:3456
    ds_read_b96 v[116:118], v9 offset:3472
    s_waitcnt lgkmcnt(0)
    v_fmac_f32 v40, v77, v100
    v_fmac_f32 v41, v77, v101
    v_fmac_f32 v42, v77, v102
    v_fmac_f32 v43, v77, v103
    v_fmac_f32 v44, v77, v104
    v_fmac_f32 v45, v77, v105
    v_fmac_f32 v46, v77, v106
    v_fmac_f32 v47, v77, v107
    v_fmac_f32 v48, v77, v108
    v_fmac_f32 v49, v77, v109
    v_fmac_f32 v50, v77, v110
    v_fmac_f32 v51, v77, v111
    v_fmac_f32 v52, v77, v112
    v_fmac_f32 v53, v77, v113
    v_fmac_f32 v54, v77, v114
    v_fmac_f32 v55, v77, v115
    v_fmac_f32 v56, v77, v116
    v_fmac_f32 v57, v77, v117
    v_fmac_f32 v58, v77, v118
    ds_read_b128 v[100:103], v9 offset:3488
    ds_read_b128 v[104:107], v9 offset:3504
    ds_read_b128 v[108:111], v9 offset:3520
    ds_read_b128 v[112:115], v9 offset:3536
    ds_read_b96 v[116:118], v9 offset:3552
    s_waitcnt lgkmcnt(0)
    v_fmac_f32 v40, v78, v100
    v_fmac_f32 v41, v78, v101
    v_fmac_f32 v42, v78, v102
    v_fmac_f32 v43, v78, v103
    v_fmac_f32 v44, v78, v104
    v_fmac_f32 v45, v78, v105
    v_fmac_f32 v46, v78, v106
    v_fmac_f32 v47, v78, v107
    v_fmac_f32 v48, v78, v108
    v_fmac_f32 v49, v78, v109
    v_fmac_f32 v50, v78, v110
    v_fmac_f32 v51, v78, v111
    v_fmac_f32 v52, v78, v112
    v_fmac_f32 v53, v78, v113
    v_fmac_f32 v54, v78, v114
    v_fmac_f32 v55, v78, v115
    v_fmac_f32 v56, v78, v116
    v_fmac_f32 v57, v78, v117
    v_fmac_f32 v58, v78, v118
    ds_read_b128 v[100:103], v9 offset:3568
    ds_read_b128 v[104:107], v9 offset:3584
    ds_read_b128 v[108:111], v9 offset:3600
    ds_read_b128 v[112:115], v9 offset:3616
    ds_read_b96 v[116:118], v9 offset:3632
    s_waitcnt lgkmcnt(0)
    v_fmac_f32 v40, v79, v100
    v_fmac_f32 v41, v79, v101
    v_fmac_f32 v42, v79, v102
    v_fmac_f32 v43, v79, v103
    v_fmac_f32 v44, v79, v104
    v_fmac_f32 v45, v79, v105
    v_fmac_f32 v46, v79, v106
    v_fmac_f32 v47, v79, v107
    v_fmac_f32 v48, v79, v108
    v_fmac_f32 v49, v79, v109
    v_fmac_f32 v50, v79, v110
    v_fmac_f32 v51, v79, v111
    v_fmac_f32 v52, v79, v112
    v_fmac_f32 v53, v79, v113
    v_fmac_f32 v54, v79, v114
    v_fmac_f32 v55, v79, v115
    v_fmac_f32 v56, v79, v116
    v_fmac_f32 v57, v79, v117
    v_fmac_f32 v58, v79, v118
    ds_read_b128 v[100:103], v9 offset:3648
    ds_read_b128 v[104:107], v9 offset:3664
    ds_read_b128 v[108:111], v9 offset:3680
    ds_read_b128 v[112:115], v9 offset:3696
    ds_read_b96 v[116:118], v9 offset:3712
    s_waitcnt lgkmcnt(0)
    v_fmac_f32 v40, v80, v100
    v_fmac_f32 v41, v80, v101
    v_fmac_f32 v42, v80, v102
    v_fmac_f32 v43, v80, v103
    v_fmac_f32 v44, v80, v104
    v_fmac_f32 v45, v80, v105
    v_fmac_f32 v46, v80, v106
    v_fmac_f32 v47, v80, v107
    v_fmac_f32 v48, v80, v108
    v_fmac_f32 v49, v80, v109
    v_fmac_f32 v50, v80, v110
    v_fmac_f32 v51, v80, v111
    v_fmac_f32 v52, v80, v112
    v_fmac_f32 v53, v80, v113
    v_fmac_f32 v54, v80, v114
    v_fmac_f32 v55, v80, v115
    v_fmac_f32 v56, v80, v116
    v_fmac_f32 v57, v80, v117
    v_fmac_f32 v58, v80, v118
    ds_read_b128 v[100:103], v9 offset:3728
    ds_read_b128 v[104:107], v9 offset:3744
    ds_read_b128 v[108:111], v9 offset:3760
    ds_read_b128 v[112:115], v9 offset:3776
    ds_read_b96 v[116:118], v9 offset:3792
    s_waitcnt lgkmcnt(0)
    v_fmac_f32 v40, v81, v100
    v_fmac_f32 v41, v81, v101
    v_fmac_f32 v42, v81, v102
    v_fmac_f32 v43, v81, v103
    v_fmac_f32 v44, v81, v104
    v_fmac_f32 v45, v81, v105
    v_fmac_f32 v46, v81, v106
    v_fmac_f32 v47, v81, v107
    v_fmac_f32 v48, v81, v108
    v_fmac_f32 v49, v81, v109
    v_fmac_f32 v50, v81, v110
    v_fmac_f32 v51, v81, v111
    v_fmac_f32 v52, v81, v112
    v_fmac_f32 v53, v81, v113
    v_fmac_f32 v54, v81, v114
    v_fmac_f32 v55, v81, v115
    v_fmac_f32 v56, v81, v116
    v_fmac_f32 v57, v81, v117
    v_fmac_f32 v58, v81, v118
    ds_read_b128 v[100:103], v9 offset:3808
    ds_read_b128 v[104:107], v9 offset:3824
    ds_read_b128 v[108:111], v9 offset:3840
    ds_read_b128 v[112:115], v9 offset:3856
    ds_read_b96 v[116:118], v9 offset:3872
    s_waitcnt lgkmcnt(0)
    v_fmac_f32 v40, v82, v100
    v_fmac_f32 v41, v82, v101
    v_fmac_f32 v42, v82, v102
    v_fmac_f32 v43, v82, v103
    v_fmac_f32 v44, v82, v104
    v_fmac_f32 v45, v82, v105
    v_fmac_f32 v46, v82, v106
    v_fmac_f32 v47, v82, v107
    v_fmac_f32 v48, v82, v108
    v_fmac_f32 v49, v82, v109
    v_fmac_f32 v50, v82, v110
    v_fmac_f32 v51, v82, v111
    v_fmac_f32 v52, v82, v112
    v_fmac_f32 v53, v82, v113
    v_fmac_f32 v54, v82, v114
    v_fmac_f32 v55, v82, v115
    v_fmac_f32 v56, v82, v116
    v_fmac_f32 v57, v82, v117
    v_fmac_f32 v58, v82, v118
    ds_read_b128 v[100:103], v9 offset:3888
    ds_read_b128 v[104:107], v9 offset:3904
    ds_read_b128 v[108:111], v9 offset:3920
    ds_read_b128 v[112:115], v9 offset:3936
    ds_read_b96 v[116:118], v9 offset:3952
    s_waitcnt lgkmcnt(0)
    v_fmac_f32 v40, v83, v100
    v_fmac_f32 v41, v83, v101
    v_fmac_f32 v42, v83, v102
    v_fmac_f32 v43, v83, v103
    v_fmac_f32 v44, v83, v104
    v_fmac_f32 v45, v83, v105
    v_fmac_f32 v46, v83, v106
    v_fmac_f32 v47, v83, v107
    v_fmac_f32 v48, v83, v108
    v_fmac_f32 v49, v83, v109
    v_fmac_f32 v50, v83, v110
    v_fmac_f32 v51, v83, v111
    v_fmac_f32 v52, v83, v112
    v_fmac_f32 v53, v83, v113
    v_fmac_f32 v54, v83, v114
    v_fmac_f32 v55, v83, v115
    v_fmac_f32 v56, v83, v116
    v_fmac_f32 v57, v83, v117
    v_fmac_f32 v58, v83, v118
    ds_read_b128 v[100:103], v9 offset:3968
    ds_read_b128 v[104:107], v9 offset:3984
    ds_read_b128 v[108:111], v9 offset:4000
    ds_read_b128 v[112:115], v9 offset:4016
    ds_read_b96 v[116:118], v9 offset:4032
    s_waitcnt lgkmcnt(0)
    v_fmac_f32 v40, v84, v100
    v_fmac_f32 v41, v84, v101
    v_fmac_f32 v42, v84, v102
    v_fmac_f32 v43, v84, v103
    v_fmac_f32 v44, v84, v104
    v_fmac_f32 v45, v84, v105
    v_fmac_f32 v46, v84, v106
    v_fmac_f32 v47, v84, v107
    v_fmac_f32 v48, v84, v108
    v_fmac_f32 v49, v84, v109
    v_fmac_f32 v50, v84, v110
    v_fmac_f32 v51, v84, v111
    v_fmac_f32 v52, v84, v112
    v_fmac_f32 v53, v84, v113
    v_fmac_f32 v54, v84, v114
    v_fmac_f32 v55, v84, v115
    v_fmac_f32 v56, v84, v116
    v_fmac_f32 v57, v84, v117
    v_fmac_f32 v58, v84, v118
    ds_read_b128 v[100:103], v9 offset:4048
    ds_read_b128 v[104:107], v9 offset:4064
    ds_read_b128 v[108:111], v9 offset:4080
    ds_read_b128 v[112:115], v9 offset:4096
    ds_read_b96 v[116:118], v9 offset:4112
    s_waitcnt lgkmcnt(0)
    v_fmac_f32 v40, v85, v100
    v_fmac_f32 v41, v85, v101
    v_fmac_f32 v42, v85, v102
    v_fmac_f32 v43, v85, v103
    v_fmac_f32 v44, v85, v104
    v_fmac_f32 v45, v85, v105
    v_fmac_f32 v46, v85, v106
    v_fmac_f32 v47, v85, v107
    v_fmac_f32 v48, v85, v108
    v_fmac_f32 v49, v85, v109
    v_fmac_f32 v50, v85, v110
    v_fmac_f32 v51, v85, v111
    v_fmac_f32 v52, v85, v112
    v_fmac_f32 v53, v85, v113
    v_fmac_f32 v54, v85, v114
    v_fmac_f32 v55, v85, v115
    v_fmac_f32 v56, v85, v116
    v_fmac_f32 v57, v85, v117
    v_fmac_f32 v58, v85, v118
    ds_read_b128 v[100:103], v9 offset:4128
    ds_read_b128 v[104:107], v9 offset:4144
    ds_read_b128 v[108:111], v9 offset:4160
    ds_read_b128 v[112:115], v9 offset:4176
    ds_read_b96 v[116:118], v9 offset:4192
    s_waitcnt lgkmcnt(0)
    v_fmac_f32 v40, v86, v100
    v_fmac_f32 v41, v86, v101
    v_fmac_f32 v42, v86, v102
    v_fmac_f32 v43, v86, v103
    v_fmac_f32 v44, v86, v104
    v_fmac_f32 v45, v86, v105
    v_fmac_f32 v46, v86, v106
    v_fmac_f32 v47, v86, v107
    v_fmac_f32 v48, v86, v108
    v_fmac_f32 v49, v86, v109
    v_fmac_f32 v50, v86, v110
    v_fmac_f32 v51, v86, v111
    v_fmac_f32 v52, v86, v112
    v_fmac_f32 v53, v86, v113
    v_fmac_f32 v54, v86, v114
    v_fmac_f32 v55, v86, v115
    v_fmac_f32 v56, v86, v116
    v_fmac_f32 v57, v86, v117
    v_fmac_f32 v58, v86, v118
    ds_read_b128 v[100:103], v9 offset:4208
    ds_read_b128 v[104:107], v9 offset:4224
    ds_read_b128 v[108:111], v9 offset:4240
    ds_read_b128 v[112:115], v9 offset:4256
    ds_read_b96 v[116:118], v9 offset:4272
    s_waitcnt lgkmcnt(0)
    v_fmac_f32 v40, v87, v100
    v_fmac_f32 v41, v87, v101
    v_fmac_f32 v42, v87, v102
    v_fmac_f32 v43, v87, v103
    v_fmac_f32 v44, v87, v104
    v_fmac_f32 v45, v87, v105
    v_fmac_f32 v46, v87, v106
    v_fmac_f32 v47, v87, v107
    v_fmac_f32 v48, v87, v108
    v_fmac_f32 v49, v87, v109
    v_fmac_f32 v50, v87, v110
    v_fmac_f32 v51, v87, v111
    v_fmac_f32 v52, v87, v112
    v_fmac_f32 v53, v87, v113
    v_fmac_f32 v54, v87, v114
    v_fmac_f32 v55, v87, v115
    v_fmac_f32 v56, v87, v116
    v_fmac_f32 v57, v87, v117
    v_fmac_f32 v58, v87, v118
    ds_read_b128 v[100:103], v9 offset:4288
    ds_read_b128 v[104:107], v9 offset:4304
    ds_read_b128 v[108:111], v9 offset:4320
    ds_read_b128 v[112:115], v9 offset:4336
    ds_read_b96 v[116:118], v9 offset:4352
    s_waitcnt lgkmcnt(0)
    v_fmac_f32 v40, v88, v100
    v_fmac_f32 v41, v88, v101
    v_fmac_f32 v42, v88, v102
    v_fmac_f32 v43, v88, v103
    v_fmac_f32 v44, v88, v104
    v_fmac_f32 v45, v88, v105
    v_fmac_f32 v46, v88, v106
    v_fmac_f32 v47, v88, v107
    v_fmac_f32 v48, v88, v108
    v_fmac_f32 v49, v88, v109
    v_fmac_f32 v50, v88, v110
    v_fmac_f32 v51, v88, v111
    v_fmac_f32 v52, v88, v112
    v_fmac_f32 v53, v88, v113
    v_fmac_f32 v54, v88, v114
    v_fmac_f32 v55, v88, v115
    v_fmac_f32 v56, v88, v116
    v_fmac_f32 v57, v88, v117
    v_fmac_f32 v58, v88, v118
    ds_read_b128 v[100:103], v9 offset:4368
    ds_read_b128 v[104:107], v9 offset:4384
    ds_read_b128 v[108:111], v9 offset:4400
    ds_read_b128 v[112:115], v9 offset:4416
    ds_read_b96 v[116:118], v9 offset:4432
    s_waitcnt lgkmcnt(0)
    v_fmac_f32 v40, v89, v100
    v_fmac_f32 v41, v89, v101
    v_fmac_f32 v42, v89, v102
    v_fmac_f32 v43, v89, v103
    v_fmac_f32 v44, v89, v104
    v_fmac_f32 v45, v89, v105
    v_fmac_f32 v46, v89, v106
    v_fmac_f32 v47, v89, v107
    v_fmac_f32 v48, v89, v108
    v_fmac_f32 v49, v89, v109
    v_fmac_f32 v50, v89, v110
    v_fmac_f32 v51, v89, v111
    v_fmac_f32 v52, v89, v112
    v_fmac_f32 v53, v89, v113
    v_fmac_f32 v54, v89, v114
    v_fmac_f32 v55, v89, v115
    v_fmac_f32 v56, v89, v116
    v_fmac_f32 v57, v89, v117
    v_fmac_f32 v58, v89, v118
    ds_read_b128 v[100:103], v9 offset:4448
    ds_read_b128 v[104:107], v9 offset:4464
    ds_read_b128 v[108:111], v9 offset:4480
    ds_read_b128 v[112:115], v9 offset:4496
    ds_read_b96 v[116:118], v9 offset:4512
    s_waitcnt lgkmcnt(0)
    v_fmac_f32 v40, v90, v100
    v_fmac_f32 v41, v90, v101
    v_fmac_f32 v42, v90, v102
    v_fmac_f32 v43, v90, v103
    v_fmac_f32 v44, v90, v104
    v_fmac_f32 v45, v90, v105
    v_fmac_f32 v46, v90, v106
    v_fmac_f32 v47, v90, v107
    v_fmac_f32 v48, v90, v108
    v_fmac_f32 v49, v90, v109
    v_fmac_f32 v50, v90, v110
    v_fmac_f32 v51, v90, v111
    v_fmac_f32 v52, v90, v112
    v_fmac_f32 v53, v90, v113
    v_fmac_f32 v54, v90, v114
    v_fmac_f32 v55, v90, v115
    v_fmac_f32 v56, v90, v116
    v_fmac_f32 v57, v90, v117
    v_fmac_f32 v58, v90, v118
    ds_read_b128 v[100:103], v9 offset:4528
    ds_read_b128 v[104:107], v9 offset:4544
    ds_read_b128 v[108:111], v9 offset:4560
    ds_read_b128 v[112:115], v9 offset:4576
    ds_read_b96 v[116:118], v9 offset:4592
    s_waitcnt lgkmcnt(0)
    v_fmac_f32 v40, v91, v100
    v_fmac_f32 v41, v91, v101
    v_fmac_f32 v42, v91, v102
    v_fmac_f32 v43, v91, v103
    v_fmac_f32 v44, v91, v104
    v_fmac_f32 v45, v91, v105
    v_fmac_f32 v46, v91, v106
    v_fmac_f32 v47, v91, v107
    v_fmac_f32 v48, v91, v108
    v_fmac_f32 v49, v91, v109
    v_fmac_f32 v50, v91, v110
    v_fmac_f32 v51, v91, v111
    v_fmac_f32 v52, v91, v112
    v_fmac_f32 v53, v91, v113
    v_fmac_f32 v54, v91, v114
    v_fmac_f32 v55, v91, v115
    v_fmac_f32 v56, v91, v116
    v_fmac_f32 v57, v91, v117
    v_fmac_f32 v58, v91, v118
    ds_read_b128 v[100:103], v9 offset:4608
    ds_read_b128 v[104:107], v9 offset:4624
    ds_read_b128 v[108:111], v9 offset:4640
    ds_read_b128 v[112:115], v9 offset:4656
    ds_read_b96 v[116:118], v9 offset:4672
    s_waitcnt lgkmcnt(0)
    v_fmac_f32 v40, v92, v100
    v_fmac_f32 v41, v92, v101
    v_fmac_f32 v42, v92, v102
    v_fmac_f32 v43, v92, v103
    v_fmac_f32 v44, v92, v104
    v_fmac_f32 v45, v92, v105
    v_fmac_f32 v46, v92, v106
    v_fmac_f32 v47, v92, v107
    v_fmac_f32 v48, v92, v108
    v_fmac_f32 v49, v92, v109
    v_fmac_f32 v50, v92, v110
    v_fmac_f32 v51, v92, v111
    v_fmac_f32 v52, v92, v112
    v_fmac_f32 v53, v92, v113
    v_fmac_f32 v54, v92, v114
    v_fmac_f32 v55, v92, v115
    v_fmac_f32 v56, v92, v116
    v_fmac_f32 v57, v92, v117
    v_fmac_f32 v58, v92, v118
    ds_read_b128 v[100:103], v9 offset:4688
    ds_read_b128 v[104:107], v9 offset:4704
    ds_read_b128 v[108:111], v9 offset:4720
    ds_read_b128 v[112:115], v9 offset:4736
    ds_read_b96 v[116:118], v9 offset:4752
    s_waitcnt lgkmcnt(0)
    v_fmac_f32 v40, v93, v100
    v_fmac_f32 v41, v93, v101
    v_fmac_f32 v42, v93, v102
    v_fmac_f32 v43, v93, v103
    v_fmac_f32 v44, v93, v104
    v_fmac_f32 v45, v93, v105
    v_fmac_f32 v46, v93, v106
    v_fmac_f32 v47, v93, v107
    v_fmac_f32 v48, v93, v108
    v_fmac_f32 v49, v93, v109
    v_fmac_f32 v50, v93, v110
    v_fmac_f32 v51, v93, v111
    v_fmac_f32 v52, v93, v112
    v_fmac_f32 v53, v93, v113
    v_fmac_f32 v54, v93, v114
    v_fmac_f32 v55, v93, v115
    v_fmac_f32 v56, v93, v116
    v_fmac_f32 v57, v93, v117
    v_fmac_f32 v58, v93, v118
    ds_read_b128 v[100:103], v9 offset:4768
    ds_read_b128 v[104:107], v9 offset:4784
    ds_read_b128 v[108:111], v9 offset:4800
    ds_read_b128 v[112:115], v9 offset:4816
    ds_read_b96 v[116:118], v9 offset:4832
    s_waitcnt lgkmcnt(0)
    v_fmac_f32 v40, v94, v100
    v_fmac_f32 v41, v94, v101
    v_fmac_f32 v42, v94, v102
    v_fmac_f32 v43, v94, v103
    v_fmac_f32 v44, v94, v104
    v_fmac_f32 v45, v94, v105
    v_fmac_f32 v46, v94, v106
    v_fmac_f32 v47, v94, v107
    v_fmac_f32 v48, v94, v108
    v_fmac_f32 v49, v94, v109
    v_fmac_f32 v50, v94, v110
    v_fmac_f32 v51, v94, v111
    v_fmac_f32 v52, v94, v112
    v_fmac_f32 v53, v94, v113
    v_fmac_f32 v54, v94, v114
    v_fmac_f32 v55, v94, v115
    v_fmac_f32 v56, v94, v116
    v_fmac_f32 v57, v94, v117
    v_fmac_f32 v58, v94, v118
    ds_read_b128 v[100:103], v9 offset:4848
    ds_read_b128 v[104:107], v9 offset:4864
    ds_read_b128 v[108:111], v9 offset:4880
    ds_read_b128 v[112:115], v9 offset:4896
    ds_read_b96 v[116:118], v9 offset:4912
    s_waitcnt lgkmcnt(0)
    v_fmac_f32 v40, v95, v100
    v_fmac_f32 v41, v95, v101
    v_fmac_f32 v42, v95, v102
    v_fmac_f32 v43, v95, v103
    v_fmac_f32 v44, v95, v104
    v_fmac_f32 v45, v95, v105
    v_fmac_f32 v46, v95, v106
    v_fmac_f32 v47, v95, v107
    v_fmac_f32 v48, v95, v108
    v_fmac_f32 v49, v95, v109
    v_fmac_f32 v50, v95, v110
    v_fmac_f32 v51, v95, v111
    v_fmac_f32 v52, v95, v112
    v_fmac_f32 v53, v95, v113
    v_fmac_f32 v54, v95, v114
    v_fmac_f32 v55, v95, v115
    v_fmac_f32 v56, v95, v116
    v_fmac_f32 v57, v95, v117
    v_fmac_f32 v58, v95, v118
    v_add_f32 v58, 0x358637bd, v58
    v_rcp_f32 v58, v58
    s_nop 0
    v_mul_f32 v40, v40, v58
    v_mul_f32 v41, v41, v58
    v_mul_f32 v42, v42, v58
    v_mul_f32 v43, v43, v58
    v_mul_f32 v44, v44, v58
    v_mul_f32 v45, v45, v58
    v_mul_f32 v46, v46, v58
    v_mul_f32 v47, v47, v58
    v_mul_f32 v48, v48, v58
    v_mul_f32 v49, v49, v58
    v_mul_f32 v50, v50, v58
    v_mul_f32 v51, v51, v58
    v_mul_f32 v52, v52, v58
    v_mul_f32 v53, v53, v58
    v_mul_f32 v54, v54, v58
    v_mul_f32 v55, v55, v58
    v_mul_f32 v56, v56, v58
    v_mul_f32 v57, v57, v58
    v_cvt_pk_bf16_f32 v16, v40, v41
    v_cvt_pk_bf16_f32 v17, v42, v43
    v_cvt_pk_bf16_f32 v18, v44, v45
    v_cvt_pk_bf16_f32 v19, v46, v47
    v_cvt_pk_bf16_f32 v20, v48, v49
    v_cvt_pk_bf16_f32 v21, v50, v51
    v_cvt_pk_bf16_f32 v22, v52, v53
    v_cvt_pk_bf16_f32 v23, v54, v55
    v_cvt_pk_bf16_f32 v24, v56, v57
    s_add_u32 s16, s6, 100663296
    s_addc_u32 s17, s7, 0
    s_mov_b32 s18, 2359296
    s_mov_b32 s19, 0x00020000
    s_mov_b32 s25, 1152
    v_mul_lo_u32 v2, v1, s25
    buffer_store_dword v16, v2, s[16:19], s26 offen offset:0
    buffer_store_dword v17, v2, s[16:19], s26 offen offset:4
    buffer_store_dword v18, v2, s[16:19], s26 offen offset:8
    buffer_store_dword v19, v2, s[16:19], s26 offen offset:12
    buffer_store_dword v20, v2, s[16:19], s26 offen offset:16
    buffer_store_dword v21, v2, s[16:19], s26 offen offset:20
    buffer_store_dword v22, v2, s[16:19], s26 offen offset:24
    buffer_store_dword v23, v2, s[16:19], s26 offen offset:28
    buffer_store_dword v24, v2, s[16:19], s26 offen offset:32
L_k_attn2_end:
    s_endpgm
L_k_l4_kernel_roleB:
    s_sub_u32 s2, s2, 256
    s_cmp_ge_u32 s2, 256
    s_cbranch_scc1 L_k_ffn2_end
    s_load_dwordx2 s[4:5], s[0:1], 88
    s_load_dwordx2 s[6:7], s[0:1], 56
    s_load_dwordx2 s[16:17], s[0:1], 88
    s_and_b32 s20, s2, 15
    s_lshr_b32 s21, s2, 4
    s_and_b32 s22, s21, 3
    s_lshr_b32 s23, s21, 2
    v_and_b32 v1, 63, v0
    v_lshrrev_b32 v2, 6, v0
    v_and_b32 v3, 15, v1
    v_lshrrev_b32 v4, 4, v1
    s_mul_i32 s24, s20, 128
    v_mul_u32_u24 v5, 32, v2
    v_add_u32 v5, v5, v3
    v_add_u32 v5, s24, v5
    v_add_u32 v6, 0, v5
    s_mov_b32 s25, 9216
    v_mul_lo_u32 v6, v6, s25
    v_lshlrev_b32 v7, 4, v4
    v_add_u32 v10, v6, v7
    v_add_u32 v6, 16, v5
    s_mov_b32 s25, 9216
    v_mul_lo_u32 v6, v6, s25
    v_lshlrev_b32 v7, 4, v4
    v_add_u32 v11, v6, v7
    v_add_u32 v6, 0, v0
    s_mov_b32 s25, 0x71c71c8
    v_mul_hi_u32 v7, v6, s25
    v_mul_u32_u24 v8, 36, v7
    v_sub_u32 v8, v6, v8
    s_mov_b32 s25, 1152
    v_mul_lo_u32 v9, v7, s25
    v_lshl_add_u32 v12, v8, 3, v9
    v_lshrrev_b32 v9, 3, v7
    v_mul_u32_u24 v9, 2432, v9
    v_and_b32 v6, 7, v7
    v_mul_u32_u24 v6, 288, v6
    v_add_u32 v9, v9, v6
    v_lshl_add_u32 v21, v8, 3, v9
    v_add_u32 v6, 256, v0
    s_mov_b32 s25, 0x71c71c8
    v_mul_hi_u32 v7, v6, s25
    v_mul_u32_u24 v8, 36, v7
    v_sub_u32 v8, v6, v8
    s_mov_b32 s25, 1152
    v_mul_lo_u32 v9, v7, s25
    v_lshl_add_u32 v13, v8, 3, v9
    v_lshrrev_b32 v9, 3, v7
    v_mul_u32_u24 v9, 2432, v9
    v_and_b32 v6, 7, v7
    v_mul_u32_u24 v6, 288, v6
    v_add_u32 v9, v9, v6
    v_lshl_add_u32 v22, v8, 3, v9
    v_add_u32 v6, 512, v0
    s_mov_b32 s25, 0x71c71c8
    v_mul_hi_u32 v7, v6, s25
    v_mul_u32_u24 v8, 36, v7
    v_sub_u32 v8, v6, v8
    s_mov_b32 s25, 1152
    v_mul_lo_u32 v9, v7, s25
    v_lshl_add_u32 v14, v8, 3, v9
    v_lshrrev_b32 v9, 3, v7
    v_mul_u32_u24 v9, 2432, v9
    v_and_b32 v6, 7, v7
    v_mul_u32_u24 v6, 288, v6
    v_add_u32 v9, v9, v6
    v_lshl_add_u32 v23, v8, 3, v9
    v_add_u32 v6, 768, v0
    s_mov_b32 s25, 0x71c71c8
    v_mul_hi_u32 v7, v6, s25
    v_mul_u32_u24 v8, 36, v7
    v_sub_u32 v8, v6, v8
    s_mov_b32 s25, 1152
    v_mul_lo_u32 v9, v7, s25
    v_lshl_add_u32 v15, v8, 3, v9
    v_lshrrev_b32 v9, 3, v7
    v_mul_u32_u24 v9, 2432, v9
    v_and_b32 v6, 7, v7
    v_mul_u32_u24 v6, 288, v6
    v_add_u32 v9, v9, v6
    v_lshl_add_u32 v24, v8, 3, v9
    v_add_u32 v6, 1024, v0
    s_mov_b32 s25, 0x71c71c8
    v_mul_hi_u32 v7, v6, s25
    v_mul_u32_u24 v8, 36, v7
    v_sub_u32 v8, v6, v8
    s_mov_b32 s25, 1152
    v_mul_lo_u32 v9, v7, s25
    v_lshl_add_u32 v16, v8, 3, v9
    v_lshrrev_b32 v9, 3, v7
    v_mul_u32_u24 v9, 2432, v9
    v_and_b32 v6, 7, v7
    v_mul_u32_u24 v6, 288, v6
    v_add_u32 v9, v9, v6
    v_lshl_add_u32 v25, v8, 3, v9
    v_add_u32 v6, 1280, v0
    s_mov_b32 s25, 0x71c71c8
    v_mul_hi_u32 v7, v6, s25
    v_mul_u32_u24 v8, 36, v7
    v_sub_u32 v8, v6, v8
    s_mov_b32 s25, 1152
    v_mul_lo_u32 v9, v7, s25
    v_lshl_add_u32 v17, v8, 3, v9
    v_lshrrev_b32 v9, 3, v7
    v_mul_u32_u24 v9, 2432, v9
    v_and_b32 v6, 7, v7
    v_mul_u32_u24 v6, 288, v6
    v_add_u32 v9, v9, v6
    v_lshl_add_u32 v26, v8, 3, v9
    v_add_u32 v6, 1536, v0
    s_mov_b32 s25, 0x71c71c8
    v_mul_hi_u32 v7, v6, s25
    v_mul_u32_u24 v8, 36, v7
    v_sub_u32 v8, v6, v8
    s_mov_b32 s25, 1152
    v_mul_lo_u32 v9, v7, s25
    v_lshl_add_u32 v18, v8, 3, v9
    v_lshrrev_b32 v9, 3, v7
    v_mul_u32_u24 v9, 2432, v9
    v_and_b32 v6, 7, v7
    v_mul_u32_u24 v6, 288, v6
    v_add_u32 v9, v9, v6
    v_lshl_add_u32 v27, v8, 3, v9
    v_add_u32 v6, 1792, v0
    s_mov_b32 s25, 0x71c71c8
    v_mul_hi_u32 v7, v6, s25
    v_mul_u32_u24 v8, 36, v7
    v_sub_u32 v8, v6, v8
    s_mov_b32 s25, 1152
    v_mul_lo_u32 v9, v7, s25
    v_lshl_add_u32 v19, v8, 3, v9
    v_lshrrev_b32 v9, 3, v7
    v_mul_u32_u24 v9, 2432, v9
    v_and_b32 v6, 7, v7
    v_mul_u32_u24 v6, 288, v6
    v_add_u32 v9, v9, v6
    v_lshl_add_u32 v28, v8, 3, v9
    v_add_u32 v6, 2048, v0
    s_mov_b32 s25, 0x71c71c8
    v_mul_hi_u32 v7, v6, s25
    v_mul_u32_u24 v8, 36, v7
    v_sub_u32 v8, v6, v8
    s_mov_b32 s25, 1152
    v_mul_lo_u32 v9, v7, s25
    v_lshl_add_u32 v20, v8, 3, v9
    v_lshrrev_b32 v9, 3, v7
    v_mul_u32_u24 v9, 2432, v9
    v_and_b32 v6, 7, v7
    v_mul_u32_u24 v6, 288, v6
    v_add_u32 v9, v9, v6
    v_lshl_add_u32 v29, v8, 3, v9
    v_mul_u32_u24 v30, 2432, v4
    v_lshrrev_b32 v6, 2, v3
    v_mul_u32_u24 v6, 288, v6
    v_add_u32 v30, v30, v6
    v_and_b32 v6, 3, v1
    v_lshl_add_u32 v30, v6, 3, v30
    s_waitcnt lgkmcnt(0)
    s_add_u32 s8, s4, 16777216
    s_addc_u32 s9, s5, 0
    s_mov_b32 s10, 18874368
    s_mov_b32 s11, 0x00020000
    s_mul_i32 s26, s22, 288
    s_add_u32 s12, s6, s26
    s_addc_u32 s13, s7, 0
    s_sub_u32 s14, 5308416, s26
    s_mov_b32 s15, 0x00020000
    s_mul_i32 s27, s23, 2304
    s_mul_i32 s28, s23, 1327104
    v_mov_b32 v156, 0
    v_mov_b32 v157, 0
    v_mov_b32 v158, 0
    v_mov_b32 v159, 0
    v_mov_b32 v160, 0
    v_mov_b32 v161, 0
    v_mov_b32 v162, 0
    v_mov_b32 v163, 0
    v_mov_b32 v164, 0
    v_mov_b32 v165, 0
    v_mov_b32 v166, 0
    v_mov_b32 v167, 0
    v_mov_b32 v168, 0
    v_mov_b32 v169, 0
    v_mov_b32 v170, 0
    v_mov_b32 v171, 0
    v_mov_b32 v172, 0
    v_mov_b32 v173, 0
    v_mov_b32 v174, 0
    v_mov_b32 v175, 0
    v_mov_b32 v176, 0
    v_mov_b32 v177, 0
    v_mov_b32 v178, 0
    v_mov_b32 v179, 0
    v_mov_b32 v180, 0
    v_mov_b32 v181, 0
    v_mov_b32 v182, 0
    v_mov_b32 v183, 0
    v_mov_b32 v184, 0
    v_mov_b32 v185, 0
    v_mov_b32 v186, 0
    v_mov_b32 v187, 0
    v_mov_b32 v188, 0
    v_mov_b32 v189, 0
    v_mov_b32 v190, 0
    v_mov_b32 v191, 0
    v_mov_b32 v192, 0
    v_mov_b32 v193, 0
    v_mov_b32 v194, 0
    v_mov_b32 v195, 0
    v_mov_b32 v196, 0
    v_mov_b32 v197, 0
    v_mov_b32 v198, 0
    v_mov_b32 v199, 0
    v_mov_b32 v200, 0
    v_mov_b32 v201, 0
    v_mov_b32 v202, 0
    v_mov_b32 v203, 0
    v_mov_b32 v204, 0
    v_mov_b32 v205, 0
    v_mov_b32 v206, 0
    v_mov_b32 v207, 0
    v_mov_b32 v208, 0
    v_mov_b32 v209, 0
    v_mov_b32 v210, 0
    v_mov_b32 v211, 0
    v_mov_b32 v212, 0
    v_mov_b32 v213, 0
    v_mov_b32 v214, 0
    v_mov_b32 v215, 0
    v_mov_b32 v216, 0
    v_mov_b32 v217, 0
    v_mov_b32 v218, 0
    v_mov_b32 v219, 0
    v_mov_b32 v220, 0
    v_mov_b32 v221, 0
    v_mov_b32 v222, 0
    v_mov_b32 v223, 0
    v_mov_b32 v224, 0
    v_mov_b32 v225, 0
    v_mov_b32 v226, 0
    v_mov_b32 v227, 0
    s_add_u32 s29, s28, 0
    buffer_load_dwordx2 v[80:81], v12, s[12:15], s29 offen
    buffer_load_dwordx2 v[82:83], v13, s[12:15], s29 offen
    buffer_load_dwordx2 v[84:85], v14, s[12:15], s29 offen
    buffer_load_dwordx2 v[86:87], v15, s[12:15], s29 offen
    buffer_load_dwordx2 v[88:89], v16, s[12:15], s29 offen
    buffer_load_dwordx2 v[90:91], v17, s[12:15], s29 offen
    buffer_load_dwordx2 v[92:93], v18, s[12:15], s29 offen
    buffer_load_dwordx2 v[94:95], v19, s[12:15], s29 offen
    buffer_load_dwordx2 v[96:97], v20, s[12:15], s29 offen
    s_add_u32 s30, s27, 0
    buffer_load_dwordx4 v[32:35], v10, s[8:11], s30 offen offset:0
    buffer_load_dwordx4 v[36:39], v10, s[8:11], s30 offen offset:64
    buffer_load_dwordx4 v[40:43], v11, s[8:11], s30 offen offset:0
    buffer_load_dwordx4 v[44:47], v11, s[8:11], s30 offen offset:64
    s_add_u32 s29, s28, 73728
    buffer_load_dwordx2 v[98:99], v12, s[12:15], s29 offen
    buffer_load_dwordx2 v[100:101], v13, s[12:15], s29 offen
    buffer_load_dwordx2 v[102:103], v14, s[12:15], s29 offen
    buffer_load_dwordx2 v[104:105], v15, s[12:15], s29 offen
    buffer_load_dwordx2 v[106:107], v16, s[12:15], s29 offen
    buffer_load_dwordx2 v[108:109], v17, s[12:15], s29 offen
    buffer_load_dwordx2 v[110:111], v18, s[12:15], s29 offen
    buffer_load_dwordx2 v[112:113], v19, s[12:15], s29 offen
    buffer_load_dwordx2 v[114:115], v20, s[12:15], s29 offen
    s_add_u32 s30, s27, 128
    buffer_load_dwordx4 v[48:51], v10, s[8:11], s30 offen offset:0
    buffer_load_dwordx4 v[52:55], v10, s[8:11], s30 offen offset:64
    buffer_load_dwordx4 v[56:59], v11, s[8:11], s30 offen offset:0
    buffer_load_dwordx4 v[60:63], v11, s[8:11], s30 offen offset:64
    s_waitcnt vmcnt(17)
    ds_write_b64 v21, v[80:81] offset:0
    ds_write_b64 v22, v[82:83] offset:0
    ds_write_b64 v23, v[84:85] offset:0
    ds_write_b64 v24, v[86:87] offset:0
    ds_write_b64 v25, v[88:89] offset:0
    ds_write_b64 v26, v[90:91] offset:0
    ds_write_b64 v27, v[92:93] offset:0
    ds_write_b64 v28, v[94:95] offset:0
    ds_write_b64 v29, v[96:97] offset:0
    s_waitcnt lgkmcnt(0)
    s_barrier
    s_add_u32 s29, s28, 147456
    buffer_load_dwordx2 v[80:81], v12, s[12:15], s29 offen
    buffer_load_dwordx2 v[82:83], v13, s[12:15], s29 offen
    buffer_load_dwordx2 v[84:85], v14, s[12:15], s29 offen
    buffer_load_dwordx2 v[86:87], v15, s[12:15], s29 offen
    buffer_load_dwordx2 v[88:89], v16, s[12:15], s29 offen
    buffer_load_dwordx2 v[90:91], v17, s[12:15], s29 offen
    buffer_load_dwordx2 v[92:93], v18, s[12:15], s29 offen
    buffer_load_dwordx2 v[94:95], v19, s[12:15], s29 offen
    buffer_load_dwordx2 v[96:97], v20, s[12:15], s29 offen
    s_add_u32 s30, s27, 256
    buffer_load_dwordx4 v[64:67], v10, s[8:11], s30 offen offset:0
    buffer_load_dwordx4 v[68:71], v10, s[8:11], s30 offen offset:64
    buffer_load_dwordx4 v[72:75], v11, s[8:11], s30 offen offset:0
    buffer_load_dwordx4 v[76:79], v11, s[8:11], s30 offen offset:64
    ds_read_b64_tr_b16 v[116:117], v30 offset:0
    ds_read_b64_tr_b16 v[118:119], v30 offset:1152
    ds_read_b64_tr_b16 v[120:121], v30 offset:32
    ds_read_b64_tr_b16 v[122:123], v30 offset:1184
    ds_read_b64_tr_b16 v[124:125], v30 offset:64
    ds_read_b64_tr_b16 v[126:127], v30 offset:1216
    ds_read_b64_tr_b16 v[128:129], v30 offset:96
    ds_read_b64_tr_b16 v[130:131], v30 offset:1248
    ds_read_b64_tr_b16 v[132:133], v30 offset:128
    ds_read_b64_tr_b16 v[134:135], v30 offset:1280
    ds_read_b64_tr_b16 v[136:137], v30 offset:160
    ds_read_b64_tr_b16 v[138:139], v30 offset:1312
    ds_read_b64_tr_b16 v[140:141], v30 offset:192
    ds_read_b64_tr_b16 v[142:143], v30 offset:1344
    ds_read_b64_tr_b16 v[144:145], v30 offset:224
    ds_read_b64_tr_b16 v[146:147], v30 offset:1376
    ds_read_b64_tr_b16 v[148:149], v30 offset:256
    ds_read_b64_tr_b16 v[150:151], v30 offset:1408
    s_waitcnt vmcnt(26)
    s_waitcnt lgkmcnt(0)
    v_mfma_f32_16x16x32_bf16 v[156:159], v[116:119], v[32:35], v[156:159]
    v_mfma_f32_16x16x32_bf16 v[192:195], v[116:119], v[40:43], v[192:195]
    v_mfma_f32_16x16x32_bf16 v[160:163], v[120:123], v[32:35], v[160:163]
    v_mfma_f32_16x16x32_bf16 v[196:199], v[120:123], v[40:43], v[196:199]
    v_mfma_f32_16x16x32_bf16 v[164:167], v[124:127], v[32:35], v[164:167]
    v_mfma_f32_16x16x32_bf16 v[200:203], v[124:127], v[40:43], v[200:203]
    v_mfma_f32_16x16x32_bf16 v[168:171], v[128:131], v[32:35], v[168:171]
    v_mfma_f32_16x16x32_bf16 v[204:207], v[128:131], v[40:43], v[204:207]
    v_mfma_f32_16x16x32_bf16 v[172:175], v[132:135], v[32:35], v[172:175]
    v_mfma_f32_16x16x32_bf16 v[208:211], v[132:135], v[40:43], v[208:211]
    v_mfma_f32_16x16x32_bf16 v[176:179], v[136:139], v[32:35], v[176:179]
    v_mfma_f32_16x16x32_bf16 v[212:215], v[136:139], v[40:43], v[212:215]
    v_mfma_f32_16x16x32_bf16 v[180:183], v[140:143], v[32:35], v[180:183]
    v_mfma_f32_16x16x32_bf16 v[216:219], v[140:143], v[40:43], v[216:219]
    v_mfma_f32_16x16x32_bf16 v[184:187], v[144:147], v[32:35], v[184:187]
    v_mfma_f32_16x16x32_bf16 v[220:223], v[144:147], v[40:43], v[220:223]
    v_mfma_f32_16x16x32_bf16 v[188:191], v[148:151], v[32:35], v[188:191]
    v_mfma_f32_16x16x32_bf16 v[224:227], v[148:151], v[40:43], v[224:227]
    ds_read_b64_tr_b16 v[116:117], v30 offset:9728
    ds_read_b64_tr_b16 v[118:119], v30 offset:10880
    ds_read_b64_tr_b16 v[120:121], v30 offset:9760
    ds_read_b64_tr_b16 v[122:123], v30 offset:10912
    ds_read_b64_tr_b16 v[124:125], v30 offset:9792
    ds_read_b64_tr_b16 v[126:127], v30 offset:10944
    ds_read_b64_tr_b16 v[128:129], v30 offset:9824
    ds_read_b64_tr_b16 v[130:131], v30 offset:10976
    ds_read_b64_tr_b16 v[132:133], v30 offset:9856
    ds_read_b64_tr_b16 v[134:135], v30 offset:11008
    ds_read_b64_tr_b16 v[136:137], v30 offset:9888
    ds_read_b64_tr_b16 v[138:139], v30 offset:11040
    ds_read_b64_tr_b16 v[140:141], v30 offset:9920
    ds_read_b64_tr_b16 v[142:143], v30 offset:11072
    ds_read_b64_tr_b16 v[144:145], v30 offset:9952
    ds_read_b64_tr_b16 v[146:147], v30 offset:11104
    ds_read_b64_tr_b16 v[148:149], v30 offset:9984
    ds_read_b64_tr_b16 v[150:151], v30 offset:11136
    s_waitcnt lgkmcnt(0)
    v_mfma_f32_16x16x32_bf16 v[156:159], v[116:119], v[36:39], v[156:159]
    v_mfma_f32_16x16x32_bf16 v[192:195], v[116:119], v[44:47], v[192:195]
    v_mfma_f32_16x16x32_bf16 v[160:163], v[120:123], v[36:39], v[160:163]
    v_mfma_f32_16x16x32_bf16 v[196:199], v[120:123], v[44:47], v[196:199]
    v_mfma_f32_16x16x32_bf16 v[164:167], v[124:127], v[36:39], v[164:167]
    v_mfma_f32_16x16x32_bf16 v[200:203], v[124:127], v[44:47], v[200:203]
    v_mfma_f32_16x16x32_bf16 v[168:171], v[128:131], v[36:39], v[168:171]
    v_mfma_f32_16x16x32_bf16 v[204:207], v[128:131], v[44:47], v[204:207]
    v_mfma_f32_16x16x32_bf16 v[172:175], v[132:135], v[36:39], v[172:175]
    v_mfma_f32_16x16x32_bf16 v[208:211], v[132:135], v[44:47], v[208:211]
    v_mfma_f32_16x16x32_bf16 v[176:179], v[136:139], v[36:39], v[176:179]
    v_mfma_f32_16x16x32_bf16 v[212:215], v[136:139], v[44:47], v[212:215]
    v_mfma_f32_16x16x32_bf16 v[180:183], v[140:143], v[36:39], v[180:183]
    v_mfma_f32_16x16x32_bf16 v[216:219], v[140:143], v[44:47], v[216:219]
    v_mfma_f32_16x16x32_bf16 v[184:187], v[144:147], v[36:39], v[184:187]
    v_mfma_f32_16x16x32_bf16 v[220:223], v[144:147], v[44:47], v[220:223]
    v_mfma_f32_16x16x32_bf16 v[188:191], v[148:151], v[36:39], v[188:191]
    v_mfma_f32_16x16x32_bf16 v[224:227], v[148:151], v[44:47], v[224:227]
    s_waitcnt vmcnt(17)
    ds_write_b64 v21, v[98:99] offset:19456
    ds_write_b64 v22, v[100:101] offset:19456
    ds_write_b64 v23, v[102:103] offset:19456
    ds_write_b64 v24, v[104:105] offset:19456
    ds_write_b64 v25, v[106:107] offset:19456
    ds_write_b64 v26, v[108:109] offset:19456
    ds_write_b64 v27, v[110:111] offset:19456
    ds_write_b64 v28, v[112:113] offset:19456
    ds_write_b64 v29, v[114:115] offset:19456
    s_waitcnt lgkmcnt(0)
    s_barrier
    s_add_u32 s29, s28, 221184
    buffer_load_dwordx2 v[98:99], v12, s[12:15], s29 offen
    buffer_load_dwordx2 v[100:101], v13, s[12:15], s29 offen
    buffer_load_dwordx2 v[102:103], v14, s[12:15], s29 offen
    buffer_load_dwordx2 v[104:105], v15, s[12:15], s29 offen
    buffer_load_dwordx2 v[106:107], v16, s[12:15], s29 offen
    buffer_load_dwordx2 v[108:109], v17, s[12:15], s29 offen
    buffer_load_dwordx2 v[110:111], v18, s[12:15], s29 offen
    buffer_load_dwordx2 v[112:113], v19, s[12:15], s29 offen
    buffer_load_dwordx2 v[114:115], v20, s[12:15], s29 offen
    s_add_u32 s30, s27, 384
    buffer_load_dwordx4 v[32:35], v10, s[8:11], s30 offen offset:0
    buffer_load_dwordx4 v[36:39], v10, s[8:11], s30 offen offset:64
    buffer_load_dwordx4 v[40:43], v11, s[8:11], s30 offen offset:0
    buffer_load_dwordx4 v[44:47], v11, s[8:11], s30 offen offset:64
    ds_read_b64_tr_b16 v[116:117], v30 offset:19456
    ds_read_b64_tr_b16 v[118:119], v30 offset:20608
    ds_read_b64_tr_b16 v[120:121], v30 offset:19488
    ds_read_b64_tr_b16 v[122:123], v30 offset:20640
    ds_read_b64_tr_b16 v[124:125], v30 offset:19520
    ds_read_b64_tr_b16 v[126:127], v30 offset:20672
    ds_read_b64_tr_b16 v[128:129], v30 offset:19552
    ds_read_b64_tr_b16 v[130:131], v30 offset:20704
    ds_read_b64_tr_b16 v[132:133], v30 offset:19584
    ds_read_b64_tr_b16 v[134:135], v30 offset:20736
    ds_read_b64_tr_b16 v[136:137], v30 offset:19616
    ds_read_b64_tr_b16 v[138:139], v30 offset:20768
    ds_read_b64_tr_b16 v[140:141], v30 offset:19648
    ds_read_b64_tr_b16 v[142:143], v30 offset:20800
    ds_read_b64_tr_b16 v[144:145], v30 offset:19680
    ds_read_b64_tr_b16 v[146:147], v30 offset:20832
    ds_read_b64_tr_b16 v[148:149], v30 offset:19712
    ds_read_b64_tr_b16 v[150:151], v30 offset:20864
    s_waitcnt vmcnt(26)
    s_waitcnt lgkmcnt(0)
    v_mfma_f32_16x16x32_bf16 v[156:159], v[116:119], v[48:51], v[156:159]
    v_mfma_f32_16x16x32_bf16 v[192:195], v[116:119], v[56:59], v[192:195]
    v_mfma_f32_16x16x32_bf16 v[160:163], v[120:123], v[48:51], v[160:163]
    v_mfma_f32_16x16x32_bf16 v[196:199], v[120:123], v[56:59], v[196:199]
    v_mfma_f32_16x16x32_bf16 v[164:167], v[124:127], v[48:51], v[164:167]
    v_mfma_f32_16x16x32_bf16 v[200:203], v[124:127], v[56:59], v[200:203]
    v_mfma_f32_16x16x32_bf16 v[168:171], v[128:131], v[48:51], v[168:171]
    v_mfma_f32_16x16x32_bf16 v[204:207], v[128:131], v[56:59], v[204:207]
    v_mfma_f32_16x16x32_bf16 v[172:175], v[132:135], v[48:51], v[172:175]
    v_mfma_f32_16x16x32_bf16 v[208:211], v[132:135], v[56:59], v[208:211]
    v_mfma_f32_16x16x32_bf16 v[176:179], v[136:139], v[48:51], v[176:179]
    v_mfma_f32_16x16x32_bf16 v[212:215], v[136:139], v[56:59], v[212:215]
    v_mfma_f32_16x16x32_bf16 v[180:183], v[140:143], v[48:51], v[180:183]
    v_mfma_f32_16x16x32_bf16 v[216:219], v[140:143], v[56:59], v[216:219]
    v_mfma_f32_16x16x32_bf16 v[184:187], v[144:147], v[48:51], v[184:187]
    v_mfma_f32_16x16x32_bf16 v[220:223], v[144:147], v[56:59], v[220:223]
    v_mfma_f32_16x16x32_bf16 v[188:191], v[148:151], v[48:51], v[188:191]
    v_mfma_f32_16x16x32_bf16 v[224:227], v[148:151], v[56:59], v[224:227]
    ds_read_b64_tr_b16 v[116:117], v30 offset:29184
    ds_read_b64_tr_b16 v[118:119], v30 offset:30336
    ds_read_b64_tr_b16 v[120:121], v30 offset:29216
    ds_read_b64_tr_b16 v[122:123], v30 offset:30368
    ds_read_b64_tr_b16 v[124:125], v30 offset:29248
    ds_read_b64_tr_b16 v[126:127], v30 offset:30400
    ds_read_b64_tr_b16 v[128:129], v30 offset:29280
    ds_read_b64_tr_b16 v[130:131], v30 offset:30432
    ds_read_b64_tr_b16 v[132:133], v30 offset:29312
    ds_read_b64_tr_b16 v[134:135], v30 offset:30464
    ds_read_b64_tr_b16 v[136:137], v30 offset:29344
    ds_read_b64_tr_b16 v[138:139], v30 offset:30496
    ds_read_b64_tr_b16 v[140:141], v30 offset:29376
    ds_read_b64_tr_b16 v[142:143], v30 offset:30528
    ds_read_b64_tr_b16 v[144:145], v30 offset:29408
    ds_read_b64_tr_b16 v[146:147], v30 offset:30560
    ds_read_b64_tr_b16 v[148:149], v30 offset:29440
    ds_read_b64_tr_b16 v[150:151], v30 offset:30592
    s_waitcnt lgkmcnt(0)
    v_mfma_f32_16x16x32_bf16 v[156:159], v[116:119], v[52:55], v[156:159]
    v_mfma_f32_16x16x32_bf16 v[192:195], v[116:119], v[60:63], v[192:195]
    v_mfma_f32_16x16x32_bf16 v[160:163], v[120:123], v[52:55], v[160:163]
    v_mfma_f32_16x16x32_bf16 v[196:199], v[120:123], v[60:63], v[196:199]
    v_mfma_f32_16x16x32_bf16 v[164:167], v[124:127], v[52:55], v[164:167]
    v_mfma_f32_16x16x32_bf16 v[200:203], v[124:127], v[60:63], v[200:203]
    v_mfma_f32_16x16x32_bf16 v[168:171], v[128:131], v[52:55], v[168:171]
    v_mfma_f32_16x16x32_bf16 v[204:207], v[128:131], v[60:63], v[204:207]
    v_mfma_f32_16x16x32_bf16 v[172:175], v[132:135], v[52:55], v[172:175]
    v_mfma_f32_16x16x32_bf16 v[208:211], v[132:135], v[60:63], v[208:211]
    v_mfma_f32_16x16x32_bf16 v[176:179], v[136:139], v[52:55], v[176:179]
    v_mfma_f32_16x16x32_bf16 v[212:215], v[136:139], v[60:63], v[212:215]
    v_mfma_f32_16x16x32_bf16 v[180:183], v[140:143], v[52:55], v[180:183]
    v_mfma_f32_16x16x32_bf16 v[216:219], v[140:143], v[60:63], v[216:219]
    v_mfma_f32_16x16x32_bf16 v[184:187], v[144:147], v[52:55], v[184:187]
    v_mfma_f32_16x16x32_bf16 v[220:223], v[144:147], v[60:63], v[220:223]
    v_mfma_f32_16x16x32_bf16 v[188:191], v[148:151], v[52:55], v[188:191]
    v_mfma_f32_16x16x32_bf16 v[224:227], v[148:151], v[60:63], v[224:227]
    s_waitcnt vmcnt(17)
    ds_write_b64 v21, v[80:81] offset:0
    ds_write_b64 v22, v[82:83] offset:0
    ds_write_b64 v23, v[84:85] offset:0
    ds_write_b64 v24, v[86:87] offset:0
    ds_write_b64 v25, v[88:89] offset:0
    ds_write_b64 v26, v[90:91] offset:0
    ds_write_b64 v27, v[92:93] offset:0
    ds_write_b64 v28, v[94:95] offset:0
    ds_write_b64 v29, v[96:97] offset:0
    s_waitcnt lgkmcnt(0)
    s_barrier
    s_add_u32 s29, s28, 294912
    buffer_load_dwordx2 v[80:81], v12, s[12:15], s29 offen
    buffer_load_dwordx2 v[82:83], v13, s[12:15], s29 offen
    buffer_load_dwordx2 v[84:85], v14, s[12:15], s29 offen
    buffer_load_dwordx2 v[86:87], v15, s[12:15], s29 offen
    buffer_load_dwordx2 v[88:89], v16, s[12:15], s29 offen
    buffer_load_dwordx2 v[90:91], v17, s[12:15], s29 offen
    buffer_load_dwordx2 v[92:93], v18, s[12:15], s29 offen
    buffer_load_dwordx2 v[94:95], v19, s[12:15], s29 offen
    buffer_load_dwordx2 v[96:97], v20, s[12:15], s29 offen
    s_add_u32 s30, s27, 512
    buffer_load_dwordx4 v[48:51], v10, s[8:11], s30 offen offset:0
    buffer_load_dwordx4 v[52:55], v10, s[8:11], s30 offen offset:64
    buffer_load_dwordx4 v[56:59], v11, s[8:11], s30 offen offset:0
    buffer_load_dwordx4 v[60:63], v11, s[8:11], s30 offen offset:64
    ds_read_b64_tr_b16 v[116:117], v30 offset:0
    ds_read_b64_tr_b16 v[118:119], v30 offset:1152
    ds_read_b64_tr_b16 v[120:121], v30 offset:32
    ds_read_b64_tr_b16 v[122:123], v30 offset:1184
    ds_read_b64_tr_b16 v[124:125], v30 offset:64
    ds_read_b64_tr_b16 v[126:127], v30 offset:1216
    ds_read_b64_tr_b16 v[128:129], v30 offset:96
    ds_read_b64_tr_b16 v[130:131], v30 offset:1248
    ds_read_b64_tr_b16 v[132:133], v30 offset:128
    ds_read_b64_tr_b16 v[134:135], v30 offset:1280
    ds_read_b64_tr_b16 v[136:137], v30 offset:160
    ds_read_b64_tr_b16 v[138:139], v30 offset:1312
    ds_read_b64_tr_b16 v[140:141], v30 offset:192
    ds_read_b64_tr_b16 v[142:143], v30 offset:1344
    ds_read_b64_tr_b16 v[144:145], v30 offset:224
    ds_read_b64_tr_b16 v[146:147], v30 offset:1376
    ds_read_b64_tr_b16 v[148:149], v30 offset:256
    ds_read_b64_tr_b16 v[150:151], v30 offset:1408
    s_waitcnt vmcnt(26)
    s_waitcnt lgkmcnt(0)
    v_mfma_f32_16x16x32_bf16 v[156:159], v[116:119], v[64:67], v[156:159]
    v_mfma_f32_16x16x32_bf16 v[192:195], v[116:119], v[72:75], v[192:195]
    v_mfma_f32_16x16x32_bf16 v[160:163], v[120:123], v[64:67], v[160:163]
    v_mfma_f32_16x16x32_bf16 v[196:199], v[120:123], v[72:75], v[196:199]
    v_mfma_f32_16x16x32_bf16 v[164:167], v[124:127], v[64:67], v[164:167]
    v_mfma_f32_16x16x32_bf16 v[200:203], v[124:127], v[72:75], v[200:203]
    v_mfma_f32_16x16x32_bf16 v[168:171], v[128:131], v[64:67], v[168:171]
    v_mfma_f32_16x16x32_bf16 v[204:207], v[128:131], v[72:75], v[204:207]
    v_mfma_f32_16x16x32_bf16 v[172:175], v[132:135], v[64:67], v[172:175]
    v_mfma_f32_16x16x32_bf16 v[208:211], v[132:135], v[72:75], v[208:211]
    v_mfma_f32_16x16x32_bf16 v[176:179], v[136:139], v[64:67], v[176:179]
    v_mfma_f32_16x16x32_bf16 v[212:215], v[136:139], v[72:75], v[212:215]
    v_mfma_f32_16x16x32_bf16 v[180:183], v[140:143], v[64:67], v[180:183]
    v_mfma_f32_16x16x32_bf16 v[216:219], v[140:143], v[72:75], v[216:219]
    v_mfma_f32_16x16x32_bf16 v[184:187], v[144:147], v[64:67], v[184:187]
    v_mfma_f32_16x16x32_bf16 v[220:223], v[144:147], v[72:75], v[220:223]
    v_mfma_f32_16x16x32_bf16 v[188:191], v[148:151], v[64:67], v[188:191]
    v_mfma_f32_16x16x32_bf16 v[224:227], v[148:151], v[72:75], v[224:227]
    ds_read_b64_tr_b16 v[116:117], v30 offset:9728
    ds_read_b64_tr_b16 v[118:119], v30 offset:10880
    ds_read_b64_tr_b16 v[120:121], v30 offset:9760
    ds_read_b64_tr_b16 v[122:123], v30 offset:10912
    ds_read_b64_tr_b16 v[124:125], v30 offset:9792
    ds_read_b64_tr_b16 v[126:127], v30 offset:10944
    ds_read_b64_tr_b16 v[128:129], v30 offset:9824
    ds_read_b64_tr_b16 v[130:131], v30 offset:10976
    ds_read_b64_tr_b16 v[132:133], v30 offset:9856
    ds_read_b64_tr_b16 v[134:135], v30 offset:11008
    ds_read_b64_tr_b16 v[136:137], v30 offset:9888
    ds_read_b64_tr_b16 v[138:139], v30 offset:11040
    ds_read_b64_tr_b16 v[140:141], v30 offset:9920
    ds_read_b64_tr_b16 v[142:143], v30 offset:11072
    ds_read_b64_tr_b16 v[144:145], v30 offset:9952
    ds_read_b64_tr_b16 v[146:147], v30 offset:11104
    ds_read_b64_tr_b16 v[148:149], v30 offset:9984
    ds_read_b64_tr_b16 v[150:151], v30 offset:11136
    s_waitcnt lgkmcnt(0)
    v_mfma_f32_16x16x32_bf16 v[156:159], v[116:119], v[68:71], v[156:159]
    v_mfma_f32_16x16x32_bf16 v[192:195], v[116:119], v[76:79], v[192:195]
    v_mfma_f32_16x16x32_bf16 v[160:163], v[120:123], v[68:71], v[160:163]
    v_mfma_f32_16x16x32_bf16 v[196:199], v[120:123], v[76:79], v[196:199]
    v_mfma_f32_16x16x32_bf16 v[164:167], v[124:127], v[68:71], v[164:167]
    v_mfma_f32_16x16x32_bf16 v[200:203], v[124:127], v[76:79], v[200:203]
    v_mfma_f32_16x16x32_bf16 v[168:171], v[128:131], v[68:71], v[168:171]
    v_mfma_f32_16x16x32_bf16 v[204:207], v[128:131], v[76:79], v[204:207]
    v_mfma_f32_16x16x32_bf16 v[172:175], v[132:135], v[68:71], v[172:175]
    v_mfma_f32_16x16x32_bf16 v[208:211], v[132:135], v[76:79], v[208:211]
    v_mfma_f32_16x16x32_bf16 v[176:179], v[136:139], v[68:71], v[176:179]
    v_mfma_f32_16x16x32_bf16 v[212:215], v[136:139], v[76:79], v[212:215]
    v_mfma_f32_16x16x32_bf16 v[180:183], v[140:143], v[68:71], v[180:183]
    v_mfma_f32_16x16x32_bf16 v[216:219], v[140:143], v[76:79], v[216:219]
    v_mfma_f32_16x16x32_bf16 v[184:187], v[144:147], v[68:71], v[184:187]
    v_mfma_f32_16x16x32_bf16 v[220:223], v[144:147], v[76:79], v[220:223]
    v_mfma_f32_16x16x32_bf16 v[188:191], v[148:151], v[68:71], v[188:191]
    v_mfma_f32_16x16x32_bf16 v[224:227], v[148:151], v[76:79], v[224:227]
    s_waitcnt vmcnt(17)
    ds_write_b64 v21, v[98:99] offset:19456
    ds_write_b64 v22, v[100:101] offset:19456
    ds_write_b64 v23, v[102:103] offset:19456
    ds_write_b64 v24, v[104:105] offset:19456
    ds_write_b64 v25, v[106:107] offset:19456
    ds_write_b64 v26, v[108:109] offset:19456
    ds_write_b64 v27, v[110:111] offset:19456
    ds_write_b64 v28, v[112:113] offset:19456
    ds_write_b64 v29, v[114:115] offset:19456
    s_waitcnt lgkmcnt(0)
    s_barrier
    s_add_u32 s29, s28, 368640
    buffer_load_dwordx2 v[98:99], v12, s[12:15], s29 offen
    buffer_load_dwordx2 v[100:101], v13, s[12:15], s29 offen
    buffer_load_dwordx2 v[102:103], v14, s[12:15], s29 offen
    buffer_load_dwordx2 v[104:105], v15, s[12:15], s29 offen
    buffer_load_dwordx2 v[106:107], v16, s[12:15], s29 offen
    buffer_load_dwordx2 v[108:109], v17, s[12:15], s29 offen
    buffer_load_dwordx2 v[110:111], v18, s[12:15], s29 offen
    buffer_load_dwordx2 v[112:113], v19, s[12:15], s29 offen
    buffer_load_dwordx2 v[114:115], v20, s[12:15], s29 offen
    s_add_u32 s30, s27, 640
    buffer_load_dwordx4 v[64:67], v10, s[8:11], s30 offen offset:0
    buffer_load_dwordx4 v[68:71], v10, s[8:11], s30 offen offset:64
    buffer_load_dwordx4 v[72:75], v11, s[8:11], s30 offen offset:0
    buffer_load_dwordx4 v[76:79], v11, s[8:11], s30 offen offset:64
    ds_read_b64_tr_b16 v[116:117], v30 offset:19456
    ds_read_b64_tr_b16 v[118:119], v30 offset:20608
    ds_read_b64_tr_b16 v[120:121], v30 offset:19488
    ds_read_b64_tr_b16 v[122:123], v30 offset:20640
    ds_read_b64_tr_b16 v[124:125], v30 offset:19520
    ds_read_b64_tr_b16 v[126:127], v30 offset:20672
    ds_read_b64_tr_b16 v[128:129], v30 offset:19552
    ds_read_b64_tr_b16 v[130:131], v30 offset:20704
    ds_read_b64_tr_b16 v[132:133], v30 offset:19584
    ds_read_b64_tr_b16 v[134:135], v30 offset:20736
    ds_read_b64_tr_b16 v[136:137], v30 offset:19616
    ds_read_b64_tr_b16 v[138:139], v30 offset:20768
    ds_read_b64_tr_b16 v[140:141], v30 offset:19648
    ds_read_b64_tr_b16 v[142:143], v30 offset:20800
    ds_read_b64_tr_b16 v[144:145], v30 offset:19680
    ds_read_b64_tr_b16 v[146:147], v30 offset:20832
    ds_read_b64_tr_b16 v[148:149], v30 offset:19712
    ds_read_b64_tr_b16 v[150:151], v30 offset:20864
    s_waitcnt vmcnt(26)
    s_waitcnt lgkmcnt(0)
    v_mfma_f32_16x16x32_bf16 v[156:159], v[116:119], v[32:35], v[156:159]
    v_mfma_f32_16x16x32_bf16 v[192:195], v[116:119], v[40:43], v[192:195]
    v_mfma_f32_16x16x32_bf16 v[160:163], v[120:123], v[32:35], v[160:163]
    v_mfma_f32_16x16x32_bf16 v[196:199], v[120:123], v[40:43], v[196:199]
    v_mfma_f32_16x16x32_bf16 v[164:167], v[124:127], v[32:35], v[164:167]
    v_mfma_f32_16x16x32_bf16 v[200:203], v[124:127], v[40:43], v[200:203]
    v_mfma_f32_16x16x32_bf16 v[168:171], v[128:131], v[32:35], v[168:171]
    v_mfma_f32_16x16x32_bf16 v[204:207], v[128:131], v[40:43], v[204:207]
    v_mfma_f32_16x16x32_bf16 v[172:175], v[132:135], v[32:35], v[172:175]
    v_mfma_f32_16x16x32_bf16 v[208:211], v[132:135], v[40:43], v[208:211]
    v_mfma_f32_16x16x32_bf16 v[176:179], v[136:139], v[32:35], v[176:179]
    v_mfma_f32_16x16x32_bf16 v[212:215], v[136:139], v[40:43], v[212:215]
    v_mfma_f32_16x16x32_bf16 v[180:183], v[140:143], v[32:35], v[180:183]
    v_mfma_f32_16x16x32_bf16 v[216:219], v[140:143], v[40:43], v[216:219]
    v_mfma_f32_16x16x32_bf16 v[184:187], v[144:147], v[32:35], v[184:187]
    v_mfma_f32_16x16x32_bf16 v[220:223], v[144:147], v[40:43], v[220:223]
    v_mfma_f32_16x16x32_bf16 v[188:191], v[148:151], v[32:35], v[188:191]
    v_mfma_f32_16x16x32_bf16 v[224:227], v[148:151], v[40:43], v[224:227]
    ds_read_b64_tr_b16 v[116:117], v30 offset:29184
    ds_read_b64_tr_b16 v[118:119], v30 offset:30336
    ds_read_b64_tr_b16 v[120:121], v30 offset:29216
    ds_read_b64_tr_b16 v[122:123], v30 offset:30368
    ds_read_b64_tr_b16 v[124:125], v30 offset:29248
    ds_read_b64_tr_b16 v[126:127], v30 offset:30400
    ds_read_b64_tr_b16 v[128:129], v30 offset:29280
    ds_read_b64_tr_b16 v[130:131], v30 offset:30432
    ds_read_b64_tr_b16 v[132:133], v30 offset:29312
    ds_read_b64_tr_b16 v[134:135], v30 offset:30464
    ds_read_b64_tr_b16 v[136:137], v30 offset:29344
    ds_read_b64_tr_b16 v[138:139], v30 offset:30496
    ds_read_b64_tr_b16 v[140:141], v30 offset:29376
    ds_read_b64_tr_b16 v[142:143], v30 offset:30528
    ds_read_b64_tr_b16 v[144:145], v30 offset:29408
    ds_read_b64_tr_b16 v[146:147], v30 offset:30560
    ds_read_b64_tr_b16 v[148:149], v30 offset:29440
    ds_read_b64_tr_b16 v[150:151], v30 offset:30592
    s_waitcnt lgkmcnt(0)
    v_mfma_f32_16x16x32_bf16 v[156:159], v[116:119], v[36:39], v[156:159]
    v_mfma_f32_16x16x32_bf16 v[192:195], v[116:119], v[44:47], v[192:195]
    v_mfma_f32_16x16x32_bf16 v[160:163], v[120:123], v[36:39], v[160:163]
    v_mfma_f32_16x16x32_bf16 v[196:199], v[120:123], v[44:47], v[196:199]
    v_mfma_f32_16x16x32_bf16 v[164:167], v[124:127], v[36:39], v[164:167]
    v_mfma_f32_16x16x32_bf16 v[200:203], v[124:127], v[44:47], v[200:203]
    v_mfma_f32_16x16x32_bf16 v[168:171], v[128:131], v[36:39], v[168:171]
    v_mfma_f32_16x16x32_bf16 v[204:207], v[128:131], v[44:47], v[204:207]
    v_mfma_f32_16x16x32_bf16 v[172:175], v[132:135], v[36:39], v[172:175]
    v_mfma_f32_16x16x32_bf16 v[208:211], v[132:135], v[44:47], v[208:211]
    v_mfma_f32_16x16x32_bf16 v[176:179], v[136:139], v[36:39], v[176:179]
    v_mfma_f32_16x16x32_bf16 v[212:215], v[136:139], v[44:47], v[212:215]
    v_mfma_f32_16x16x32_bf16 v[180:183], v[140:143], v[36:39], v[180:183]
    v_mfma_f32_16x16x32_bf16 v[216:219], v[140:143], v[44:47], v[216:219]
    v_mfma_f32_16x16x32_bf16 v[184:187], v[144:147], v[36:39], v[184:187]
    v_mfma_f32_16x16x32_bf16 v[220:223], v[144:147], v[44:47], v[220:223]
    v_mfma_f32_16x16x32_bf16 v[188:191], v[148:151], v[36:39], v[188:191]
    v_mfma_f32_16x16x32_bf16 v[224:227], v[148:151], v[44:47], v[224:227]
    s_waitcnt vmcnt(17)
    ds_write_b64 v21, v[80:81] offset:0
    ds_write_b64 v22, v[82:83] offset:0
    ds_write_b64 v23, v[84:85] offset:0
    ds_write_b64 v24, v[86:87] offset:0
    ds_write_b64 v25, v[88:89] offset:0
    ds_write_b64 v26, v[90:91] offset:0
    ds_write_b64 v27, v[92:93] offset:0
    ds_write_b64 v28, v[94:95] offset:0
    ds_write_b64 v29, v[96:97] offset:0
    s_waitcnt lgkmcnt(0)
    s_barrier
    s_add_u32 s29, s28, 442368
    buffer_load_dwordx2 v[80:81], v12, s[12:15], s29 offen
    buffer_load_dwordx2 v[82:83], v13, s[12:15], s29 offen
    buffer_load_dwordx2 v[84:85], v14, s[12:15], s29 offen
    buffer_load_dwordx2 v[86:87], v15, s[12:15], s29 offen
    buffer_load_dwordx2 v[88:89], v16, s[12:15], s29 offen
    buffer_load_dwordx2 v[90:91], v17, s[12:15], s29 offen
    buffer_load_dwordx2 v[92:93], v18, s[12:15], s29 offen
    buffer_load_dwordx2 v[94:95], v19, s[12:15], s29 offen
    buffer_load_dwordx2 v[96:97], v20, s[12:15], s29 offen
    s_add_u32 s30, s27, 768
    buffer_load_dwordx4 v[32:35], v10, s[8:11], s30 offen offset:0
    buffer_load_dwordx4 v[36:39], v10, s[8:11], s30 offen offset:64
    buffer_load_dwordx4 v[40:43], v11, s[8:11], s30 offen offset:0
    buffer_load_dwordx4 v[44:47], v11, s[8:11], s30 offen offset:64
    ds_read_b64_tr_b16 v[116:117], v30 offset:0
    ds_read_b64_tr_b16 v[118:119], v30 offset:1152
    ds_read_b64_tr_b16 v[120:121], v30 offset:32
    ds_read_b64_tr_b16 v[122:123], v30 offset:1184
    ds_read_b64_tr_b16 v[124:125], v30 offset:64
    ds_read_b64_tr_b16 v[126:127], v30 offset:1216
    ds_read_b64_tr_b16 v[128:129], v30 offset:96
    ds_read_b64_tr_b16 v[130:131], v30 offset:1248
    ds_read_b64_tr_b16 v[132:133], v30 offset:128
    ds_read_b64_tr_b16 v[134:135], v30 offset:1280
    ds_read_b64_tr_b16 v[136:137], v30 offset:160
    ds_read_b64_tr_b16 v[138:139], v30 offset:1312
    ds_read_b64_tr_b16 v[140:141], v30 offset:192
    ds_read_b64_tr_b16 v[142:143], v30 offset:1344
    ds_read_b64_tr_b16 v[144:145], v30 offset:224
    ds_read_b64_tr_b16 v[146:147], v30 offset:1376
    ds_read_b64_tr_b16 v[148:149], v30 offset:256
    ds_read_b64_tr_b16 v[150:151], v30 offset:1408
    s_waitcnt vmcnt(26)
    s_waitcnt lgkmcnt(0)
    v_mfma_f32_16x16x32_bf16 v[156:159], v[116:119], v[48:51], v[156:159]
    v_mfma_f32_16x16x32_bf16 v[192:195], v[116:119], v[56:59], v[192:195]
    v_mfma_f32_16x16x32_bf16 v[160:163], v[120:123], v[48:51], v[160:163]
    v_mfma_f32_16x16x32_bf16 v[196:199], v[120:123], v[56:59], v[196:199]
    v_mfma_f32_16x16x32_bf16 v[164:167], v[124:127], v[48:51], v[164:167]
    v_mfma_f32_16x16x32_bf16 v[200:203], v[124:127], v[56:59], v[200:203]
    v_mfma_f32_16x16x32_bf16 v[168:171], v[128:131], v[48:51], v[168:171]
    v_mfma_f32_16x16x32_bf16 v[204:207], v[128:131], v[56:59], v[204:207]
    v_mfma_f32_16x16x32_bf16 v[172:175], v[132:135], v[48:51], v[172:175]
    v_mfma_f32_16x16x32_bf16 v[208:211], v[132:135], v[56:59], v[208:211]
    v_mfma_f32_16x16x32_bf16 v[176:179], v[136:139], v[48:51], v[176:179]
    v_mfma_f32_16x16x32_bf16 v[212:215], v[136:139], v[56:59], v[212:215]
    v_mfma_f32_16x16x32_bf16 v[180:183], v[140:143], v[48:51], v[180:183]
    v_mfma_f32_16x16x32_bf16 v[216:219], v[140:143], v[56:59], v[216:219]
    v_mfma_f32_16x16x32_bf16 v[184:187], v[144:147], v[48:51], v[184:187]
    v_mfma_f32_16x16x32_bf16 v[220:223], v[144:147], v[56:59], v[220:223]
    v_mfma_f32_16x16x32_bf16 v[188:191], v[148:151], v[48:51], v[188:191]
    v_mfma_f32_16x16x32_bf16 v[224:227], v[148:151], v[56:59], v[224:227]
    ds_read_b64_tr_b16 v[116:117], v30 offset:9728
    ds_read_b64_tr_b16 v[118:119], v30 offset:10880
    ds_read_b64_tr_b16 v[120:121], v30 offset:9760
    ds_read_b64_tr_b16 v[122:123], v30 offset:10912
    ds_read_b64_tr_b16 v[124:125], v30 offset:9792
    ds_read_b64_tr_b16 v[126:127], v30 offset:10944
    ds_read_b64_tr_b16 v[128:129], v30 offset:9824
    ds_read_b64_tr_b16 v[130:131], v30 offset:10976
    ds_read_b64_tr_b16 v[132:133], v30 offset:9856
    ds_read_b64_tr_b16 v[134:135], v30 offset:11008
    ds_read_b64_tr_b16 v[136:137], v30 offset:9888
    ds_read_b64_tr_b16 v[138:139], v30 offset:11040
    ds_read_b64_tr_b16 v[140:141], v30 offset:9920
    ds_read_b64_tr_b16 v[142:143], v30 offset:11072
    ds_read_b64_tr_b16 v[144:145], v30 offset:9952
    ds_read_b64_tr_b16 v[146:147], v30 offset:11104
    ds_read_b64_tr_b16 v[148:149], v30 offset:9984
    ds_read_b64_tr_b16 v[150:151], v30 offset:11136
    s_waitcnt lgkmcnt(0)
    v_mfma_f32_16x16x32_bf16 v[156:159], v[116:119], v[52:55], v[156:159]
    v_mfma_f32_16x16x32_bf16 v[192:195], v[116:119], v[60:63], v[192:195]
    v_mfma_f32_16x16x32_bf16 v[160:163], v[120:123], v[52:55], v[160:163]
    v_mfma_f32_16x16x32_bf16 v[196:199], v[120:123], v[60:63], v[196:199]
    v_mfma_f32_16x16x32_bf16 v[164:167], v[124:127], v[52:55], v[164:167]
    v_mfma_f32_16x16x32_bf16 v[200:203], v[124:127], v[60:63], v[200:203]
    v_mfma_f32_16x16x32_bf16 v[168:171], v[128:131], v[52:55], v[168:171]
    v_mfma_f32_16x16x32_bf16 v[204:207], v[128:131], v[60:63], v[204:207]
    v_mfma_f32_16x16x32_bf16 v[172:175], v[132:135], v[52:55], v[172:175]
    v_mfma_f32_16x16x32_bf16 v[208:211], v[132:135], v[60:63], v[208:211]
    v_mfma_f32_16x16x32_bf16 v[176:179], v[136:139], v[52:55], v[176:179]
    v_mfma_f32_16x16x32_bf16 v[212:215], v[136:139], v[60:63], v[212:215]
    v_mfma_f32_16x16x32_bf16 v[180:183], v[140:143], v[52:55], v[180:183]
    v_mfma_f32_16x16x32_bf16 v[216:219], v[140:143], v[60:63], v[216:219]
    v_mfma_f32_16x16x32_bf16 v[184:187], v[144:147], v[52:55], v[184:187]
    v_mfma_f32_16x16x32_bf16 v[220:223], v[144:147], v[60:63], v[220:223]
    v_mfma_f32_16x16x32_bf16 v[188:191], v[148:151], v[52:55], v[188:191]
    v_mfma_f32_16x16x32_bf16 v[224:227], v[148:151], v[60:63], v[224:227]
    s_waitcnt vmcnt(17)
    ds_write_b64 v21, v[98:99] offset:19456
    ds_write_b64 v22, v[100:101] offset:19456
    ds_write_b64 v23, v[102:103] offset:19456
    ds_write_b64 v24, v[104:105] offset:19456
    ds_write_b64 v25, v[106:107] offset:19456
    ds_write_b64 v26, v[108:109] offset:19456
    ds_write_b64 v27, v[110:111] offset:19456
    ds_write_b64 v28, v[112:113] offset:19456
    ds_write_b64 v29, v[114:115] offset:19456
    s_waitcnt lgkmcnt(0)
    s_barrier
    s_add_u32 s29, s28, 516096
    buffer_load_dwordx2 v[98:99], v12, s[12:15], s29 offen
    buffer_load_dwordx2 v[100:101], v13, s[12:15], s29 offen
    buffer_load_dwordx2 v[102:103], v14, s[12:15], s29 offen
    buffer_load_dwordx2 v[104:105], v15, s[12:15], s29 offen
    buffer_load_dwordx2 v[106:107], v16, s[12:15], s29 offen
    buffer_load_dwordx2 v[108:109], v17, s[12:15], s29 offen
    buffer_load_dwordx2 v[110:111], v18, s[12:15], s29 offen
    buffer_load_dwordx2 v[112:113], v19, s[12:15], s29 offen
    buffer_load_dwordx2 v[114:115], v20, s[12:15], s29 offen
    s_add_u32 s30, s27, 896
    buffer_load_dwordx4 v[48:51], v10, s[8:11], s30 offen offset:0
    buffer_load_dwordx4 v[52:55], v10, s[8:11], s30 offen offset:64
    buffer_load_dwordx4 v[56:59], v11, s[8:11], s30 offen offset:0
    buffer_load_dwordx4 v[60:63], v11, s[8:11], s30 offen offset:64
    ds_read_b64_tr_b16 v[116:117], v30 offset:19456
    ds_read_b64_tr_b16 v[118:119], v30 offset:20608
    ds_read_b64_tr_b16 v[120:121], v30 offset:19488
    ds_read_b64_tr_b16 v[122:123], v30 offset:20640
    ds_read_b64_tr_b16 v[124:125], v30 offset:19520
    ds_read_b64_tr_b16 v[126:127], v30 offset:20672
    ds_read_b64_tr_b16 v[128:129], v30 offset:19552
    ds_read_b64_tr_b16 v[130:131], v30 offset:20704
    ds_read_b64_tr_b16 v[132:133], v30 offset:19584
    ds_read_b64_tr_b16 v[134:135], v30 offset:20736
    ds_read_b64_tr_b16 v[136:137], v30 offset:19616
    ds_read_b64_tr_b16 v[138:139], v30 offset:20768
    ds_read_b64_tr_b16 v[140:141], v30 offset:19648
    ds_read_b64_tr_b16 v[142:143], v30 offset:20800
    ds_read_b64_tr_b16 v[144:145], v30 offset:19680
    ds_read_b64_tr_b16 v[146:147], v30 offset:20832
    ds_read_b64_tr_b16 v[148:149], v30 offset:19712
    ds_read_b64_tr_b16 v[150:151], v30 offset:20864
    s_waitcnt vmcnt(26)
    s_waitcnt lgkmcnt(0)
    v_mfma_f32_16x16x32_bf16 v[156:159], v[116:119], v[64:67], v[156:159]
    v_mfma_f32_16x16x32_bf16 v[192:195], v[116:119], v[72:75], v[192:195]
    v_mfma_f32_16x16x32_bf16 v[160:163], v[120:123], v[64:67], v[160:163]
    v_mfma_f32_16x16x32_bf16 v[196:199], v[120:123], v[72:75], v[196:199]
    v_mfma_f32_16x16x32_bf16 v[164:167], v[124:127], v[64:67], v[164:167]
    v_mfma_f32_16x16x32_bf16 v[200:203], v[124:127], v[72:75], v[200:203]
    v_mfma_f32_16x16x32_bf16 v[168:171], v[128:131], v[64:67], v[168:171]
    v_mfma_f32_16x16x32_bf16 v[204:207], v[128:131], v[72:75], v[204:207]
    v_mfma_f32_16x16x32_bf16 v[172:175], v[132:135], v[64:67], v[172:175]
    v_mfma_f32_16x16x32_bf16 v[208:211], v[132:135], v[72:75], v[208:211]
    v_mfma_f32_16x16x32_bf16 v[176:179], v[136:139], v[64:67], v[176:179]
    v_mfma_f32_16x16x32_bf16 v[212:215], v[136:139], v[72:75], v[212:215]
    v_mfma_f32_16x16x32_bf16 v[180:183], v[140:143], v[64:67], v[180:183]
    v_mfma_f32_16x16x32_bf16 v[216:219], v[140:143], v[72:75], v[216:219]
    v_mfma_f32_16x16x32_bf16 v[184:187], v[144:147], v[64:67], v[184:187]
    v_mfma_f32_16x16x32_bf16 v[220:223], v[144:147], v[72:75], v[220:223]
    v_mfma_f32_16x16x32_bf16 v[188:191], v[148:151], v[64:67], v[188:191]
    v_mfma_f32_16x16x32_bf16 v[224:227], v[148:151], v[72:75], v[224:227]
    ds_read_b64_tr_b16 v[116:117], v30 offset:29184
    ds_read_b64_tr_b16 v[118:119], v30 offset:30336
    ds_read_b64_tr_b16 v[120:121], v30 offset:29216
    ds_read_b64_tr_b16 v[122:123], v30 offset:30368
    ds_read_b64_tr_b16 v[124:125], v30 offset:29248
    ds_read_b64_tr_b16 v[126:127], v30 offset:30400
    ds_read_b64_tr_b16 v[128:129], v30 offset:29280
    ds_read_b64_tr_b16 v[130:131], v30 offset:30432
    ds_read_b64_tr_b16 v[132:133], v30 offset:29312
    ds_read_b64_tr_b16 v[134:135], v30 offset:30464
    ds_read_b64_tr_b16 v[136:137], v30 offset:29344
    ds_read_b64_tr_b16 v[138:139], v30 offset:30496
    ds_read_b64_tr_b16 v[140:141], v30 offset:29376
    ds_read_b64_tr_b16 v[142:143], v30 offset:30528
    ds_read_b64_tr_b16 v[144:145], v30 offset:29408
    ds_read_b64_tr_b16 v[146:147], v30 offset:30560
    ds_read_b64_tr_b16 v[148:149], v30 offset:29440
    ds_read_b64_tr_b16 v[150:151], v30 offset:30592
    s_waitcnt lgkmcnt(0)
    v_mfma_f32_16x16x32_bf16 v[156:159], v[116:119], v[68:71], v[156:159]
    v_mfma_f32_16x16x32_bf16 v[192:195], v[116:119], v[76:79], v[192:195]
    v_mfma_f32_16x16x32_bf16 v[160:163], v[120:123], v[68:71], v[160:163]
    v_mfma_f32_16x16x32_bf16 v[196:199], v[120:123], v[76:79], v[196:199]
    v_mfma_f32_16x16x32_bf16 v[164:167], v[124:127], v[68:71], v[164:167]
    v_mfma_f32_16x16x32_bf16 v[200:203], v[124:127], v[76:79], v[200:203]
    v_mfma_f32_16x16x32_bf16 v[168:171], v[128:131], v[68:71], v[168:171]
    v_mfma_f32_16x16x32_bf16 v[204:207], v[128:131], v[76:79], v[204:207]
    v_mfma_f32_16x16x32_bf16 v[172:175], v[132:135], v[68:71], v[172:175]
    v_mfma_f32_16x16x32_bf16 v[208:211], v[132:135], v[76:79], v[208:211]
    v_mfma_f32_16x16x32_bf16 v[176:179], v[136:139], v[68:71], v[176:179]
    v_mfma_f32_16x16x32_bf16 v[212:215], v[136:139], v[76:79], v[212:215]
    v_mfma_f32_16x16x32_bf16 v[180:183], v[140:143], v[68:71], v[180:183]
    v_mfma_f32_16x16x32_bf16 v[216:219], v[140:143], v[76:79], v[216:219]
    v_mfma_f32_16x16x32_bf16 v[184:187], v[144:147], v[68:71], v[184:187]
    v_mfma_f32_16x16x32_bf16 v[220:223], v[144:147], v[76:79], v[220:223]
    v_mfma_f32_16x16x32_bf16 v[188:191], v[148:151], v[68:71], v[188:191]
    v_mfma_f32_16x16x32_bf16 v[224:227], v[148:151], v[76:79], v[224:227]
    s_waitcnt vmcnt(17)
    ds_write_b64 v21, v[80:81] offset:0
    ds_write_b64 v22, v[82:83] offset:0
    ds_write_b64 v23, v[84:85] offset:0
    ds_write_b64 v24, v[86:87] offset:0
    ds_write_b64 v25, v[88:89] offset:0
    ds_write_b64 v26, v[90:91] offset:0
    ds_write_b64 v27, v[92:93] offset:0
    ds_write_b64 v28, v[94:95] offset:0
    ds_write_b64 v29, v[96:97] offset:0
    s_waitcnt lgkmcnt(0)
    s_barrier
    s_add_u32 s29, s28, 589824
    buffer_load_dwordx2 v[80:81], v12, s[12:15], s29 offen
    buffer_load_dwordx2 v[82:83], v13, s[12:15], s29 offen
    buffer_load_dwordx2 v[84:85], v14, s[12:15], s29 offen
    buffer_load_dwordx2 v[86:87], v15, s[12:15], s29 offen
    buffer_load_dwordx2 v[88:89], v16, s[12:15], s29 offen
    buffer_load_dwordx2 v[90:91], v17, s[12:15], s29 offen
    buffer_load_dwordx2 v[92:93], v18, s[12:15], s29 offen
    buffer_load_dwordx2 v[94:95], v19, s[12:15], s29 offen
    buffer_load_dwordx2 v[96:97], v20, s[12:15], s29 offen
    s_add_u32 s30, s27, 1024
    buffer_load_dwordx4 v[64:67], v10, s[8:11], s30 offen offset:0
    buffer_load_dwordx4 v[68:71], v10, s[8:11], s30 offen offset:64
    buffer_load_dwordx4 v[72:75], v11, s[8:11], s30 offen offset:0
    buffer_load_dwordx4 v[76:79], v11, s[8:11], s30 offen offset:64
    ds_read_b64_tr_b16 v[116:117], v30 offset:0
    ds_read_b64_tr_b16 v[118:119], v30 offset:1152
    ds_read_b64_tr_b16 v[120:121], v30 offset:32
    ds_read_b64_tr_b16 v[122:123], v30 offset:1184
    ds_read_b64_tr_b16 v[124:125], v30 offset:64
    ds_read_b64_tr_b16 v[126:127], v30 offset:1216
    ds_read_b64_tr_b16 v[128:129], v30 offset:96
    ds_read_b64_tr_b16 v[130:131], v30 offset:1248
    ds_read_b64_tr_b16 v[132:133], v30 offset:128
    ds_read_b64_tr_b16 v[134:135], v30 offset:1280
    ds_read_b64_tr_b16 v[136:137], v30 offset:160
    ds_read_b64_tr_b16 v[138:139], v30 offset:1312
    ds_read_b64_tr_b16 v[140:141], v30 offset:192
    ds_read_b64_tr_b16 v[142:143], v30 offset:1344
    ds_read_b64_tr_b16 v[144:145], v30 offset:224
    ds_read_b64_tr_b16 v[146:147], v30 offset:1376
    ds_read_b64_tr_b16 v[148:149], v30 offset:256
    ds_read_b64_tr_b16 v[150:151], v30 offset:1408
    s_waitcnt vmcnt(26)
    s_waitcnt lgkmcnt(0)
    v_mfma_f32_16x16x32_bf16 v[156:159], v[116:119], v[32:35], v[156:159]
    v_mfma_f32_16x16x32_bf16 v[192:195], v[116:119], v[40:43], v[192:195]
    v_mfma_f32_16x16x32_bf16 v[160:163], v[120:123], v[32:35], v[160:163]
    v_mfma_f32_16x16x32_bf16 v[196:199], v[120:123], v[40:43], v[196:199]
    v_mfma_f32_16x16x32_bf16 v[164:167], v[124:127], v[32:35], v[164:167]
    v_mfma_f32_16x16x32_bf16 v[200:203], v[124:127], v[40:43], v[200:203]
    v_mfma_f32_16x16x32_bf16 v[168:171], v[128:131], v[32:35], v[168:171]
    v_mfma_f32_16x16x32_bf16 v[204:207], v[128:131], v[40:43], v[204:207]
    v_mfma_f32_16x16x32_bf16 v[172:175], v[132:135], v[32:35], v[172:175]
    v_mfma_f32_16x16x32_bf16 v[208:211], v[132:135], v[40:43], v[208:211]
    v_mfma_f32_16x16x32_bf16 v[176:179], v[136:139], v[32:35], v[176:179]
    v_mfma_f32_16x16x32_bf16 v[212:215], v[136:139], v[40:43], v[212:215]
    v_mfma_f32_16x16x32_bf16 v[180:183], v[140:143], v[32:35], v[180:183]
    v_mfma_f32_16x16x32_bf16 v[216:219], v[140:143], v[40:43], v[216:219]
    v_mfma_f32_16x16x32_bf16 v[184:187], v[144:147], v[32:35], v[184:187]
    v_mfma_f32_16x16x32_bf16 v[220:223], v[144:147], v[40:43], v[220:223]
    v_mfma_f32_16x16x32_bf16 v[188:191], v[148:151], v[32:35], v[188:191]
    v_mfma_f32_16x16x32_bf16 v[224:227], v[148:151], v[40:43], v[224:227]
    ds_read_b64_tr_b16 v[116:117], v30 offset:9728
    ds_read_b64_tr_b16 v[118:119], v30 offset:10880
    ds_read_b64_tr_b16 v[120:121], v30 offset:9760
    ds_read_b64_tr_b16 v[122:123], v30 offset:10912
    ds_read_b64_tr_b16 v[124:125], v30 offset:9792
    ds_read_b64_tr_b16 v[126:127], v30 offset:10944
    ds_read_b64_tr_b16 v[128:129], v30 offset:9824
    ds_read_b64_tr_b16 v[130:131], v30 offset:10976
    ds_read_b64_tr_b16 v[132:133], v30 offset:9856
    ds_read_b64_tr_b16 v[134:135], v30 offset:11008
    ds_read_b64_tr_b16 v[136:137], v30 offset:9888
    ds_read_b64_tr_b16 v[138:139], v30 offset:11040
    ds_read_b64_tr_b16 v[140:141], v30 offset:9920
    ds_read_b64_tr_b16 v[142:143], v30 offset:11072
    ds_read_b64_tr_b16 v[144:145], v30 offset:9952
    ds_read_b64_tr_b16 v[146:147], v30 offset:11104
    ds_read_b64_tr_b16 v[148:149], v30 offset:9984
    ds_read_b64_tr_b16 v[150:151], v30 offset:11136
    s_waitcnt lgkmcnt(0)
    v_mfma_f32_16x16x32_bf16 v[156:159], v[116:119], v[36:39], v[156:159]
    v_mfma_f32_16x16x32_bf16 v[192:195], v[116:119], v[44:47], v[192:195]
    v_mfma_f32_16x16x32_bf16 v[160:163], v[120:123], v[36:39], v[160:163]
    v_mfma_f32_16x16x32_bf16 v[196:199], v[120:123], v[44:47], v[196:199]
    v_mfma_f32_16x16x32_bf16 v[164:167], v[124:127], v[36:39], v[164:167]
    v_mfma_f32_16x16x32_bf16 v[200:203], v[124:127], v[44:47], v[200:203]
    v_mfma_f32_16x16x32_bf16 v[168:171], v[128:131], v[36:39], v[168:171]
    v_mfma_f32_16x16x32_bf16 v[204:207], v[128:131], v[44:47], v[204:207]
    v_mfma_f32_16x16x32_bf16 v[172:175], v[132:135], v[36:39], v[172:175]
    v_mfma_f32_16x16x32_bf16 v[208:211], v[132:135], v[44:47], v[208:211]
    v_mfma_f32_16x16x32_bf16 v[176:179], v[136:139], v[36:39], v[176:179]
    v_mfma_f32_16x16x32_bf16 v[212:215], v[136:139], v[44:47], v[212:215]
    v_mfma_f32_16x16x32_bf16 v[180:183], v[140:143], v[36:39], v[180:183]
    v_mfma_f32_16x16x32_bf16 v[216:219], v[140:143], v[44:47], v[216:219]
    v_mfma_f32_16x16x32_bf16 v[184:187], v[144:147], v[36:39], v[184:187]
    v_mfma_f32_16x16x32_bf16 v[220:223], v[144:147], v[44:47], v[220:223]
    v_mfma_f32_16x16x32_bf16 v[188:191], v[148:151], v[36:39], v[188:191]
    v_mfma_f32_16x16x32_bf16 v[224:227], v[148:151], v[44:47], v[224:227]
    s_waitcnt vmcnt(17)
    ds_write_b64 v21, v[98:99] offset:19456
    ds_write_b64 v22, v[100:101] offset:19456
    ds_write_b64 v23, v[102:103] offset:19456
    ds_write_b64 v24, v[104:105] offset:19456
    ds_write_b64 v25, v[106:107] offset:19456
    ds_write_b64 v26, v[108:109] offset:19456
    ds_write_b64 v27, v[110:111] offset:19456
    ds_write_b64 v28, v[112:113] offset:19456
    ds_write_b64 v29, v[114:115] offset:19456
    s_waitcnt lgkmcnt(0)
    s_barrier
    s_add_u32 s29, s28, 663552
    buffer_load_dwordx2 v[98:99], v12, s[12:15], s29 offen
    buffer_load_dwordx2 v[100:101], v13, s[12:15], s29 offen
    buffer_load_dwordx2 v[102:103], v14, s[12:15], s29 offen
    buffer_load_dwordx2 v[104:105], v15, s[12:15], s29 offen
    buffer_load_dwordx2 v[106:107], v16, s[12:15], s29 offen
    buffer_load_dwordx2 v[108:109], v17, s[12:15], s29 offen
    buffer_load_dwordx2 v[110:111], v18, s[12:15], s29 offen
    buffer_load_dwordx2 v[112:113], v19, s[12:15], s29 offen
    buffer_load_dwordx2 v[114:115], v20, s[12:15], s29 offen
    s_add_u32 s30, s27, 1152
    buffer_load_dwordx4 v[32:35], v10, s[8:11], s30 offen offset:0
    buffer_load_dwordx4 v[36:39], v10, s[8:11], s30 offen offset:64
    buffer_load_dwordx4 v[40:43], v11, s[8:11], s30 offen offset:0
    buffer_load_dwordx4 v[44:47], v11, s[8:11], s30 offen offset:64
    ds_read_b64_tr_b16 v[116:117], v30 offset:19456
    ds_read_b64_tr_b16 v[118:119], v30 offset:20608
    ds_read_b64_tr_b16 v[120:121], v30 offset:19488
    ds_read_b64_tr_b16 v[122:123], v30 offset:20640
    ds_read_b64_tr_b16 v[124:125], v30 offset:19520
    ds_read_b64_tr_b16 v[126:127], v30 offset:20672
    ds_read_b64_tr_b16 v[128:129], v30 offset:19552
    ds_read_b64_tr_b16 v[130:131], v30 offset:20704
    ds_read_b64_tr_b16 v[132:133], v30 offset:19584
    ds_read_b64_tr_b16 v[134:135], v30 offset:20736
    ds_read_b64_tr_b16 v[136:137], v30 offset:19616
    ds_read_b64_tr_b16 v[138:139], v30 offset:20768
    ds_read_b64_tr_b16 v[140:141], v30 offset:19648
    ds_read_b64_tr_b16 v[142:143], v30 offset:20800
    ds_read_b64_tr_b16 v[144:145], v30 offset:19680
    ds_read_b64_tr_b16 v[146:147], v30 offset:20832
    ds_read_b64_tr_b16 v[148:149], v30 offset:19712
    ds_read_b64_tr_b16 v[150:151], v30 offset:20864
    s_waitcnt vmcnt(26)
    s_waitcnt lgkmcnt(0)
    v_mfma_f32_16x16x32_bf16 v[156:159], v[116:119], v[48:51], v[156:159]
    v_mfma_f32_16x16x32_bf16 v[192:195], v[116:119], v[56:59], v[192:195]
    v_mfma_f32_16x16x32_bf16 v[160:163], v[120:123], v[48:51], v[160:163]
    v_mfma_f32_16x16x32_bf16 v[196:199], v[120:123], v[56:59], v[196:199]
    v_mfma_f32_16x16x32_bf16 v[164:167], v[124:127], v[48:51], v[164:167]
    v_mfma_f32_16x16x32_bf16 v[200:203], v[124:127], v[56:59], v[200:203]
    v_mfma_f32_16x16x32_bf16 v[168:171], v[128:131], v[48:51], v[168:171]
    v_mfma_f32_16x16x32_bf16 v[204:207], v[128:131], v[56:59], v[204:207]
    v_mfma_f32_16x16x32_bf16 v[172:175], v[132:135], v[48:51], v[172:175]
    v_mfma_f32_16x16x32_bf16 v[208:211], v[132:135], v[56:59], v[208:211]
    v_mfma_f32_16x16x32_bf16 v[176:179], v[136:139], v[48:51], v[176:179]
    v_mfma_f32_16x16x32_bf16 v[212:215], v[136:139], v[56:59], v[212:215]
    v_mfma_f32_16x16x32_bf16 v[180:183], v[140:143], v[48:51], v[180:183]
    v_mfma_f32_16x16x32_bf16 v[216:219], v[140:143], v[56:59], v[216:219]
    v_mfma_f32_16x16x32_bf16 v[184:187], v[144:147], v[48:51], v[184:187]
    v_mfma_f32_16x16x32_bf16 v[220:223], v[144:147], v[56:59], v[220:223]
    v_mfma_f32_16x16x32_bf16 v[188:191], v[148:151], v[48:51], v[188:191]
    v_mfma_f32_16x16x32_bf16 v[224:227], v[148:151], v[56:59], v[224:227]
    ds_read_b64_tr_b16 v[116:117], v30 offset:29184
    ds_read_b64_tr_b16 v[118:119], v30 offset:30336
    ds_read_b64_tr_b16 v[120:121], v30 offset:29216
    ds_read_b64_tr_b16 v[122:123], v30 offset:30368
    ds_read_b64_tr_b16 v[124:125], v30 offset:29248
    ds_read_b64_tr_b16 v[126:127], v30 offset:30400
    ds_read_b64_tr_b16 v[128:129], v30 offset:29280
    ds_read_b64_tr_b16 v[130:131], v30 offset:30432
    ds_read_b64_tr_b16 v[132:133], v30 offset:29312
    ds_read_b64_tr_b16 v[134:135], v30 offset:30464
    ds_read_b64_tr_b16 v[136:137], v30 offset:29344
    ds_read_b64_tr_b16 v[138:139], v30 offset:30496
    ds_read_b64_tr_b16 v[140:141], v30 offset:29376
    ds_read_b64_tr_b16 v[142:143], v30 offset:30528
    ds_read_b64_tr_b16 v[144:145], v30 offset:29408
    ds_read_b64_tr_b16 v[146:147], v30 offset:30560
    ds_read_b64_tr_b16 v[148:149], v30 offset:29440
    ds_read_b64_tr_b16 v[150:151], v30 offset:30592
    s_waitcnt lgkmcnt(0)
    v_mfma_f32_16x16x32_bf16 v[156:159], v[116:119], v[52:55], v[156:159]
    v_mfma_f32_16x16x32_bf16 v[192:195], v[116:119], v[60:63], v[192:195]
    v_mfma_f32_16x16x32_bf16 v[160:163], v[120:123], v[52:55], v[160:163]
    v_mfma_f32_16x16x32_bf16 v[196:199], v[120:123], v[60:63], v[196:199]
    v_mfma_f32_16x16x32_bf16 v[164:167], v[124:127], v[52:55], v[164:167]
    v_mfma_f32_16x16x32_bf16 v[200:203], v[124:127], v[60:63], v[200:203]
    v_mfma_f32_16x16x32_bf16 v[168:171], v[128:131], v[52:55], v[168:171]
    v_mfma_f32_16x16x32_bf16 v[204:207], v[128:131], v[60:63], v[204:207]
    v_mfma_f32_16x16x32_bf16 v[172:175], v[132:135], v[52:55], v[172:175]
    v_mfma_f32_16x16x32_bf16 v[208:211], v[132:135], v[60:63], v[208:211]
    v_mfma_f32_16x16x32_bf16 v[176:179], v[136:139], v[52:55], v[176:179]
    v_mfma_f32_16x16x32_bf16 v[212:215], v[136:139], v[60:63], v[212:215]
    v_mfma_f32_16x16x32_bf16 v[180:183], v[140:143], v[52:55], v[180:183]
    v_mfma_f32_16x16x32_bf16 v[216:219], v[140:143], v[60:63], v[216:219]
    v_mfma_f32_16x16x32_bf16 v[184:187], v[144:147], v[52:55], v[184:187]
    v_mfma_f32_16x16x32_bf16 v[220:223], v[144:147], v[60:63], v[220:223]
    v_mfma_f32_16x16x32_bf16 v[188:191], v[148:151], v[52:55], v[188:191]
    v_mfma_f32_16x16x32_bf16 v[224:227], v[148:151], v[60:63], v[224:227]
    s_waitcnt vmcnt(17)
    ds_write_b64 v21, v[80:81] offset:0
    ds_write_b64 v22, v[82:83] offset:0
    ds_write_b64 v23, v[84:85] offset:0
    ds_write_b64 v24, v[86:87] offset:0
    ds_write_b64 v25, v[88:89] offset:0
    ds_write_b64 v26, v[90:91] offset:0
    ds_write_b64 v27, v[92:93] offset:0
    ds_write_b64 v28, v[94:95] offset:0
    ds_write_b64 v29, v[96:97] offset:0
    s_waitcnt lgkmcnt(0)
    s_barrier
    s_add_u32 s29, s28, 737280
    buffer_load_dwordx2 v[80:81], v12, s[12:15], s29 offen
    buffer_load_dwordx2 v[82:83], v13, s[12:15], s29 offen
    buffer_load_dwordx2 v[84:85], v14, s[12:15], s29 offen
    buffer_load_dwordx2 v[86:87], v15, s[12:15], s29 offen
    buffer_load_dwordx2 v[88:89], v16, s[12:15], s29 offen
    buffer_load_dwordx2 v[90:91], v17, s[12:15], s29 offen
    buffer_load_dwordx2 v[92:93], v18, s[12:15], s29 offen
    buffer_load_dwordx2 v[94:95], v19, s[12:15], s29 offen
    buffer_load_dwordx2 v[96:97], v20, s[12:15], s29 offen
    s_add_u32 s30, s27, 1280
    buffer_load_dwordx4 v[48:51], v10, s[8:11], s30 offen offset:0
    buffer_load_dwordx4 v[52:55], v10, s[8:11], s30 offen offset:64
    buffer_load_dwordx4 v[56:59], v11, s[8:11], s30 offen offset:0
    buffer_load_dwordx4 v[60:63], v11, s[8:11], s30 offen offset:64
    ds_read_b64_tr_b16 v[116:117], v30 offset:0
    ds_read_b64_tr_b16 v[118:119], v30 offset:1152
    ds_read_b64_tr_b16 v[120:121], v30 offset:32
    ds_read_b64_tr_b16 v[122:123], v30 offset:1184
    ds_read_b64_tr_b16 v[124:125], v30 offset:64
    ds_read_b64_tr_b16 v[126:127], v30 offset:1216
    ds_read_b64_tr_b16 v[128:129], v30 offset:96
    ds_read_b64_tr_b16 v[130:131], v30 offset:1248
    ds_read_b64_tr_b16 v[132:133], v30 offset:128
    ds_read_b64_tr_b16 v[134:135], v30 offset:1280
    ds_read_b64_tr_b16 v[136:137], v30 offset:160
    ds_read_b64_tr_b16 v[138:139], v30 offset:1312
    ds_read_b64_tr_b16 v[140:141], v30 offset:192
    ds_read_b64_tr_b16 v[142:143], v30 offset:1344
    ds_read_b64_tr_b16 v[144:145], v30 offset:224
    ds_read_b64_tr_b16 v[146:147], v30 offset:1376
    ds_read_b64_tr_b16 v[148:149], v30 offset:256
    ds_read_b64_tr_b16 v[150:151], v30 offset:1408
    s_waitcnt vmcnt(26)
    s_waitcnt lgkmcnt(0)
    v_mfma_f32_16x16x32_bf16 v[156:159], v[116:119], v[64:67], v[156:159]
    v_mfma_f32_16x16x32_bf16 v[192:195], v[116:119], v[72:75], v[192:195]
    v_mfma_f32_16x16x32_bf16 v[160:163], v[120:123], v[64:67], v[160:163]
    v_mfma_f32_16x16x32_bf16 v[196:199], v[120:123], v[72:75], v[196:199]
    v_mfma_f32_16x16x32_bf16 v[164:167], v[124:127], v[64:67], v[164:167]
    v_mfma_f32_16x16x32_bf16 v[200:203], v[124:127], v[72:75], v[200:203]
    v_mfma_f32_16x16x32_bf16 v[168:171], v[128:131], v[64:67], v[168:171]
    v_mfma_f32_16x16x32_bf16 v[204:207], v[128:131], v[72:75], v[204:207]
    v_mfma_f32_16x16x32_bf16 v[172:175], v[132:135], v[64:67], v[172:175]
    v_mfma_f32_16x16x32_bf16 v[208:211], v[132:135], v[72:75], v[208:211]
    v_mfma_f32_16x16x32_bf16 v[176:179], v[136:139], v[64:67], v[176:179]
    v_mfma_f32_16x16x32_bf16 v[212:215], v[136:139], v[72:75], v[212:215]
    v_mfma_f32_16x16x32_bf16 v[180:183], v[140:143], v[64:67], v[180:183]
    v_mfma_f32_16x16x32_bf16 v[216:219], v[140:143], v[72:75], v[216:219]
    v_mfma_f32_16x16x32_bf16 v[184:187], v[144:147], v[64:67], v[184:187]
    v_mfma_f32_16x16x32_bf16 v[220:223], v[144:147], v[72:75], v[220:223]
    v_mfma_f32_16x16x32_bf16 v[188:191], v[148:151], v[64:67], v[188:191]
    v_mfma_f32_16x16x32_bf16 v[224:227], v[148:151], v[72:75], v[224:227]
    ds_read_b64_tr_b16 v[116:117], v30 offset:9728
    ds_read_b64_tr_b16 v[118:119], v30 offset:10880
    ds_read_b64_tr_b16 v[120:121], v30 offset:9760
    ds_read_b64_tr_b16 v[122:123], v30 offset:10912
    ds_read_b64_tr_b16 v[124:125], v30 offset:9792
    ds_read_b64_tr_b16 v[126:127], v30 offset:10944
    ds_read_b64_tr_b16 v[128:129], v30 offset:9824
    ds_read_b64_tr_b16 v[130:131], v30 offset:10976
    ds_read_b64_tr_b16 v[132:133], v30 offset:9856
    ds_read_b64_tr_b16 v[134:135], v30 offset:11008
    ds_read_b64_tr_b16 v[136:137], v30 offset:9888
    ds_read_b64_tr_b16 v[138:139], v30 offset:11040
    ds_read_b64_tr_b16 v[140:141], v30 offset:9920
    ds_read_b64_tr_b16 v[142:143], v30 offset:11072
    ds_read_b64_tr_b16 v[144:145], v30 offset:9952
    ds_read_b64_tr_b16 v[146:147], v30 offset:11104
    ds_read_b64_tr_b16 v[148:149], v30 offset:9984
    ds_read_b64_tr_b16 v[150:151], v30 offset:11136
    s_waitcnt lgkmcnt(0)
    v_mfma_f32_16x16x32_bf16 v[156:159], v[116:119], v[68:71], v[156:159]
    v_mfma_f32_16x16x32_bf16 v[192:195], v[116:119], v[76:79], v[192:195]
    v_mfma_f32_16x16x32_bf16 v[160:163], v[120:123], v[68:71], v[160:163]
    v_mfma_f32_16x16x32_bf16 v[196:199], v[120:123], v[76:79], v[196:199]
    v_mfma_f32_16x16x32_bf16 v[164:167], v[124:127], v[68:71], v[164:167]
    v_mfma_f32_16x16x32_bf16 v[200:203], v[124:127], v[76:79], v[200:203]
    v_mfma_f32_16x16x32_bf16 v[168:171], v[128:131], v[68:71], v[168:171]
    v_mfma_f32_16x16x32_bf16 v[204:207], v[128:131], v[76:79], v[204:207]
    v_mfma_f32_16x16x32_bf16 v[172:175], v[132:135], v[68:71], v[172:175]
    v_mfma_f32_16x16x32_bf16 v[208:211], v[132:135], v[76:79], v[208:211]
    v_mfma_f32_16x16x32_bf16 v[176:179], v[136:139], v[68:71], v[176:179]
    v_mfma_f32_16x16x32_bf16 v[212:215], v[136:139], v[76:79], v[212:215]
    v_mfma_f32_16x16x32_bf16 v[180:183], v[140:143], v[68:71], v[180:183]
    v_mfma_f32_16x16x32_bf16 v[216:219], v[140:143], v[76:79], v[216:219]
    v_mfma_f32_16x16x32_bf16 v[184:187], v[144:147], v[68:71], v[184:187]
    v_mfma_f32_16x16x32_bf16 v[220:223], v[144:147], v[76:79], v[220:223]
    v_mfma_f32_16x16x32_bf16 v[188:191], v[148:151], v[68:71], v[188:191]
    v_mfma_f32_16x16x32_bf16 v[224:227], v[148:151], v[76:79], v[224:227]
    s_waitcnt vmcnt(17)
    ds_write_b64 v21, v[98:99] offset:19456
    ds_write_b64 v22, v[100:101] offset:19456
    ds_write_b64 v23, v[102:103] offset:19456
    ds_write_b64 v24, v[104:105] offset:19456
    ds_write_b64 v25, v[106:107] offset:19456
    ds_write_b64 v26, v[108:109] offset:19456
    ds_write_b64 v27, v[110:111] offset:19456
    ds_write_b64 v28, v[112:113] offset:19456
    ds_write_b64 v29, v[114:115] offset:19456
    s_waitcnt lgkmcnt(0)
    s_barrier
    s_add_u32 s29, s28, 811008
    buffer_load_dwordx2 v[98:99], v12, s[12:15], s29 offen
    buffer_load_dwordx2 v[100:101], v13, s[12:15], s29 offen
    buffer_load_dwordx2 v[102:103], v14, s[12:15], s29 offen
    buffer_load_dwordx2 v[104:105], v15, s[12:15], s29 offen
    buffer_load_dwordx2 v[106:107], v16, s[12:15], s29 offen
    buffer_load_dwordx2 v[108:109], v17, s[12:15], s29 offen
    buffer_load_dwordx2 v[110:111], v18, s[12:15], s29 offen
    buffer_load_dwordx2 v[112:113], v19, s[12:15], s29 offen
    buffer_load_dwordx2 v[114:115], v20, s[12:15], s29 offen
    s_add_u32 s30, s27, 1408
    buffer_load_dwordx4 v[64:67], v10, s[8:11], s30 offen offset:0
    buffer_load_dwordx4 v[68:71], v10, s[8:11], s30 offen offset:64
    buffer_load_dwordx4 v[72:75], v11, s[8:11], s30 offen offset:0
    buffer_load_dwordx4 v[76:79], v11, s[8:11], s30 offen offset:64
    ds_read_b64_tr_b16 v[116:117], v30 offset:19456
    ds_read_b64_tr_b16 v[118:119], v30 offset:20608
    ds_read_b64_tr_b16 v[120:121], v30 offset:19488
    ds_read_b64_tr_b16 v[122:123], v30 offset:20640
    ds_read_b64_tr_b16 v[124:125], v30 offset:19520
    ds_read_b64_tr_b16 v[126:127], v30 offset:20672
    ds_read_b64_tr_b16 v[128:129], v30 offset:19552
    ds_read_b64_tr_b16 v[130:131], v30 offset:20704
    ds_read_b64_tr_b16 v[132:133], v30 offset:19584
    ds_read_b64_tr_b16 v[134:135], v30 offset:20736
    ds_read_b64_tr_b16 v[136:137], v30 offset:19616
    ds_read_b64_tr_b16 v[138:139], v30 offset:20768
    ds_read_b64_tr_b16 v[140:141], v30 offset:19648
    ds_read_b64_tr_b16 v[142:143], v30 offset:20800
    ds_read_b64_tr_b16 v[144:145], v30 offset:19680
    ds_read_b64_tr_b16 v[146:147], v30 offset:20832
    ds_read_b64_tr_b16 v[148:149], v30 offset:19712
    ds_read_b64_tr_b16 v[150:151], v30 offset:20864
    s_waitcnt vmcnt(26)
    s_waitcnt lgkmcnt(0)
    v_mfma_f32_16x16x32_bf16 v[156:159], v[116:119], v[32:35], v[156:159]
    v_mfma_f32_16x16x32_bf16 v[192:195], v[116:119], v[40:43], v[192:195]
    v_mfma_f32_16x16x32_bf16 v[160:163], v[120:123], v[32:35], v[160:163]
    v_mfma_f32_16x16x32_bf16 v[196:199], v[120:123], v[40:43], v[196:199]
    v_mfma_f32_16x16x32_bf16 v[164:167], v[124:127], v[32:35], v[164:167]
    v_mfma_f32_16x16x32_bf16 v[200:203], v[124:127], v[40:43], v[200:203]
    v_mfma_f32_16x16x32_bf16 v[168:171], v[128:131], v[32:35], v[168:171]
    v_mfma_f32_16x16x32_bf16 v[204:207], v[128:131], v[40:43], v[204:207]
    v_mfma_f32_16x16x32_bf16 v[172:175], v[132:135], v[32:35], v[172:175]
    v_mfma_f32_16x16x32_bf16 v[208:211], v[132:135], v[40:43], v[208:211]
    v_mfma_f32_16x16x32_bf16 v[176:179], v[136:139], v[32:35], v[176:179]
    v_mfma_f32_16x16x32_bf16 v[212:215], v[136:139], v[40:43], v[212:215]
    v_mfma_f32_16x16x32_bf16 v[180:183], v[140:143], v[32:35], v[180:183]
    v_mfma_f32_16x16x32_bf16 v[216:219], v[140:143], v[40:43], v[216:219]
    v_mfma_f32_16x16x32_bf16 v[184:187], v[144:147], v[32:35], v[184:187]
    v_mfma_f32_16x16x32_bf16 v[220:223], v[144:147], v[40:43], v[220:223]
    v_mfma_f32_16x16x32_bf16 v[188:191], v[148:151], v[32:35], v[188:191]
    v_mfma_f32_16x16x32_bf16 v[224:227], v[148:151], v[40:43], v[224:227]
    ds_read_b64_tr_b16 v[116:117], v30 offset:29184
    ds_read_b64_tr_b16 v[118:119], v30 offset:30336
    ds_read_b64_tr_b16 v[120:121], v30 offset:29216
    ds_read_b64_tr_b16 v[122:123], v30 offset:30368
    ds_read_b64_tr_b16 v[124:125], v30 offset:29248
    ds_read_b64_tr_b16 v[126:127], v30 offset:30400
    ds_read_b64_tr_b16 v[128:129], v30 offset:29280
    ds_read_b64_tr_b16 v[130:131], v30 offset:30432
    ds_read_b64_tr_b16 v[132:133], v30 offset:29312
    ds_read_b64_tr_b16 v[134:135], v30 offset:30464
    ds_read_b64_tr_b16 v[136:137], v30 offset:29344
    ds_read_b64_tr_b16 v[138:139], v30 offset:30496
    ds_read_b64_tr_b16 v[140:141], v30 offset:29376
    ds_read_b64_tr_b16 v[142:143], v30 offset:30528
    ds_read_b64_tr_b16 v[144:145], v30 offset:29408
    ds_read_b64_tr_b16 v[146:147], v30 offset:30560
    ds_read_b64_tr_b16 v[148:149], v30 offset:29440
    ds_read_b64_tr_b16 v[150:151], v30 offset:30592
    s_waitcnt lgkmcnt(0)
    v_mfma_f32_16x16x32_bf16 v[156:159], v[116:119], v[36:39], v[156:159]
    v_mfma_f32_16x16x32_bf16 v[192:195], v[116:119], v[44:47], v[192:195]
    v_mfma_f32_16x16x32_bf16 v[160:163], v[120:123], v[36:39], v[160:163]
    v_mfma_f32_16x16x32_bf16 v[196:199], v[120:123], v[44:47], v[196:199]
    v_mfma_f32_16x16x32_bf16 v[164:167], v[124:127], v[36:39], v[164:167]
    v_mfma_f32_16x16x32_bf16 v[200:203], v[124:127], v[44:47], v[200:203]
    v_mfma_f32_16x16x32_bf16 v[168:171], v[128:131], v[36:39], v[168:171]
    v_mfma_f32_16x16x32_bf16 v[204:207], v[128:131], v[44:47], v[204:207]
    v_mfma_f32_16x16x32_bf16 v[172:175], v[132:135], v[36:39], v[172:175]
    v_mfma_f32_16x16x32_bf16 v[208:211], v[132:135], v[44:47], v[208:211]
    v_mfma_f32_16x16x32_bf16 v[176:179], v[136:139], v[36:39], v[176:179]
    v_mfma_f32_16x16x32_bf16 v[212:215], v[136:139], v[44:47], v[212:215]
    v_mfma_f32_16x16x32_bf16 v[180:183], v[140:143], v[36:39], v[180:183]
    v_mfma_f32_16x16x32_bf16 v[216:219], v[140:143], v[44:47], v[216:219]
    v_mfma_f32_16x16x32_bf16 v[184:187], v[144:147], v[36:39], v[184:187]
    v_mfma_f32_16x16x32_bf16 v[220:223], v[144:147], v[44:47], v[220:223]
    v_mfma_f32_16x16x32_bf16 v[188:191], v[148:151], v[36:39], v[188:191]
    v_mfma_f32_16x16x32_bf16 v[224:227], v[148:151], v[44:47], v[224:227]
    s_waitcnt vmcnt(17)
    ds_write_b64 v21, v[80:81] offset:0
    ds_write_b64 v22, v[82:83] offset:0
    ds_write_b64 v23, v[84:85] offset:0
    ds_write_b64 v24, v[86:87] offset:0
    ds_write_b64 v25, v[88:89] offset:0
    ds_write_b64 v26, v[90:91] offset:0
    ds_write_b64 v27, v[92:93] offset:0
    ds_write_b64 v28, v[94:95] offset:0
    ds_write_b64 v29, v[96:97] offset:0
    s_waitcnt lgkmcnt(0)
    s_barrier
    s_add_u32 s29, s28, 884736
    buffer_load_dwordx2 v[80:81], v12, s[12:15], s29 offen
    buffer_load_dwordx2 v[82:83], v13, s[12:15], s29 offen
    buffer_load_dwordx2 v[84:85], v14, s[12:15], s29 offen
    buffer_load_dwordx2 v[86:87], v15, s[12:15], s29 offen
    buffer_load_dwordx2 v[88:89], v16, s[12:15], s29 offen
    buffer_load_dwordx2 v[90:91], v17, s[12:15], s29 offen
    buffer_load_dwordx2 v[92:93], v18, s[12:15], s29 offen
    buffer_load_dwordx2 v[94:95], v19, s[12:15], s29 offen
    buffer_load_dwordx2 v[96:97], v20, s[12:15], s29 offen
    s_add_u32 s30, s27, 1536
    buffer_load_dwordx4 v[32:35], v10, s[8:11], s30 offen offset:0
    buffer_load_dwordx4 v[36:39], v10, s[8:11], s30 offen offset:64
    buffer_load_dwordx4 v[40:43], v11, s[8:11], s30 offen offset:0
    buffer_load_dwordx4 v[44:47], v11, s[8:11], s30 offen offset:64
    ds_read_b64_tr_b16 v[116:117], v30 offset:0
    ds_read_b64_tr_b16 v[118:119], v30 offset:1152
    ds_read_b64_tr_b16 v[120:121], v30 offset:32
    ds_read_b64_tr_b16 v[122:123], v30 offset:1184
    ds_read_b64_tr_b16 v[124:125], v30 offset:64
    ds_read_b64_tr_b16 v[126:127], v30 offset:1216
    ds_read_b64_tr_b16 v[128:129], v30 offset:96
    ds_read_b64_tr_b16 v[130:131], v30 offset:1248
    ds_read_b64_tr_b16 v[132:133], v30 offset:128
    ds_read_b64_tr_b16 v[134:135], v30 offset:1280
    ds_read_b64_tr_b16 v[136:137], v30 offset:160
    ds_read_b64_tr_b16 v[138:139], v30 offset:1312
    ds_read_b64_tr_b16 v[140:141], v30 offset:192
    ds_read_b64_tr_b16 v[142:143], v30 offset:1344
    ds_read_b64_tr_b16 v[144:145], v30 offset:224
    ds_read_b64_tr_b16 v[146:147], v30 offset:1376
    ds_read_b64_tr_b16 v[148:149], v30 offset:256
    ds_read_b64_tr_b16 v[150:151], v30 offset:1408
    s_waitcnt vmcnt(26)
    s_waitcnt lgkmcnt(0)
    v_mfma_f32_16x16x32_bf16 v[156:159], v[116:119], v[48:51], v[156:159]
    v_mfma_f32_16x16x32_bf16 v[192:195], v[116:119], v[56:59], v[192:195]
    v_mfma_f32_16x16x32_bf16 v[160:163], v[120:123], v[48:51], v[160:163]
    v_mfma_f32_16x16x32_bf16 v[196:199], v[120:123], v[56:59], v[196:199]
    v_mfma_f32_16x16x32_bf16 v[164:167], v[124:127], v[48:51], v[164:167]
    v_mfma_f32_16x16x32_bf16 v[200:203], v[124:127], v[56:59], v[200:203]
    v_mfma_f32_16x16x32_bf16 v[168:171], v[128:131], v[48:51], v[168:171]
    v_mfma_f32_16x16x32_bf16 v[204:207], v[128:131], v[56:59], v[204:207]
    v_mfma_f32_16x16x32_bf16 v[172:175], v[132:135], v[48:51], v[172:175]
    v_mfma_f32_16x16x32_bf16 v[208:211], v[132:135], v[56:59], v[208:211]
    v_mfma_f32_16x16x32_bf16 v[176:179], v[136:139], v[48:51], v[176:179]
    v_mfma_f32_16x16x32_bf16 v[212:215], v[136:139], v[56:59], v[212:215]
    v_mfma_f32_16x16x32_bf16 v[180:183], v[140:143], v[48:51], v[180:183]
    v_mfma_f32_16x16x32_bf16 v[216:219], v[140:143], v[56:59], v[216:219]
    v_mfma_f32_16x16x32_bf16 v[184:187], v[144:147], v[48:51], v[184:187]
    v_mfma_f32_16x16x32_bf16 v[220:223], v[144:147], v[56:59], v[220:223]
    v_mfma_f32_16x16x32_bf16 v[188:191], v[148:151], v[48:51], v[188:191]
    v_mfma_f32_16x16x32_bf16 v[224:227], v[148:151], v[56:59], v[224:227]
    ds_read_b64_tr_b16 v[116:117], v30 offset:9728
    ds_read_b64_tr_b16 v[118:119], v30 offset:10880
    ds_read_b64_tr_b16 v[120:121], v30 offset:9760
    ds_read_b64_tr_b16 v[122:123], v30 offset:10912
    ds_read_b64_tr_b16 v[124:125], v30 offset:9792
    ds_read_b64_tr_b16 v[126:127], v30 offset:10944
    ds_read_b64_tr_b16 v[128:129], v30 offset:9824
    ds_read_b64_tr_b16 v[130:131], v30 offset:10976
    ds_read_b64_tr_b16 v[132:133], v30 offset:9856
    ds_read_b64_tr_b16 v[134:135], v30 offset:11008
    ds_read_b64_tr_b16 v[136:137], v30 offset:9888
    ds_read_b64_tr_b16 v[138:139], v30 offset:11040
    ds_read_b64_tr_b16 v[140:141], v30 offset:9920
    ds_read_b64_tr_b16 v[142:143], v30 offset:11072
    ds_read_b64_tr_b16 v[144:145], v30 offset:9952
    ds_read_b64_tr_b16 v[146:147], v30 offset:11104
    ds_read_b64_tr_b16 v[148:149], v30 offset:9984
    ds_read_b64_tr_b16 v[150:151], v30 offset:11136
    s_waitcnt lgkmcnt(0)
    v_mfma_f32_16x16x32_bf16 v[156:159], v[116:119], v[52:55], v[156:159]
    v_mfma_f32_16x16x32_bf16 v[192:195], v[116:119], v[60:63], v[192:195]
    v_mfma_f32_16x16x32_bf16 v[160:163], v[120:123], v[52:55], v[160:163]
    v_mfma_f32_16x16x32_bf16 v[196:199], v[120:123], v[60:63], v[196:199]
    v_mfma_f32_16x16x32_bf16 v[164:167], v[124:127], v[52:55], v[164:167]
    v_mfma_f32_16x16x32_bf16 v[200:203], v[124:127], v[60:63], v[200:203]
    v_mfma_f32_16x16x32_bf16 v[168:171], v[128:131], v[52:55], v[168:171]
    v_mfma_f32_16x16x32_bf16 v[204:207], v[128:131], v[60:63], v[204:207]
    v_mfma_f32_16x16x32_bf16 v[172:175], v[132:135], v[52:55], v[172:175]
    v_mfma_f32_16x16x32_bf16 v[208:211], v[132:135], v[60:63], v[208:211]
    v_mfma_f32_16x16x32_bf16 v[176:179], v[136:139], v[52:55], v[176:179]
    v_mfma_f32_16x16x32_bf16 v[212:215], v[136:139], v[60:63], v[212:215]
    v_mfma_f32_16x16x32_bf16 v[180:183], v[140:143], v[52:55], v[180:183]
    v_mfma_f32_16x16x32_bf16 v[216:219], v[140:143], v[60:63], v[216:219]
    v_mfma_f32_16x16x32_bf16 v[184:187], v[144:147], v[52:55], v[184:187]
    v_mfma_f32_16x16x32_bf16 v[220:223], v[144:147], v[60:63], v[220:223]
    v_mfma_f32_16x16x32_bf16 v[188:191], v[148:151], v[52:55], v[188:191]
    v_mfma_f32_16x16x32_bf16 v[224:227], v[148:151], v[60:63], v[224:227]
    s_waitcnt vmcnt(17)
    ds_write_b64 v21, v[98:99] offset:19456
    ds_write_b64 v22, v[100:101] offset:19456
    ds_write_b64 v23, v[102:103] offset:19456
    ds_write_b64 v24, v[104:105] offset:19456
    ds_write_b64 v25, v[106:107] offset:19456
    ds_write_b64 v26, v[108:109] offset:19456
    ds_write_b64 v27, v[110:111] offset:19456
    ds_write_b64 v28, v[112:113] offset:19456
    ds_write_b64 v29, v[114:115] offset:19456
    s_waitcnt lgkmcnt(0)
    s_barrier
    s_add_u32 s29, s28, 958464
    buffer_load_dwordx2 v[98:99], v12, s[12:15], s29 offen
    buffer_load_dwordx2 v[100:101], v13, s[12:15], s29 offen
    buffer_load_dwordx2 v[102:103], v14, s[12:15], s29 offen
    buffer_load_dwordx2 v[104:105], v15, s[12:15], s29 offen
    buffer_load_dwordx2 v[106:107], v16, s[12:15], s29 offen
    buffer_load_dwordx2 v[108:109], v17, s[12:15], s29 offen
    buffer_load_dwordx2 v[110:111], v18, s[12:15], s29 offen
    buffer_load_dwordx2 v[112:113], v19, s[12:15], s29 offen
    buffer_load_dwordx2 v[114:115], v20, s[12:15], s29 offen
    s_add_u32 s30, s27, 1664
    buffer_load_dwordx4 v[48:51], v10, s[8:11], s30 offen offset:0
    buffer_load_dwordx4 v[52:55], v10, s[8:11], s30 offen offset:64
    buffer_load_dwordx4 v[56:59], v11, s[8:11], s30 offen offset:0
    buffer_load_dwordx4 v[60:63], v11, s[8:11], s30 offen offset:64
    ds_read_b64_tr_b16 v[116:117], v30 offset:19456
    ds_read_b64_tr_b16 v[118:119], v30 offset:20608
    ds_read_b64_tr_b16 v[120:121], v30 offset:19488
    ds_read_b64_tr_b16 v[122:123], v30 offset:20640
    ds_read_b64_tr_b16 v[124:125], v30 offset:19520
    ds_read_b64_tr_b16 v[126:127], v30 offset:20672
    ds_read_b64_tr_b16 v[128:129], v30 offset:19552
    ds_read_b64_tr_b16 v[130:131], v30 offset:20704
    ds_read_b64_tr_b16 v[132:133], v30 offset:19584
    ds_read_b64_tr_b16 v[134:135], v30 offset:20736
    ds_read_b64_tr_b16 v[136:137], v30 offset:19616
    ds_read_b64_tr_b16 v[138:139], v30 offset:20768
    ds_read_b64_tr_b16 v[140:141], v30 offset:19648
    ds_read_b64_tr_b16 v[142:143], v30 offset:20800
    ds_read_b64_tr_b16 v[144:145], v30 offset:19680
    ds_read_b64_tr_b16 v[146:147], v30 offset:20832
    ds_read_b64_tr_b16 v[148:149], v30 offset:19712
    ds_read_b64_tr_b16 v[150:151], v30 offset:20864
    s_waitcnt vmcnt(26)
    s_waitcnt lgkmcnt(0)
    v_mfma_f32_16x16x32_bf16 v[156:159], v[116:119], v[64:67], v[156:159]
    v_mfma_f32_16x16x32_bf16 v[192:195], v[116:119], v[72:75], v[192:195]
    v_mfma_f32_16x16x32_bf16 v[160:163], v[120:123], v[64:67], v[160:163]
    v_mfma_f32_16x16x32_bf16 v[196:199], v[120:123], v[72:75], v[196:199]
    v_mfma_f32_16x16x32_bf16 v[164:167], v[124:127], v[64:67], v[164:167]
    v_mfma_f32_16x16x32_bf16 v[200:203], v[124:127], v[72:75], v[200:203]
    v_mfma_f32_16x16x32_bf16 v[168:171], v[128:131], v[64:67], v[168:171]
    v_mfma_f32_16x16x32_bf16 v[204:207], v[128:131], v[72:75], v[204:207]
    v_mfma_f32_16x16x32_bf16 v[172:175], v[132:135], v[64:67], v[172:175]
    v_mfma_f32_16x16x32_bf16 v[208:211], v[132:135], v[72:75], v[208:211]
    v_mfma_f32_16x16x32_bf16 v[176:179], v[136:139], v[64:67], v[176:179]
    v_mfma_f32_16x16x32_bf16 v[212:215], v[136:139], v[72:75], v[212:215]
    v_mfma_f32_16x16x32_bf16 v[180:183], v[140:143], v[64:67], v[180:183]
    v_mfma_f32_16x16x32_bf16 v[216:219], v[140:143], v[72:75], v[216:219]
    v_mfma_f32_16x16x32_bf16 v[184:187], v[144:147], v[64:67], v[184:187]
    v_mfma_f32_16x16x32_bf16 v[220:223], v[144:147], v[72:75], v[220:223]
    v_mfma_f32_16x16x32_bf16 v[188:191], v[148:151], v[64:67], v[188:191]
    v_mfma_f32_16x16x32_bf16 v[224:227], v[148:151], v[72:75], v[224:227]
    ds_read_b64_tr_b16 v[116:117], v30 offset:29184
    ds_read_b64_tr_b16 v[118:119], v30 offset:30336
    ds_read_b64_tr_b16 v[120:121], v30 offset:29216
    ds_read_b64_tr_b16 v[122:123], v30 offset:30368
    ds_read_b64_tr_b16 v[124:125], v30 offset:29248
    ds_read_b64_tr_b16 v[126:127], v30 offset:30400
    ds_read_b64_tr_b16 v[128:129], v30 offset:29280
    ds_read_b64_tr_b16 v[130:131], v30 offset:30432
    ds_read_b64_tr_b16 v[132:133], v30 offset:29312
    ds_read_b64_tr_b16 v[134:135], v30 offset:30464
    ds_read_b64_tr_b16 v[136:137], v30 offset:29344
    ds_read_b64_tr_b16 v[138:139], v30 offset:30496
    ds_read_b64_tr_b16 v[140:141], v30 offset:29376
    ds_read_b64_tr_b16 v[142:143], v30 offset:30528
    ds_read_b64_tr_b16 v[144:145], v30 offset:29408
    ds_read_b64_tr_b16 v[146:147], v30 offset:30560
    ds_read_b64_tr_b16 v[148:149], v30 offset:29440
    ds_read_b64_tr_b16 v[150:151], v30 offset:30592
    s_waitcnt lgkmcnt(0)
    v_mfma_f32_16x16x32_bf16 v[156:159], v[116:119], v[68:71], v[156:159]
    v_mfma_f32_16x16x32_bf16 v[192:195], v[116:119], v[76:79], v[192:195]
    v_mfma_f32_16x16x32_bf16 v[160:163], v[120:123], v[68:71], v[160:163]
    v_mfma_f32_16x16x32_bf16 v[196:199], v[120:123], v[76:79], v[196:199]
    v_mfma_f32_16x16x32_bf16 v[164:167], v[124:127], v[68:71], v[164:167]
    v_mfma_f32_16x16x32_bf16 v[200:203], v[124:127], v[76:79], v[200:203]
    v_mfma_f32_16x16x32_bf16 v[168:171], v[128:131], v[68:71], v[168:171]
    v_mfma_f32_16x16x32_bf16 v[204:207], v[128:131], v[76:79], v[204:207]
    v_mfma_f32_16x16x32_bf16 v[172:175], v[132:135], v[68:71], v[172:175]
    v_mfma_f32_16x16x32_bf16 v[208:211], v[132:135], v[76:79], v[208:211]
    v_mfma_f32_16x16x32_bf16 v[176:179], v[136:139], v[68:71], v[176:179]
    v_mfma_f32_16x16x32_bf16 v[212:215], v[136:139], v[76:79], v[212:215]
    v_mfma_f32_16x16x32_bf16 v[180:183], v[140:143], v[68:71], v[180:183]
    v_mfma_f32_16x16x32_bf16 v[216:219], v[140:143], v[76:79], v[216:219]
    v_mfma_f32_16x16x32_bf16 v[184:187], v[144:147], v[68:71], v[184:187]
    v_mfma_f32_16x16x32_bf16 v[220:223], v[144:147], v[76:79], v[220:223]
    v_mfma_f32_16x16x32_bf16 v[188:191], v[148:151], v[68:71], v[188:191]
    v_mfma_f32_16x16x32_bf16 v[224:227], v[148:151], v[76:79], v[224:227]
    s_waitcnt vmcnt(17)
    ds_write_b64 v21, v[80:81] offset:0
    ds_write_b64 v22, v[82:83] offset:0
    ds_write_b64 v23, v[84:85] offset:0
    ds_write_b64 v24, v[86:87] offset:0
    ds_write_b64 v25, v[88:89] offset:0
    ds_write_b64 v26, v[90:91] offset:0
    ds_write_b64 v27, v[92:93] offset:0
    ds_write_b64 v28, v[94:95] offset:0
    ds_write_b64 v29, v[96:97] offset:0
    s_waitcnt lgkmcnt(0)
    s_barrier
    s_add_u32 s29, s28, 1032192
    buffer_load_dwordx2 v[80:81], v12, s[12:15], s29 offen
    buffer_load_dwordx2 v[82:83], v13, s[12:15], s29 offen
    buffer_load_dwordx2 v[84:85], v14, s[12:15], s29 offen
    buffer_load_dwordx2 v[86:87], v15, s[12:15], s29 offen
    buffer_load_dwordx2 v[88:89], v16, s[12:15], s29 offen
    buffer_load_dwordx2 v[90:91], v17, s[12:15], s29 offen
    buffer_load_dwordx2 v[92:93], v18, s[12:15], s29 offen
    buffer_load_dwordx2 v[94:95], v19, s[12:15], s29 offen
    buffer_load_dwordx2 v[96:97], v20, s[12:15], s29 offen
    s_add_u32 s30, s27, 1792
    buffer_load_dwordx4 v[64:67], v10, s[8:11], s30 offen offset:0
    buffer_load_dwordx4 v[68:71], v10, s[8:11], s30 offen offset:64
    buffer_load_dwordx4 v[72:75], v11, s[8:11], s30 offen offset:0
    buffer_load_dwordx4 v[76:79], v11, s[8:11], s30 offen offset:64
    ds_read_b64_tr_b16 v[116:117], v30 offset:0
    ds_read_b64_tr_b16 v[118:119], v30 offset:1152
    ds_read_b64_tr_b16 v[120:121], v30 offset:32
    ds_read_b64_tr_b16 v[122:123], v30 offset:1184
    ds_read_b64_tr_b16 v[124:125], v30 offset:64
    ds_read_b64_tr_b16 v[126:127], v30 offset:1216
    ds_read_b64_tr_b16 v[128:129], v30 offset:96
    ds_read_b64_tr_b16 v[130:131], v30 offset:1248
    ds_read_b64_tr_b16 v[132:133], v30 offset:128
    ds_read_b64_tr_b16 v[134:135], v30 offset:1280
    ds_read_b64_tr_b16 v[136:137], v30 offset:160
    ds_read_b64_tr_b16 v[138:139], v30 offset:1312
    ds_read_b64_tr_b16 v[140:141], v30 offset:192
    ds_read_b64_tr_b16 v[142:143], v30 offset:1344
    ds_read_b64_tr_b16 v[144:145], v30 offset:224
    ds_read_b64_tr_b16 v[146:147], v30 offset:1376
    ds_read_b64_tr_b16 v[148:149], v30 offset:256
    ds_read_b64_tr_b16 v[150:151], v30 offset:1408
    s_waitcnt vmcnt(26)
    s_waitcnt lgkmcnt(0)
    v_mfma_f32_16x16x32_bf16 v[156:159], v[116:119], v[32:35], v[156:159]
    v_mfma_f32_16x16x32_bf16 v[192:195], v[116:119], v[40:43], v[192:195]
    v_mfma_f32_16x16x32_bf16 v[160:163], v[120:123], v[32:35], v[160:163]
    v_mfma_f32_16x16x32_bf16 v[196:199], v[120:123], v[40:43], v[196:199]
    v_mfma_f32_16x16x32_bf16 v[164:167], v[124:127], v[32:35], v[164:167]
    v_mfma_f32_16x16x32_bf16 v[200:203], v[124:127], v[40:43], v[200:203]
    v_mfma_f32_16x16x32_bf16 v[168:171], v[128:131], v[32:35], v[168:171]
    v_mfma_f32_16x16x32_bf16 v[204:207], v[128:131], v[40:43], v[204:207]
    v_mfma_f32_16x16x32_bf16 v[172:175], v[132:135], v[32:35], v[172:175]
    v_mfma_f32_16x16x32_bf16 v[208:211], v[132:135], v[40:43], v[208:211]
    v_mfma_f32_16x16x32_bf16 v[176:179], v[136:139], v[32:35], v[176:179]
    v_mfma_f32_16x16x32_bf16 v[212:215], v[136:139], v[40:43], v[212:215]
    v_mfma_f32_16x16x32_bf16 v[180:183], v[140:143], v[32:35], v[180:183]
    v_mfma_f32_16x16x32_bf16 v[216:219], v[140:143], v[40:43], v[216:219]
    v_mfma_f32_16x16x32_bf16 v[184:187], v[144:147], v[32:35], v[184:187]
    v_mfma_f32_16x16x32_bf16 v[220:223], v[144:147], v[40:43], v[220:223]
    v_mfma_f32_16x16x32_bf16 v[188:191], v[148:151], v[32:35], v[188:191]
    v_mfma_f32_16x16x32_bf16 v[224:227], v[148:151], v[40:43], v[224:227]
    ds_read_b64_tr_b16 v[116:117], v30 offset:9728
    ds_read_b64_tr_b16 v[118:119], v30 offset:10880
    ds_read_b64_tr_b16 v[120:121], v30 offset:9760
    ds_read_b64_tr_b16 v[122:123], v30 offset:10912
    ds_read_b64_tr_b16 v[124:125], v30 offset:9792
    ds_read_b64_tr_b16 v[126:127], v30 offset:10944
    ds_read_b64_tr_b16 v[128:129], v30 offset:9824
    ds_read_b64_tr_b16 v[130:131], v30 offset:10976
    ds_read_b64_tr_b16 v[132:133], v30 offset:9856
    ds_read_b64_tr_b16 v[134:135], v30 offset:11008
    ds_read_b64_tr_b16 v[136:137], v30 offset:9888
    ds_read_b64_tr_b16 v[138:139], v30 offset:11040
    ds_read_b64_tr_b16 v[140:141], v30 offset:9920
    ds_read_b64_tr_b16 v[142:143], v30 offset:11072
    ds_read_b64_tr_b16 v[144:145], v30 offset:9952
    ds_read_b64_tr_b16 v[146:147], v30 offset:11104
    ds_read_b64_tr_b16 v[148:149], v30 offset:9984
    ds_read_b64_tr_b16 v[150:151], v30 offset:11136
    s_waitcnt lgkmcnt(0)
    v_mfma_f32_16x16x32_bf16 v[156:159], v[116:119], v[36:39], v[156:159]
    v_mfma_f32_16x16x32_bf16 v[192:195], v[116:119], v[44:47], v[192:195]
    v_mfma_f32_16x16x32_bf16 v[160:163], v[120:123], v[36:39], v[160:163]
    v_mfma_f32_16x16x32_bf16 v[196:199], v[120:123], v[44:47], v[196:199]
    v_mfma_f32_16x16x32_bf16 v[164:167], v[124:127], v[36:39], v[164:167]
    v_mfma_f32_16x16x32_bf16 v[200:203], v[124:127], v[44:47], v[200:203]
    v_mfma_f32_16x16x32_bf16 v[168:171], v[128:131], v[36:39], v[168:171]
    v_mfma_f32_16x16x32_bf16 v[204:207], v[128:131], v[44:47], v[204:207]
    v_mfma_f32_16x16x32_bf16 v[172:175], v[132:135], v[36:39], v[172:175]
    v_mfma_f32_16x16x32_bf16 v[208:211], v[132:135], v[44:47], v[208:211]
    v_mfma_f32_16x16x32_bf16 v[176:179], v[136:139], v[36:39], v[176:179]
    v_mfma_f32_16x16x32_bf16 v[212:215], v[136:139], v[44:47], v[212:215]
    v_mfma_f32_16x16x32_bf16 v[180:183], v[140:143], v[36:39], v[180:183]
    v_mfma_f32_16x16x32_bf16 v[216:219], v[140:143], v[44:47], v[216:219]
    v_mfma_f32_16x16x32_bf16 v[184:187], v[144:147], v[36:39], v[184:187]
    v_mfma_f32_16x16x32_bf16 v[220:223], v[144:147], v[44:47], v[220:223]
    v_mfma_f32_16x16x32_bf16 v[188:191], v[148:151], v[36:39], v[188:191]
    v_mfma_f32_16x16x32_bf16 v[224:227], v[148:151], v[44:47], v[224:227]
    s_waitcnt vmcnt(17)
    ds_write_b64 v21, v[98:99] offset:19456
    ds_write_b64 v22, v[100:101] offset:19456
    ds_write_b64 v23, v[102:103] offset:19456
    ds_write_b64 v24, v[104:105] offset:19456
    ds_write_b64 v25, v[106:107] offset:19456
    ds_write_b64 v26, v[108:109] offset:19456
    ds_write_b64 v27, v[110:111] offset:19456
    ds_write_b64 v28, v[112:113] offset:19456
    ds_write_b64 v29, v[114:115] offset:19456
    s_waitcnt lgkmcnt(0)
    s_barrier
    s_add_u32 s29, s28, 1105920
    buffer_load_dwordx2 v[98:99], v12, s[12:15], s29 offen
    buffer_load_dwordx2 v[100:101], v13, s[12:15], s29 offen
    buffer_load_dwordx2 v[102:103], v14, s[12:15], s29 offen
    buffer_load_dwordx2 v[104:105], v15, s[12:15], s29 offen
    buffer_load_dwordx2 v[106:107], v16, s[12:15], s29 offen
    buffer_load_dwordx2 v[108:109], v17, s[12:15], s29 offen
    buffer_load_dwordx2 v[110:111], v18, s[12:15], s29 offen
    buffer_load_dwordx2 v[112:113], v19, s[12:15], s29 offen
    buffer_load_dwordx2 v[114:115], v20, s[12:15], s29 offen
    s_add_u32 s30, s27, 1920
    buffer_load_dwordx4 v[32:35], v10, s[8:11], s30 offen offset:0
    buffer_load_dwordx4 v[36:39], v10, s[8:11], s30 offen offset:64
    buffer_load_dwordx4 v[40:43], v11, s[8:11], s30 offen offset:0
    buffer_load_dwordx4 v[44:47], v11, s[8:11], s30 offen offset:64
    ds_read_b64_tr_b16 v[116:117], v30 offset:19456
    ds_read_b64_tr_b16 v[118:119], v30 offset:20608
    ds_read_b64_tr_b16 v[120:121], v30 offset:19488
    ds_read_b64_tr_b16 v[122:123], v30 offset:20640
    ds_read_b64_tr_b16 v[124:125], v30 offset:19520
    ds_read_b64_tr_b16 v[126:127], v30 offset:20672
    ds_read_b64_tr_b16 v[128:129], v30 offset:19552
    ds_read_b64_tr_b16 v[130:131], v30 offset:20704
    ds_read_b64_tr_b16 v[132:133], v30 offset:19584
    ds_read_b64_tr_b16 v[134:135], v30 offset:20736
    ds_read_b64_tr_b16 v[136:137], v30 offset:19616
    ds_read_b64_tr_b16 v[138:139], v30 offset:20768
    ds_read_b64_tr_b16 v[140:141], v30 offset:19648
    ds_read_b64_tr_b16 v[142:143], v30 offset:20800
    ds_read_b64_tr_b16 v[144:145], v30 offset:19680
    ds_read_b64_tr_b16 v[146:147], v30 offset:20832
    ds_read_b64_tr_b16 v[148:149], v30 offset:19712
    ds_read_b64_tr_b16 v[150:151], v30 offset:20864
    s_waitcnt vmcnt(26)
    s_waitcnt lgkmcnt(0)
    v_mfma_f32_16x16x32_bf16 v[156:159], v[116:119], v[48:51], v[156:159]
    v_mfma_f32_16x16x32_bf16 v[192:195], v[116:119], v[56:59], v[192:195]
    v_mfma_f32_16x16x32_bf16 v[160:163], v[120:123], v[48:51], v[160:163]
    v_mfma_f32_16x16x32_bf16 v[196:199], v[120:123], v[56:59], v[196:199]
    v_mfma_f32_16x16x32_bf16 v[164:167], v[124:127], v[48:51], v[164:167]
    v_mfma_f32_16x16x32_bf16 v[200:203], v[124:127], v[56:59], v[200:203]
    v_mfma_f32_16x16x32_bf16 v[168:171], v[128:131], v[48:51], v[168:171]
    v_mfma_f32_16x16x32_bf16 v[204:207], v[128:131], v[56:59], v[204:207]
    v_mfma_f32_16x16x32_bf16 v[172:175], v[132:135], v[48:51], v[172:175]
    v_mfma_f32_16x16x32_bf16 v[208:211], v[132:135], v[56:59], v[208:211]
    v_mfma_f32_16x16x32_bf16 v[176:179], v[136:139], v[48:51], v[176:179]
    v_mfma_f32_16x16x32_bf16 v[212:215], v[136:139], v[56:59], v[212:215]
    v_mfma_f32_16x16x32_bf16 v[180:183], v[140:143], v[48:51], v[180:183]
    v_mfma_f32_16x16x32_bf16 v[216:219], v[140:143], v[56:59], v[216:219]
    v_mfma_f32_16x16x32_bf16 v[184:187], v[144:147], v[48:51], v[184:187]
    v_mfma_f32_16x16x32_bf16 v[220:223], v[144:147], v[56:59], v[220:223]
    v_mfma_f32_16x16x32_bf16 v[188:191], v[148:151], v[48:51], v[188:191]
    v_mfma_f32_16x16x32_bf16 v[224:227], v[148:151], v[56:59], v[224:227]
    ds_read_b64_tr_b16 v[116:117], v30 offset:29184
    ds_read_b64_tr_b16 v[118:119], v30 offset:30336
    ds_read_b64_tr_b16 v[120:121], v30 offset:29216
    ds_read_b64_tr_b16 v[122:123], v30 offset:30368
    ds_read_b64_tr_b16 v[124:125], v30 offset:29248
    ds_read_b64_tr_b16 v[126:127], v30 offset:30400
    ds_read_b64_tr_b16 v[128:129], v30 offset:29280
    ds_read_b64_tr_b16 v[130:131], v30 offset:30432
    ds_read_b64_tr_b16 v[132:133], v30 offset:29312
    ds_read_b64_tr_b16 v[134:135], v30 offset:30464
    ds_read_b64_tr_b16 v[136:137], v30 offset:29344
    ds_read_b64_tr_b16 v[138:139], v30 offset:30496
    ds_read_b64_tr_b16 v[140:141], v30 offset:29376
    ds_read_b64_tr_b16 v[142:143], v30 offset:30528
    ds_read_b64_tr_b16 v[144:145], v30 offset:29408
    ds_read_b64_tr_b16 v[146:147], v30 offset:30560
    ds_read_b64_tr_b16 v[148:149], v30 offset:29440
    ds_read_b64_tr_b16 v[150:151], v30 offset:30592
    s_waitcnt lgkmcnt(0)
    v_mfma_f32_16x16x32_bf16 v[156:159], v[116:119], v[52:55], v[156:159]
    v_mfma_f32_16x16x32_bf16 v[192:195], v[116:119], v[60:63], v[192:195]
    v_mfma_f32_16x16x32_bf16 v[160:163], v[120:123], v[52:55], v[160:163]
    v_mfma_f32_16x16x32_bf16 v[196:199], v[120:123], v[60:63], v[196:199]
    v_mfma_f32_16x16x32_bf16 v[164:167], v[124:127], v[52:55], v[164:167]
    v_mfma_f32_16x16x32_bf16 v[200:203], v[124:127], v[60:63], v[200:203]
    v_mfma_f32_16x16x32_bf16 v[168:171], v[128:131], v[52:55], v[168:171]
    v_mfma_f32_16x16x32_bf16 v[204:207], v[128:131], v[60:63], v[204:207]
    v_mfma_f32_16x16x32_bf16 v[172:175], v[132:135], v[52:55], v[172:175]
    v_mfma_f32_16x16x32_bf16 v[208:211], v[132:135], v[60:63], v[208:211]
    v_mfma_f32_16x16x32_bf16 v[176:179], v[136:139], v[52:55], v[176:179]
    v_mfma_f32_16x16x32_bf16 v[212:215], v[136:139], v[60:63], v[212:215]
    v_mfma_f32_16x16x32_bf16 v[180:183], v[140:143], v[52:55], v[180:183]
    v_mfma_f32_16x16x32_bf16 v[216:219], v[140:143], v[60:63], v[216:219]
    v_mfma_f32_16x16x32_bf16 v[184:187], v[144:147], v[52:55], v[184:187]
    v_mfma_f32_16x16x32_bf16 v[220:223], v[144:147], v[60:63], v[220:223]
    v_mfma_f32_16x16x32_bf16 v[188:191], v[148:151], v[52:55], v[188:191]
    v_mfma_f32_16x16x32_bf16 v[224:227], v[148:151], v[60:63], v[224:227]
    s_waitcnt vmcnt(17)
    ds_write_b64 v21, v[80:81] offset:0
    ds_write_b64 v22, v[82:83] offset:0
    ds_write_b64 v23, v[84:85] offset:0
    ds_write_b64 v24, v[86:87] offset:0
    ds_write_b64 v25, v[88:89] offset:0
    ds_write_b64 v26, v[90:91] offset:0
    ds_write_b64 v27, v[92:93] offset:0
    ds_write_b64 v28, v[94:95] offset:0
    ds_write_b64 v29, v[96:97] offset:0
    s_waitcnt lgkmcnt(0)
    s_barrier
    s_add_u32 s29, s28, 1179648
    buffer_load_dwordx2 v[80:81], v12, s[12:15], s29 offen
    buffer_load_dwordx2 v[82:83], v13, s[12:15], s29 offen
    buffer_load_dwordx2 v[84:85], v14, s[12:15], s29 offen
    buffer_load_dwordx2 v[86:87], v15, s[12:15], s29 offen
    buffer_load_dwordx2 v[88:89], v16, s[12:15], s29 offen
    buffer_load_dwordx2 v[90:91], v17, s[12:15], s29 offen
    buffer_load_dwordx2 v[92:93], v18, s[12:15], s29 offen
    buffer_load_dwordx2 v[94:95], v19, s[12:15], s29 offen
    buffer_load_dwordx2 v[96:97], v20, s[12:15], s29 offen
    s_add_u32 s30, s27, 2048
    buffer_load_dwordx4 v[48:51], v10, s[8:11], s30 offen offset:0
    buffer_load_dwordx4 v[52:55], v10, s[8:11], s30 offen offset:64
    buffer_load_dwordx4 v[56:59], v11, s[8:11], s30 offen offset:0
    buffer_load_dwordx4 v[60:63], v11, s[8:11], s30 offen offset:64
    ds_read_b64_tr_b16 v[116:117], v30 offset:0
    ds_read_b64_tr_b16 v[118:119], v30 offset:1152
    ds_read_b64_tr_b16 v[120:121], v30 offset:32
    ds_read_b64_tr_b16 v[122:123], v30 offset:1184
    ds_read_b64_tr_b16 v[124:125], v30 offset:64
    ds_read_b64_tr_b16 v[126:127], v30 offset:1216
    ds_read_b64_tr_b16 v[128:129], v30 offset:96
    ds_read_b64_tr_b16 v[130:131], v30 offset:1248
    ds_read_b64_tr_b16 v[132:133], v30 offset:128
    ds_read_b64_tr_b16 v[134:135], v30 offset:1280
    ds_read_b64_tr_b16 v[136:137], v30 offset:160
    ds_read_b64_tr_b16 v[138:139], v30 offset:1312
    ds_read_b64_tr_b16 v[140:141], v30 offset:192
    ds_read_b64_tr_b16 v[142:143], v30 offset:1344
    ds_read_b64_tr_b16 v[144:145], v30 offset:224
    ds_read_b64_tr_b16 v[146:147], v30 offset:1376
    ds_read_b64_tr_b16 v[148:149], v30 offset:256
    ds_read_b64_tr_b16 v[150:151], v30 offset:1408
    s_waitcnt vmcnt(26)
    s_waitcnt lgkmcnt(0)
    v_mfma_f32_16x16x32_bf16 v[156:159], v[116:119], v[64:67], v[156:159]
    v_mfma_f32_16x16x32_bf16 v[192:195], v[116:119], v[72:75], v[192:195]
    v_mfma_f32_16x16x32_bf16 v[160:163], v[120:123], v[64:67], v[160:163]
    v_mfma_f32_16x16x32_bf16 v[196:199], v[120:123], v[72:75], v[196:199]
    v_mfma_f32_16x16x32_bf16 v[164:167], v[124:127], v[64:67], v[164:167]
    v_mfma_f32_16x16x32_bf16 v[200:203], v[124:127], v[72:75], v[200:203]
    v_mfma_f32_16x16x32_bf16 v[168:171], v[128:131], v[64:67], v[168:171]
    v_mfma_f32_16x16x32_bf16 v[204:207], v[128:131], v[72:75], v[204:207]
    v_mfma_f32_16x16x32_bf16 v[172:175], v[132:135], v[64:67], v[172:175]
    v_mfma_f32_16x16x32_bf16 v[208:211], v[132:135], v[72:75], v[208:211]
    v_mfma_f32_16x16x32_bf16 v[176:179], v[136:139], v[64:67], v[176:179]
    v_mfma_f32_16x16x32_bf16 v[212:215], v[136:139], v[72:75], v[212:215]
    v_mfma_f32_16x16x32_bf16 v[180:183], v[140:143], v[64:67], v[180:183]
    v_mfma_f32_16x16x32_bf16 v[216:219], v[140:143], v[72:75], v[216:219]
    v_mfma_f32_16x16x32_bf16 v[184:187], v[144:147], v[64:67], v[184:187]
    v_mfma_f32_16x16x32_bf16 v[220:223], v[144:147], v[72:75], v[220:223]
    v_mfma_f32_16x16x32_bf16 v[188:191], v[148:151], v[64:67], v[188:191]
    v_mfma_f32_16x16x32_bf16 v[224:227], v[148:151], v[72:75], v[224:227]
    ds_read_b64_tr_b16 v[116:117], v30 offset:9728
    ds_read_b64_tr_b16 v[118:119], v30 offset:10880
    ds_read_b64_tr_b16 v[120:121], v30 offset:9760
    ds_read_b64_tr_b16 v[122:123], v30 offset:10912
    ds_read_b64_tr_b16 v[124:125], v30 offset:9792
    ds_read_b64_tr_b16 v[126:127], v30 offset:10944
    ds_read_b64_tr_b16 v[128:129], v30 offset:9824
    ds_read_b64_tr_b16 v[130:131], v30 offset:10976
    ds_read_b64_tr_b16 v[132:133], v30 offset:9856
    ds_read_b64_tr_b16 v[134:135], v30 offset:11008
    ds_read_b64_tr_b16 v[136:137], v30 offset:9888
    ds_read_b64_tr_b16 v[138:139], v30 offset:11040
    ds_read_b64_tr_b16 v[140:141], v30 offset:9920
    ds_read_b64_tr_b16 v[142:143], v30 offset:11072
    ds_read_b64_tr_b16 v[144:145], v30 offset:9952
    ds_read_b64_tr_b16 v[146:147], v30 offset:11104
    ds_read_b64_tr_b16 v[148:149], v30 offset:9984
    ds_read_b64_tr_b16 v[150:151], v30 offset:11136
    s_waitcnt lgkmcnt(0)
    v_mfma_f32_16x16x32_bf16 v[156:159], v[116:119], v[68:71], v[156:159]
    v_mfma_f32_16x16x32_bf16 v[192:195], v[116:119], v[76:79], v[192:195]
    v_mfma_f32_16x16x32_bf16 v[160:163], v[120:123], v[68:71], v[160:163]
    v_mfma_f32_16x16x32_bf16 v[196:199], v[120:123], v[76:79], v[196:199]
    v_mfma_f32_16x16x32_bf16 v[164:167], v[124:127], v[68:71], v[164:167]
    v_mfma_f32_16x16x32_bf16 v[200:203], v[124:127], v[76:79], v[200:203]
    v_mfma_f32_16x16x32_bf16 v[168:171], v[128:131], v[68:71], v[168:171]
    v_mfma_f32_16x16x32_bf16 v[204:207], v[128:131], v[76:79], v[204:207]
    v_mfma_f32_16x16x32_bf16 v[172:175], v[132:135], v[68:71], v[172:175]
    v_mfma_f32_16x16x32_bf16 v[208:211], v[132:135], v[76:79], v[208:211]
    v_mfma_f32_16x16x32_bf16 v[176:179], v[136:139], v[68:71], v[176:179]
    v_mfma_f32_16x16x32_bf16 v[212:215], v[136:139], v[76:79], v[212:215]
    v_mfma_f32_16x16x32_bf16 v[180:183], v[140:143], v[68:71], v[180:183]
    v_mfma_f32_16x16x32_bf16 v[216:219], v[140:143], v[76:79], v[216:219]
    v_mfma_f32_16x16x32_bf16 v[184:187], v[144:147], v[68:71], v[184:187]
    v_mfma_f32_16x16x32_bf16 v[220:223], v[144:147], v[76:79], v[220:223]
    v_mfma_f32_16x16x32_bf16 v[188:191], v[148:151], v[68:71], v[188:191]
    v_mfma_f32_16x16x32_bf16 v[224:227], v[148:151], v[76:79], v[224:227]
    s_waitcnt vmcnt(17)
    ds_write_b64 v21, v[98:99] offset:19456
    ds_write_b64 v22, v[100:101] offset:19456
    ds_write_b64 v23, v[102:103] offset:19456
    ds_write_b64 v24, v[104:105] offset:19456
    ds_write_b64 v25, v[106:107] offset:19456
    ds_write_b64 v26, v[108:109] offset:19456
    ds_write_b64 v27, v[110:111] offset:19456
    ds_write_b64 v28, v[112:113] offset:19456
    ds_write_b64 v29, v[114:115] offset:19456
    s_waitcnt lgkmcnt(0)
    s_barrier
    s_add_u32 s29, s28, 1253376
    buffer_load_dwordx2 v[98:99], v12, s[12:15], s29 offen
    buffer_load_dwordx2 v[100:101], v13, s[12:15], s29 offen
    buffer_load_dwordx2 v[102:103], v14, s[12:15], s29 offen
    buffer_load_dwordx2 v[104:105], v15, s[12:15], s29 offen
    buffer_load_dwordx2 v[106:107], v16, s[12:15], s29 offen
    buffer_load_dwordx2 v[108:109], v17, s[12:15], s29 offen
    buffer_load_dwordx2 v[110:111], v18, s[12:15], s29 offen
    buffer_load_dwordx2 v[112:113], v19, s[12:15], s29 offen
    buffer_load_dwordx2 v[114:115], v20, s[12:15], s29 offen
    s_add_u32 s30, s27, 2176
    buffer_load_dwordx4 v[64:67], v10, s[8:11], s30 offen offset:0
    buffer_load_dwordx4 v[68:71], v10, s[8:11], s30 offen offset:64
    buffer_load_dwordx4 v[72:75], v11, s[8:11], s30 offen offset:0
    buffer_load_dwordx4 v[76:79], v11, s[8:11], s30 offen offset:64
    ds_read_b64_tr_b16 v[116:117], v30 offset:19456
    ds_read_b64_tr_b16 v[118:119], v30 offset:20608
    ds_read_b64_tr_b16 v[120:121], v30 offset:19488
    ds_read_b64_tr_b16 v[122:123], v30 offset:20640
    ds_read_b64_tr_b16 v[124:125], v30 offset:19520
    ds_read_b64_tr_b16 v[126:127], v30 offset:20672
    ds_read_b64_tr_b16 v[128:129], v30 offset:19552
    ds_read_b64_tr_b16 v[130:131], v30 offset:20704
    ds_read_b64_tr_b16 v[132:133], v30 offset:19584
    ds_read_b64_tr_b16 v[134:135], v30 offset:20736
    ds_read_b64_tr_b16 v[136:137], v30 offset:19616
    ds_read_b64_tr_b16 v[138:139], v30 offset:20768
    ds_read_b64_tr_b16 v[140:141], v30 offset:19648
    ds_read_b64_tr_b16 v[142:143], v30 offset:20800
    ds_read_b64_tr_b16 v[144:145], v30 offset:19680
    ds_read_b64_tr_b16 v[146:147], v30 offset:20832
    ds_read_b64_tr_b16 v[148:149], v30 offset:19712
    ds_read_b64_tr_b16 v[150:151], v30 offset:20864
    s_waitcnt vmcnt(26)
    s_waitcnt lgkmcnt(0)
    v_mfma_f32_16x16x32_bf16 v[156:159], v[116:119], v[32:35], v[156:159]
    v_mfma_f32_16x16x32_bf16 v[192:195], v[116:119], v[40:43], v[192:195]
    v_mfma_f32_16x16x32_bf16 v[160:163], v[120:123], v[32:35], v[160:163]
    v_mfma_f32_16x16x32_bf16 v[196:199], v[120:123], v[40:43], v[196:199]
    v_mfma_f32_16x16x32_bf16 v[164:167], v[124:127], v[32:35], v[164:167]
    v_mfma_f32_16x16x32_bf16 v[200:203], v[124:127], v[40:43], v[200:203]
    v_mfma_f32_16x16x32_bf16 v[168:171], v[128:131], v[32:35], v[168:171]
    v_mfma_f32_16x16x32_bf16 v[204:207], v[128:131], v[40:43], v[204:207]
    v_mfma_f32_16x16x32_bf16 v[172:175], v[132:135], v[32:35], v[172:175]
    v_mfma_f32_16x16x32_bf16 v[208:211], v[132:135], v[40:43], v[208:211]
    v_mfma_f32_16x16x32_bf16 v[176:179], v[136:139], v[32:35], v[176:179]
    v_mfma_f32_16x16x32_bf16 v[212:215], v[136:139], v[40:43], v[212:215]
    v_mfma_f32_16x16x32_bf16 v[180:183], v[140:143], v[32:35], v[180:183]
    v_mfma_f32_16x16x32_bf16 v[216:219], v[140:143], v[40:43], v[216:219]
    v_mfma_f32_16x16x32_bf16 v[184:187], v[144:147], v[32:35], v[184:187]
    v_mfma_f32_16x16x32_bf16 v[220:223], v[144:147], v[40:43], v[220:223]
    v_mfma_f32_16x16x32_bf16 v[188:191], v[148:151], v[32:35], v[188:191]
    v_mfma_f32_16x16x32_bf16 v[224:227], v[148:151], v[40:43], v[224:227]
    ds_read_b64_tr_b16 v[116:117], v30 offset:29184
    ds_read_b64_tr_b16 v[118:119], v30 offset:30336
    ds_read_b64_tr_b16 v[120:121], v30 offset:29216
    ds_read_b64_tr_b16 v[122:123], v30 offset:30368
    ds_read_b64_tr_b16 v[124:125], v30 offset:29248
    ds_read_b64_tr_b16 v[126:127], v30 offset:30400
    ds_read_b64_tr_b16 v[128:129], v30 offset:29280
    ds_read_b64_tr_b16 v[130:131], v30 offset:30432
    ds_read_b64_tr_b16 v[132:133], v30 offset:29312
    ds_read_b64_tr_b16 v[134:135], v30 offset:30464
    ds_read_b64_tr_b16 v[136:137], v30 offset:29344
    ds_read_b64_tr_b16 v[138:139], v30 offset:30496
    ds_read_b64_tr_b16 v[140:141], v30 offset:29376
    ds_read_b64_tr_b16 v[142:143], v30 offset:30528
    ds_read_b64_tr_b16 v[144:145], v30 offset:29408
    ds_read_b64_tr_b16 v[146:147], v30 offset:30560
    ds_read_b64_tr_b16 v[148:149], v30 offset:29440
    ds_read_b64_tr_b16 v[150:151], v30 offset:30592
    s_waitcnt lgkmcnt(0)
    v_mfma_f32_16x16x32_bf16 v[156:159], v[116:119], v[36:39], v[156:159]
    v_mfma_f32_16x16x32_bf16 v[192:195], v[116:119], v[44:47], v[192:195]
    v_mfma_f32_16x16x32_bf16 v[160:163], v[120:123], v[36:39], v[160:163]
    v_mfma_f32_16x16x32_bf16 v[196:199], v[120:123], v[44:47], v[196:199]
    v_mfma_f32_16x16x32_bf16 v[164:167], v[124:127], v[36:39], v[164:167]
    v_mfma_f32_16x16x32_bf16 v[200:203], v[124:127], v[44:47], v[200:203]
    v_mfma_f32_16x16x32_bf16 v[168:171], v[128:131], v[36:39], v[168:171]
    v_mfma_f32_16x16x32_bf16 v[204:207], v[128:131], v[44:47], v[204:207]
    v_mfma_f32_16x16x32_bf16 v[172:175], v[132:135], v[36:39], v[172:175]
    v_mfma_f32_16x16x32_bf16 v[208:211], v[132:135], v[44:47], v[208:211]
    v_mfma_f32_16x16x32_bf16 v[176:179], v[136:139], v[36:39], v[176:179]
    v_mfma_f32_16x16x32_bf16 v[212:215], v[136:139], v[44:47], v[212:215]
    v_mfma_f32_16x16x32_bf16 v[180:183], v[140:143], v[36:39], v[180:183]
    v_mfma_f32_16x16x32_bf16 v[216:219], v[140:143], v[44:47], v[216:219]
    v_mfma_f32_16x16x32_bf16 v[184:187], v[144:147], v[36:39], v[184:187]
    v_mfma_f32_16x16x32_bf16 v[220:223], v[144:147], v[44:47], v[220:223]
    v_mfma_f32_16x16x32_bf16 v[188:191], v[148:151], v[36:39], v[188:191]
    v_mfma_f32_16x16x32_bf16 v[224:227], v[148:151], v[44:47], v[224:227]
    s_waitcnt vmcnt(17)
    ds_write_b64 v21, v[80:81] offset:0
    ds_write_b64 v22, v[82:83] offset:0
    ds_write_b64 v23, v[84:85] offset:0
    ds_write_b64 v24, v[86:87] offset:0
    ds_write_b64 v25, v[88:89] offset:0
    ds_write_b64 v26, v[90:91] offset:0
    ds_write_b64 v27, v[92:93] offset:0
    ds_write_b64 v28, v[94:95] offset:0
    ds_write_b64 v29, v[96:97] offset:0
    s_waitcnt lgkmcnt(0)
    s_barrier
    ds_read_b64_tr_b16 v[116:117], v30 offset:0
    ds_read_b64_tr_b16 v[118:119], v30 offset:1152
    ds_read_b64_tr_b16 v[120:121], v30 offset:32
    ds_read_b64_tr_b16 v[122:123], v30 offset:1184
    ds_read_b64_tr_b16 v[124:125], v30 offset:64
    ds_read_b64_tr_b16 v[126:127], v30 offset:1216
    ds_read_b64_tr_b16 v[128:129], v30 offset:96
    ds_read_b64_tr_b16 v[130:131], v30 offset:1248
    ds_read_b64_tr_b16 v[132:133], v30 offset:128
    ds_read_b64_tr_b16 v[134:135], v30 offset:1280
    ds_read_b64_tr_b16 v[136:137], v30 offset:160
    ds_read_b64_tr_b16 v[138:139], v30 offset:1312
    ds_read_b64_tr_b16 v[140:141], v30 offset:192
    ds_read_b64_tr_b16 v[142:143], v30 offset:1344
    ds_read_b64_tr_b16 v[144:145], v30 offset:224
    ds_read_b64_tr_b16 v[146:147], v30 offset:1376
    ds_read_b64_tr_b16 v[148:149], v30 offset:256
    ds_read_b64_tr_b16 v[150:151], v30 offset:1408
    s_waitcnt vmcnt(13)
    s_waitcnt lgkmcnt(0)
    v_mfma_f32_16x16x32_bf16 v[156:159], v[116:119], v[48:51], v[156:159]
    v_mfma_f32_16x16x32_bf16 v[192:195], v[116:119], v[56:59], v[192:195]
    v_mfma_f32_16x16x32_bf16 v[160:163], v[120:123], v[48:51], v[160:163]
    v_mfma_f32_16x16x32_bf16 v[196:199], v[120:123], v[56:59], v[196:199]
    v_mfma_f32_16x16x32_bf16 v[164:167], v[124:127], v[48:51], v[164:167]
    v_mfma_f32_16x16x32_bf16 v[200:203], v[124:127], v[56:59], v[200:203]
    v_mfma_f32_16x16x32_bf16 v[168:171], v[128:131], v[48:51], v[168:171]
    v_mfma_f32_16x16x32_bf16 v[204:207], v[128:131], v[56:59], v[204:207]
    v_mfma_f32_16x16x32_bf16 v[172:175], v[132:135], v[48:51], v[172:175]
    v_mfma_f32_16x16x32_bf16 v[208:211], v[132:135], v[56:59], v[208:211]
    v_mfma_f32_16x16x32_bf16 v[176:179], v[136:139], v[48:51], v[176:179]
    v_mfma_f32_16x16x32_bf16 v[212:215], v[136:139], v[56:59], v[212:215]
    v_mfma_f32_16x16x32_bf16 v[180:183], v[140:143], v[48:51], v[180:183]
    v_mfma_f32_16x16x32_bf16 v[216:219], v[140:143], v[56:59], v[216:219]
    v_mfma_f32_16x16x32_bf16 v[184:187], v[144:147], v[48:51], v[184:187]
    v_mfma_f32_16x16x32_bf16 v[220:223], v[144:147], v[56:59], v[220:223]
    v_mfma_f32_16x16x32_bf16 v[188:191], v[148:151], v[48:51], v[188:191]
    v_mfma_f32_16x16x32_bf16 v[224:227], v[148:151], v[56:59], v[224:227]
    ds_read_b64_tr_b16 v[116:117], v30 offset:9728
    ds_read_b64_tr_b16 v[118:119], v30 offset:10880
    ds_read_b64_tr_b16 v[120:121], v30 offset:9760
    ds_read_b64_tr_b16 v[122:123], v30 offset:10912
    ds_read_b64_tr_b16 v[124:125], v30 offset:9792
    ds_read_b64_tr_b16 v[126:127], v30 offset:10944
    ds_read_b64_tr_b16 v[128:129], v30 offset:9824
    ds_read_b64_tr_b16 v[130:131], v30 offset:10976
    ds_read_b64_tr_b16 v[132:133], v30 offset:9856
    ds_read_b64_tr_b16 v[134:135], v30 offset:11008
    ds_read_b64_tr_b16 v[136:137], v30 offset:9888
    ds_read_b64_tr_b16 v[138:139], v30 offset:11040
    ds_read_b64_tr_b16 v[140:141], v30 offset:9920
    ds_read_b64_tr_b16 v[142:143], v30 offset:11072
    ds_read_b64_tr_b16 v[144:145], v30 offset:9952
    ds_read_b64_tr_b16 v[146:147], v30 offset:11104
    ds_read_b64_tr_b16 v[148:149], v30 offset:9984
    ds_read_b64_tr_b16 v[150:151], v30 offset:11136
    s_waitcnt lgkmcnt(0)
    v_mfma_f32_16x16x32_bf16 v[156:159], v[116:119], v[52:55], v[156:159]
    v_mfma_f32_16x16x32_bf16 v[192:195], v[116:119], v[60:63], v[192:195]
    v_mfma_f32_16x16x32_bf16 v[160:163], v[120:123], v[52:55], v[160:163]
    v_mfma_f32_16x16x32_bf16 v[196:199], v[120:123], v[60:63], v[196:199]
    v_mfma_f32_16x16x32_bf16 v[164:167], v[124:127], v[52:55], v[164:167]
    v_mfma_f32_16x16x32_bf16 v[200:203], v[124:127], v[60:63], v[200:203]
    v_mfma_f32_16x16x32_bf16 v[168:171], v[128:131], v[52:55], v[168:171]
    v_mfma_f32_16x16x32_bf16 v[204:207], v[128:131], v[60:63], v[204:207]
    v_mfma_f32_16x16x32_bf16 v[172:175], v[132:135], v[52:55], v[172:175]
    v_mfma_f32_16x16x32_bf16 v[208:211], v[132:135], v[60:63], v[208:211]
    v_mfma_f32_16x16x32_bf16 v[176:179], v[136:139], v[52:55], v[176:179]
    v_mfma_f32_16x16x32_bf16 v[212:215], v[136:139], v[60:63], v[212:215]
    v_mfma_f32_16x16x32_bf16 v[180:183], v[140:143], v[52:55], v[180:183]
    v_mfma_f32_16x16x32_bf16 v[216:219], v[140:143], v[60:63], v[216:219]
    v_mfma_f32_16x16x32_bf16 v[184:187], v[144:147], v[52:55], v[184:187]
    v_mfma_f32_16x16x32_bf16 v[220:223], v[144:147], v[60:63], v[220:223]
    v_mfma_f32_16x16x32_bf16 v[188:191], v[148:151], v[52:55], v[188:191]
    v_mfma_f32_16x16x32_bf16 v[224:227], v[148:151], v[60:63], v[224:227]
    s_waitcnt vmcnt(4)
    ds_write_b64 v21, v[98:99] offset:19456
    ds_write_b64 v22, v[100:101] offset:19456
    ds_write_b64 v23, v[102:103] offset:19456
    ds_write_b64 v24, v[104:105] offset:19456
    ds_write_b64 v25, v[106:107] offset:19456
    ds_write_b64 v26, v[108:109] offset:19456
    ds_write_b64 v27, v[110:111] offset:19456
    ds_write_b64 v28, v[112:113] offset:19456
    ds_write_b64 v29, v[114:115] offset:19456
    s_waitcnt lgkmcnt(0)
    s_barrier
    ds_read_b64_tr_b16 v[116:117], v30 offset:19456
    ds_read_b64_tr_b16 v[118:119], v30 offset:20608
    ds_read_b64_tr_b16 v[120:121], v30 offset:19488
    ds_read_b64_tr_b16 v[122:123], v30 offset:20640
    ds_read_b64_tr_b16 v[124:125], v30 offset:19520
    ds_read_b64_tr_b16 v[126:127], v30 offset:20672
    ds_read_b64_tr_b16 v[128:129], v30 offset:19552
    ds_read_b64_tr_b16 v[130:131], v30 offset:20704
    ds_read_b64_tr_b16 v[132:133], v30 offset:19584
    ds_read_b64_tr_b16 v[134:135], v30 offset:20736
    ds_read_b64_tr_b16 v[136:137], v30 offset:19616
    ds_read_b64_tr_b16 v[138:139], v30 offset:20768
    ds_read_b64_tr_b16 v[140:141], v30 offset:19648
    ds_read_b64_tr_b16 v[142:143], v30 offset:20800
    ds_read_b64_tr_b16 v[144:145], v30 offset:19680
    ds_read_b64_tr_b16 v[146:147], v30 offset:20832
    ds_read_b64_tr_b16 v[148:149], v30 offset:19712
    ds_read_b64_tr_b16 v[150:151], v30 offset:20864
    s_waitcnt vmcnt(0)
    s_waitcnt lgkmcnt(0)
    v_mfma_f32_16x16x32_bf16 v[156:159], v[116:119], v[64:67], v[156:159]
    v_mfma_f32_16x16x32_bf16 v[192:195], v[116:119], v[72:75], v[192:195]
    v_mfma_f32_16x16x32_bf16 v[160:163], v[120:123], v[64:67], v[160:163]
    v_mfma_f32_16x16x32_bf16 v[196:199], v[120:123], v[72:75], v[196:199]
    v_mfma_f32_16x16x32_bf16 v[164:167], v[124:127], v[64:67], v[164:167]
    v_mfma_f32_16x16x32_bf16 v[200:203], v[124:127], v[72:75], v[200:203]
    v_mfma_f32_16x16x32_bf16 v[168:171], v[128:131], v[64:67], v[168:171]
    v_mfma_f32_16x16x32_bf16 v[204:207], v[128:131], v[72:75], v[204:207]
    v_mfma_f32_16x16x32_bf16 v[172:175], v[132:135], v[64:67], v[172:175]
    v_mfma_f32_16x16x32_bf16 v[208:211], v[132:135], v[72:75], v[208:211]
    v_mfma_f32_16x16x32_bf16 v[176:179], v[136:139], v[64:67], v[176:179]
    v_mfma_f32_16x16x32_bf16 v[212:215], v[136:139], v[72:75], v[212:215]
    v_mfma_f32_16x16x32_bf16 v[180:183], v[140:143], v[64:67], v[180:183]
    v_mfma_f32_16x16x32_bf16 v[216:219], v[140:143], v[72:75], v[216:219]
    v_mfma_f32_16x16x32_bf16 v[184:187], v[144:147], v[64:67], v[184:187]
    v_mfma_f32_16x16x32_bf16 v[220:223], v[144:147], v[72:75], v[220:223]
    v_mfma_f32_16x16x32_bf16 v[188:191], v[148:151], v[64:67], v[188:191]
    v_mfma_f32_16x16x32_bf16 v[224:227], v[148:151], v[72:75], v[224:227]
    ds_read_b64_tr_b16 v[116:117], v30 offset:29184
    ds_read_b64_tr_b16 v[118:119], v30 offset:30336
    ds_read_b64_tr_b16 v[120:121], v30 offset:29216
    ds_read_b64_tr_b16 v[122:123], v30 offset:30368
    ds_read_b64_tr_b16 v[124:125], v30 offset:29248
    ds_read_b64_tr_b16 v[126:127], v30 offset:30400
    ds_read_b64_tr_b16 v[128:129], v30 offset:29280
    ds_read_b64_tr_b16 v[130:131], v30 offset:30432
    ds_read_b64_tr_b16 v[132:133], v30 offset:29312
    ds_read_b64_tr_b16 v[134:135], v30 offset:30464
    ds_read_b64_tr_b16 v[136:137], v30 offset:29344
    ds_read_b64_tr_b16 v[138:139], v30 offset:30496
    ds_read_b64_tr_b16 v[140:141], v30 offset:29376
    ds_read_b64_tr_b16 v[142:143], v30 offset:30528
    ds_read_b64_tr_b16 v[144:145], v30 offset:29408
    ds_read_b64_tr_b16 v[146:147], v30 offset:30560
    ds_read_b64_tr_b16 v[148:149], v30 offset:29440
    ds_read_b64_tr_b16 v[150:151], v30 offset:30592
    s_waitcnt lgkmcnt(0)
    v_mfma_f32_16x16x32_bf16 v[156:159], v[116:119], v[68:71], v[156:159]
    v_mfma_f32_16x16x32_bf16 v[192:195], v[116:119], v[76:79], v[192:195]
    v_mfma_f32_16x16x32_bf16 v[160:163], v[120:123], v[68:71], v[160:163]
    v_mfma_f32_16x16x32_bf16 v[196:199], v[120:123], v[76:79], v[196:199]
    v_mfma_f32_16x16x32_bf16 v[164:167], v[124:127], v[68:71], v[164:167]
    v_mfma_f32_16x16x32_bf16 v[200:203], v[124:127], v[76:79], v[200:203]
    v_mfma_f32_16x16x32_bf16 v[168:171], v[128:131], v[68:71], v[168:171]
    v_mfma_f32_16x16x32_bf16 v[204:207], v[128:131], v[76:79], v[204:207]
    v_mfma_f32_16x16x32_bf16 v[172:175], v[132:135], v[68:71], v[172:175]
    v_mfma_f32_16x16x32_bf16 v[208:211], v[132:135], v[76:79], v[208:211]
    v_mfma_f32_16x16x32_bf16 v[176:179], v[136:139], v[68:71], v[176:179]
    v_mfma_f32_16x16x32_bf16 v[212:215], v[136:139], v[76:79], v[212:215]
    v_mfma_f32_16x16x32_bf16 v[180:183], v[140:143], v[68:71], v[180:183]
    v_mfma_f32_16x16x32_bf16 v[216:219], v[140:143], v[76:79], v[216:219]
    v_mfma_f32_16x16x32_bf16 v[184:187], v[144:147], v[68:71], v[184:187]
    v_mfma_f32_16x16x32_bf16 v[220:223], v[144:147], v[76:79], v[220:223]
    v_mfma_f32_16x16x32_bf16 v[188:191], v[148:151], v[68:71], v[188:191]
    v_mfma_f32_16x16x32_bf16 v[224:227], v[148:151], v[76:79], v[224:227]
    s_nop 15
    s_nop 3
    s_mul_i32 s31, s23, 4718592
    s_add_u32 s36, s16, s31
    s_addc_u32 s37, s17, 0
    s_add_u32 s32, s36, 50331648
    s_addc_u32 s33, s37, 0
    s_mov_b32 s34, 4718592
    s_mov_b32 s35, 0x00020000
    s_mul_i32 s31, s22, 576
    v_mul_u32_u24 v7, 16, v4
    v_add_u32 v7, s31, v7
    s_mov_b32 s25, 2304
    v_add_u32 v6, 0, v5
    v_mul_lo_u32 v6, v6, s25
    v_add_u32 v60, v6, v7
    v_add_u32 v6, 16, v5
    v_mul_lo_u32 v6, v6, s25
    v_add_u32 v61, v6, v7
    buffer_store_dwordx4 v[156:159], v60, s[32:35], 0 offen offset:0
    buffer_store_dwordx4 v[160:163], v60, s[32:35], 0 offen offset:64
    buffer_store_dwordx4 v[164:167], v60, s[32:35], 0 offen offset:128
    buffer_store_dwordx4 v[168:171], v60, s[32:35], 0 offen offset:192
    buffer_store_dwordx4 v[172:175], v60, s[32:35], 0 offen offset:256
    buffer_store_dwordx4 v[176:179], v60, s[32:35], 0 offen offset:320
    buffer_store_dwordx4 v[180:183], v60, s[32:35], 0 offen offset:384
    buffer_store_dwordx4 v[184:187], v60, s[32:35], 0 offen offset:448
    buffer_store_dwordx4 v[188:191], v60, s[32:35], 0 offen offset:512
    buffer_store_dwordx4 v[192:195], v61, s[32:35], 0 offen offset:0
    buffer_store_dwordx4 v[196:199], v61, s[32:35], 0 offen offset:64
    buffer_store_dwordx4 v[200:203], v61, s[32:35], 0 offen offset:128
    buffer_store_dwordx4 v[204:207], v61, s[32:35], 0 offen offset:192
    buffer_store_dwordx4 v[208:211], v61, s[32:35], 0 offen offset:256
    buffer_store_dwordx4 v[212:215], v61, s[32:35], 0 offen offset:320
    buffer_store_dwordx4 v[216:219], v61, s[32:35], 0 offen offset:384
    buffer_store_dwordx4 v[220:223], v61, s[32:35], 0 offen offset:448
    buffer_store_dwordx4 v[224:227], v61, s[32:35], 0 offen offset:512
L_k_ffn2_end:
    s_endpgm
.globl k_final_kernel
.p2align 8
.type k_final_kernel,@function
k_final_kernel:
    s_cmp_ge_u32 s2, 128
    s_cbranch_scc1 L_k_final_kernel_end
    s_load_dwordx2 s[4:5], s[0:1], 88
    s_load_dwordx2 s[6:7], s[0:1], 24
    s_load_dwordx2 s[16:17], s[0:1], 88
    s_and_b32 s20, s2, 31
    s_lshr_b32 s21, s2, 5
    s_mov_b32 s22, s21
    s_mov_b32 s23, 0
    v_and_b32 v1, 63, v0
    v_lshrrev_b32 v2, 6, v0
    v_and_b32 v3, 15, v1
    v_lshrrev_b32 v4, 4, v1
    s_mul_i32 s24, s20, 64
    v_mul_u32_u24 v5, 16, v2
    v_add_u32 v5, v5, v3
    v_add_u32 v5, s24, v5
    v_add_u32 v6, 0, v5
    s_mov_b32 s25, 1152
    v_mul_lo_u32 v6, v6, s25
    v_lshlrev_b32 v7, 4, v4
    v_add_u32 v10, v6, v7
    v_add_u32 v6, 0, v0
    s_mov_b32 s25, 0x71c71c8
    v_mul_hi_u32 v7, v6, s25
    v_mul_u32_u24 v8, 36, v7
    v_sub_u32 v8, v6, v8
    s_mov_b32 s25, 1152
    v_mul_lo_u32 v9, v7, s25
    v_lshl_add_u32 v12, v8, 3, v9
    v_lshrrev_b32 v9, 3, v7
    v_mul_u32_u24 v9, 2432, v9
    v_and_b32 v6, 7, v7
    v_mul_u32_u24 v6, 288, v6
    v_add_u32 v9, v9, v6
    v_lshl_add_u32 v21, v8, 3, v9
    v_add_u32 v6, 256, v0
    s_mov_b32 s25, 0x71c71c8
    v_mul_hi_u32 v7, v6, s25
    v_mul_u32_u24 v8, 36, v7
    v_sub_u32 v8, v6, v8
    s_mov_b32 s25, 1152
    v_mul_lo_u32 v9, v7, s25
    v_lshl_add_u32 v13, v8, 3, v9
    v_lshrrev_b32 v9, 3, v7
    v_mul_u32_u24 v9, 2432, v9
    v_and_b32 v6, 7, v7
    v_mul_u32_u24 v6, 288, v6
    v_add_u32 v9, v9, v6
    v_lshl_add_u32 v22, v8, 3, v9
    v_add_u32 v6, 512, v0
    s_mov_b32 s25, 0x71c71c8
    v_mul_hi_u32 v7, v6, s25
    v_mul_u32_u24 v8, 36, v7
    v_sub_u32 v8, v6, v8
    s_mov_b32 s25, 1152
    v_mul_lo_u32 v9, v7, s25
    v_lshl_add_u32 v14, v8, 3, v9
    v_lshrrev_b32 v9, 3, v7
    v_mul_u32_u24 v9, 2432, v9
    v_and_b32 v6, 7, v7
    v_mul_u32_u24 v6, 288, v6
    v_add_u32 v9, v9, v6
    v_lshl_add_u32 v23, v8, 3, v9
    v_add_u32 v6, 768, v0
    s_mov_b32 s25, 0x71c71c8
    v_mul_hi_u32 v7, v6, s25
    v_mul_u32_u24 v8, 36, v7
    v_sub_u32 v8, v6, v8
    s_mov_b32 s25, 1152
    v_mul_lo_u32 v9, v7, s25
    v_lshl_add_u32 v15, v8, 3, v9
    v_lshrrev_b32 v9, 3, v7
    v_mul_u32_u24 v9, 2432, v9
    v_and_b32 v6, 7, v7
    v_mul_u32_u24 v6, 288, v6
    v_add_u32 v9, v9, v6
    v_lshl_add_u32 v24, v8, 3, v9
    v_add_u32 v6, 1024, v0
    s_mov_b32 s25, 0x71c71c8
    v_mul_hi_u32 v7, v6, s25
    v_mul_u32_u24 v8, 36, v7
    v_sub_u32 v8, v6, v8
    s_mov_b32 s25, 1152
    v_mul_lo_u32 v9, v7, s25
    v_lshl_add_u32 v16, v8, 3, v9
    v_lshrrev_b32 v9, 3, v7
    v_mul_u32_u24 v9, 2432, v9
    v_and_b32 v6, 7, v7
    v_mul_u32_u24 v6, 288, v6
    v_add_u32 v9, v9, v6
    v_lshl_add_u32 v25, v8, 3, v9
    v_add_u32 v6, 1280, v0
    s_mov_b32 s25, 0x71c71c8
    v_mul_hi_u32 v7, v6, s25
    v_mul_u32_u24 v8, 36, v7
    v_sub_u32 v8, v6, v8
    s_mov_b32 s25, 1152
    v_mul_lo_u32 v9, v7, s25
    v_lshl_add_u32 v17, v8, 3, v9
    v_lshrrev_b32 v9, 3, v7
    v_mul_u32_u24 v9, 2432, v9
    v_and_b32 v6, 7, v7
    v_mul_u32_u24 v6, 288, v6
    v_add_u32 v9, v9, v6
    v_lshl_add_u32 v26, v8, 3, v9
    v_add_u32 v6, 1536, v0
    s_mov_b32 s25, 0x71c71c8
    v_mul_hi_u32 v7, v6, s25
    v_mul_u32_u24 v8, 36, v7
    v_sub_u32 v8, v6, v8
    s_mov_b32 s25, 1152
    v_mul_lo_u32 v9, v7, s25
    v_lshl_add_u32 v18, v8, 3, v9
    v_lshrrev_b32 v9, 3, v7
    v_mul_u32_u24 v9, 2432, v9
    v_and_b32 v6, 7, v7
    v_mul_u32_u24 v6, 288, v6
    v_add_u32 v9, v9, v6
    v_lshl_add_u32 v27, v8, 3, v9
    v_add_u32 v6, 1792, v0
    s_mov_b32 s25, 0x71c71c8
    v_mul_hi_u32 v7, v6, s25
    v_mul_u32_u24 v8, 36, v7
    v_sub_u32 v8, v6, v8
    s_mov_b32 s25, 1152
    v_mul_lo_u32 v9, v7, s25
    v_lshl_add_u32 v19, v8, 3, v9
    v_lshrrev_b32 v9, 3, v7
    v_mul_u32_u24 v9, 2432, v9
    v_and_b32 v6, 7, v7
    v_mul_u32_u24 v6, 288, v6
    v_add_u32 v9, v9, v6
    v_lshl_add_u32 v28, v8, 3, v9
    v_add_u32 v6, 2048, v0
    s_mov_b32 s25, 0x71c71c8
    v_mul_hi_u32 v7, v6, s25
    v_mul_u32_u24 v8, 36, v7
    v_sub_u32 v8, v6, v8
    s_mov_b32 s25, 1152
    v_mul_lo_u32 v9, v7, s25
    v_lshl_add_u32 v20, v8, 3, v9
    v_lshrrev_b32 v9, 3, v7
    v_mul_u32_u24 v9, 2432, v9
    v_and_b32 v6, 7, v7
    v_mul_u32_u24 v6, 288, v6
    v_add_u32 v9, v9, v6
    v_lshl_add_u32 v29, v8, 3, v9
    v_mul_u32_u24 v30, 2432, v4
    v_lshrrev_b32 v6, 2, v3
    v_mul_u32_u24 v6, 288, v6
    v_add_u32 v30, v30, v6
    v_and_b32 v6, 3, v1
    v_lshl_add_u32 v30, v6, 3, v30
    s_waitcnt lgkmcnt(0)
    s_add_u32 s8, s4, 100663296
    s_addc_u32 s9, s5, 0
    s_mov_b32 s10, 2359296
    s_mov_b32 s11, 0x00020000
    s_mul_i32 s26, s22, 288
    s_add_u32 s12, s6, s26
    s_addc_u32 s13, s7, 0
    s_sub_u32 s14, 663552, s26
    s_mov_b32 s15, 0x00020000
    s_mul_i32 s27, s23, 1152
    s_mul_i32 s28, s23, 663552
    v_mov_b32 v156, 0
    v_mov_b32 v157, 0
    v_mov_b32 v158, 0
    v_mov_b32 v159, 0
    v_mov_b32 v160, 0
    v_mov_b32 v161, 0
    v_mov_b32 v162, 0
    v_mov_b32 v163, 0
    v_mov_b32 v164, 0
    v_mov_b32 v165, 0
    v_mov_b32 v166, 0
    v_mov_b32 v167, 0
    v_mov_b32 v168, 0
    v_mov_b32 v169, 0
    v_mov_b32 v170, 0
    v_mov_b32 v171, 0
    v_mov_b32 v172, 0
    v_mov_b32 v173, 0
    v_mov_b32 v174, 0
    v_mov_b32 v175, 0
    v_mov_b32 v176, 0
    v_mov_b32 v177, 0
    v_mov_b32 v178, 0
    v_mov_b32 v179, 0
    v_mov_b32 v180, 0
    v_mov_b32 v181, 0
    v_mov_b32 v182, 0
    v_mov_b32 v183, 0
    v_mov_b32 v184, 0
    v_mov_b32 v185, 0
    v_mov_b32 v186, 0
    v_mov_b32 v187, 0
    v_mov_b32 v188, 0
    v_mov_b32 v189, 0
    v_mov_b32 v190, 0
    v_mov_b32 v191, 0
    s_add_u32 s29, s28, 0
    buffer_load_dwordx2 v[80:81], v12, s[12:15], s29 offen
    buffer_load_dwordx2 v[82:83], v13, s[12:15], s29 offen
    buffer_load_dwordx2 v[84:85], v14, s[12:15], s29 offen
    buffer_load_dwordx2 v[86:87], v15, s[12:15], s29 offen
    buffer_load_dwordx2 v[88:89], v16, s[12:15], s29 offen
    buffer_load_dwordx2 v[90:91], v17, s[12:15], s29 offen
    buffer_load_dwordx2 v[92:93], v18, s[12:15], s29 offen
    buffer_load_dwordx2 v[94:95], v19, s[12:15], s29 offen
    buffer_load_dwordx2 v[96:97], v20, s[12:15], s29 offen
    s_add_u32 s30, s27, 0
    buffer_load_dwordx4 v[32:35], v10, s[8:11], s30 offen offset:0
    buffer_load_dwordx4 v[36:39], v10, s[8:11], s30 offen offset:64
    s_add_u32 s29, s28, 73728
    buffer_load_dwordx2 v[98:99], v12, s[12:15], s29 offen
    buffer_load_dwordx2 v[100:101], v13, s[12:15], s29 offen
    buffer_load_dwordx2 v[102:103], v14, s[12:15], s29 offen
    buffer_load_dwordx2 v[104:105], v15, s[12:15], s29 offen
    buffer_load_dwordx2 v[106:107], v16, s[12:15], s29 offen
    buffer_load_dwordx2 v[108:109], v17, s[12:15], s29 offen
    buffer_load_dwordx2 v[110:111], v18, s[12:15], s29 offen
    buffer_load_dwordx2 v[112:113], v19, s[12:15], s29 offen
    buffer_load_dwordx2 v[114:115], v20, s[12:15], s29 offen
    s_add_u32 s30, s27, 128
    buffer_load_dwordx4 v[40:43], v10, s[8:11], s30 offen offset:0
    buffer_load_dwordx4 v[44:47], v10, s[8:11], s30 offen offset:64
    s_waitcnt vmcnt(13)
    ds_write_b64 v21, v[80:81] offset:0
    ds_write_b64 v22, v[82:83] offset:0
    ds_write_b64 v23, v[84:85] offset:0
    ds_write_b64 v24, v[86:87] offset:0
    ds_write_b64 v25, v[88:89] offset:0
    ds_write_b64 v26, v[90:91] offset:0
    ds_write_b64 v27, v[92:93] offset:0
    ds_write_b64 v28, v[94:95] offset:0
    ds_write_b64 v29, v[96:97] offset:0
    s_waitcnt lgkmcnt(0)
    s_barrier
    s_add_u32 s29, s28, 147456
    buffer_load_dwordx2 v[80:81], v12, s[12:15], s29 offen
    buffer_load_dwordx2 v[82:83], v13, s[12:15], s29 offen
    buffer_load_dwordx2 v[84:85], v14, s[12:15], s29 offen
    buffer_load_dwordx2 v[86:87], v15, s[12:15], s29 offen
    buffer_load_dwordx2 v[88:89], v16, s[12:15], s29 offen
    buffer_load_dwordx2 v[90:91], v17, s[12:15], s29 offen
    buffer_load_dwordx2 v[92:93], v18, s[12:15], s29 offen
    buffer_load_dwordx2 v[94:95], v19, s[12:15], s29 offen
    buffer_load_dwordx2 v[96:97], v20, s[12:15], s29 offen
    s_add_u32 s30, s27, 256
    buffer_load_dwordx4 v[48:51], v10, s[8:11], s30 offen offset:0
    buffer_load_dwordx4 v[52:55], v10, s[8:11], s30 offen offset:64
    ds_read_b64_tr_b16 v[116:117], v30 offset:0
    ds_read_b64_tr_b16 v[118:119], v30 offset:1152
    ds_read_b64_tr_b16 v[120:121], v30 offset:32
    ds_read_b64_tr_b16 v[122:123], v30 offset:1184
    ds_read_b64_tr_b16 v[124:125], v30 offset:64
    ds_read_b64_tr_b16 v[126:127], v30 offset:1216
    ds_read_b64_tr_b16 v[128:129], v30 offset:96
    ds_read_b64_tr_b16 v[130:131], v30 offset:1248
    ds_read_b64_tr_b16 v[132:133], v30 offset:128
    ds_read_b64_tr_b16 v[134:135], v30 offset:1280
    ds_read_b64_tr_b16 v[136:137], v30 offset:160
    ds_read_b64_tr_b16 v[138:139], v30 offset:1312
    ds_read_b64_tr_b16 v[140:141], v30 offset:192
    ds_read_b64_tr_b16 v[142:143], v30 offset:1344
    ds_read_b64_tr_b16 v[144:145], v30 offset:224
    ds_read_b64_tr_b16 v[146:147], v30 offset:1376
    ds_read_b64_tr_b16 v[148:149], v30 offset:256
    ds_read_b64_tr_b16 v[150:151], v30 offset:1408
    s_waitcnt vmcnt(22)
    s_waitcnt lgkmcnt(0)
    v_mfma_f32_16x16x32_bf16 v[156:159], v[116:119], v[32:35], v[156:159]
    v_mfma_f32_16x16x32_bf16 v[160:163], v[120:123], v[32:35], v[160:163]
    v_mfma_f32_16x16x32_bf16 v[164:167], v[124:127], v[32:35], v[164:167]
    v_mfma_f32_16x16x32_bf16 v[168:171], v[128:131], v[32:35], v[168:171]
    v_mfma_f32_16x16x32_bf16 v[172:175], v[132:135], v[32:35], v[172:175]
    v_mfma_f32_16x16x32_bf16 v[176:179], v[136:139], v[32:35], v[176:179]
    v_mfma_f32_16x16x32_bf16 v[180:183], v[140:143], v[32:35], v[180:183]
    v_mfma_f32_16x16x32_bf16 v[184:187], v[144:147], v[32:35], v[184:187]
    v_mfma_f32_16x16x32_bf16 v[188:191], v[148:151], v[32:35], v[188:191]
    ds_read_b64_tr_b16 v[116:117], v30 offset:9728
    ds_read_b64_tr_b16 v[118:119], v30 offset:10880
    ds_read_b64_tr_b16 v[120:121], v30 offset:9760
    ds_read_b64_tr_b16 v[122:123], v30 offset:10912
    ds_read_b64_tr_b16 v[124:125], v30 offset:9792
    ds_read_b64_tr_b16 v[126:127], v30 offset:10944
    ds_read_b64_tr_b16 v[128:129], v30 offset:9824
    ds_read_b64_tr_b16 v[130:131], v30 offset:10976
    ds_read_b64_tr_b16 v[132:133], v30 offset:9856
    ds_read_b64_tr_b16 v[134:135], v30 offset:11008
    ds_read_b64_tr_b16 v[136:137], v30 offset:9888
    ds_read_b64_tr_b16 v[138:139], v30 offset:11040
    ds_read_b64_tr_b16 v[140:141], v30 offset:9920
    ds_read_b64_tr_b16 v[142:143], v30 offset:11072
    ds_read_b64_tr_b16 v[144:145], v30 offset:9952
    ds_read_b64_tr_b16 v[146:147], v30 offset:11104
    ds_read_b64_tr_b16 v[148:149], v30 offset:9984
    ds_read_b64_tr_b16 v[150:151], v30 offset:11136
    s_waitcnt lgkmcnt(0)
    v_mfma_f32_16x16x32_bf16 v[156:159], v[116:119], v[36:39], v[156:159]
    v_mfma_f32_16x16x32_bf16 v[160:163], v[120:123], v[36:39], v[160:163]
    v_mfma_f32_16x16x32_bf16 v[164:167], v[124:127], v[36:39], v[164:167]
    v_mfma_f32_16x16x32_bf16 v[168:171], v[128:131], v[36:39], v[168:171]
    v_mfma_f32_16x16x32_bf16 v[172:175], v[132:135], v[36:39], v[172:175]
    v_mfma_f32_16x16x32_bf16 v[176:179], v[136:139], v[36:39], v[176:179]
    v_mfma_f32_16x16x32_bf16 v[180:183], v[140:143], v[36:39], v[180:183]
    v_mfma_f32_16x16x32_bf16 v[184:187], v[144:147], v[36:39], v[184:187]
    v_mfma_f32_16x16x32_bf16 v[188:191], v[148:151], v[36:39], v[188:191]
    s_waitcnt vmcnt(13)
    ds_write_b64 v21, v[98:99] offset:19456
    ds_write_b64 v22, v[100:101] offset:19456
    ds_write_b64 v23, v[102:103] offset:19456
    ds_write_b64 v24, v[104:105] offset:19456
    ds_write_b64 v25, v[106:107] offset:19456
    ds_write_b64 v26, v[108:109] offset:19456
    ds_write_b64 v27, v[110:111] offset:19456
    ds_write_b64 v28, v[112:113] offset:19456
    ds_write_b64 v29, v[114:115] offset:19456
    s_waitcnt lgkmcnt(0)
    s_barrier
    s_add_u32 s29, s28, 221184
    buffer_load_dwordx2 v[98:99], v12, s[12:15], s29 offen
    buffer_load_dwordx2 v[100:101], v13, s[12:15], s29 offen
    buffer_load_dwordx2 v[102:103], v14, s[12:15], s29 offen
    buffer_load_dwordx2 v[104:105], v15, s[12:15], s29 offen
    buffer_load_dwordx2 v[106:107], v16, s[12:15], s29 offen
    buffer_load_dwordx2 v[108:109], v17, s[12:15], s29 offen
    buffer_load_dwordx2 v[110:111], v18, s[12:15], s29 offen
    buffer_load_dwordx2 v[112:113], v19, s[12:15], s29 offen
    buffer_load_dwordx2 v[114:115], v20, s[12:15], s29 offen
    s_add_u32 s30, s27, 384
    buffer_load_dwordx4 v[32:35], v10, s[8:11], s30 offen offset:0
    buffer_load_dwordx4 v[36:39], v10, s[8:11], s30 offen offset:64
    ds_read_b64_tr_b16 v[116:117], v30 offset:19456
    ds_read_b64_tr_b16 v[118:119], v30 offset:20608
    ds_read_b64_tr_b16 v[120:121], v30 offset:19488
    ds_read_b64_tr_b16 v[122:123], v30 offset:20640
    ds_read_b64_tr_b16 v[124:125], v30 offset:19520
    ds_read_b64_tr_b16 v[126:127], v30 offset:20672
    ds_read_b64_tr_b16 v[128:129], v30 offset:19552
    ds_read_b64_tr_b16 v[130:131], v30 offset:20704
    ds_read_b64_tr_b16 v[132:133], v30 offset:19584
    ds_read_b64_tr_b16 v[134:135], v30 offset:20736
    ds_read_b64_tr_b16 v[136:137], v30 offset:19616
    ds_read_b64_tr_b16 v[138:139], v30 offset:20768
    ds_read_b64_tr_b16 v[140:141], v30 offset:19648
    ds_read_b64_tr_b16 v[142:143], v30 offset:20800
    ds_read_b64_tr_b16 v[144:145], v30 offset:19680
    ds_read_b64_tr_b16 v[146:147], v30 offset:20832
    ds_read_b64_tr_b16 v[148:149], v30 offset:19712
    ds_read_b64_tr_b16 v[150:151], v30 offset:20864
    s_waitcnt vmcnt(22)
    s_waitcnt lgkmcnt(0)
    v_mfma_f32_16x16x32_bf16 v[156:159], v[116:119], v[40:43], v[156:159]
    v_mfma_f32_16x16x32_bf16 v[160:163], v[120:123], v[40:43], v[160:163]
    v_mfma_f32_16x16x32_bf16 v[164:167], v[124:127], v[40:43], v[164:167]
    v_mfma_f32_16x16x32_bf16 v[168:171], v[128:131], v[40:43], v[168:171]
    v_mfma_f32_16x16x32_bf16 v[172:175], v[132:135], v[40:43], v[172:175]
    v_mfma_f32_16x16x32_bf16 v[176:179], v[136:139], v[40:43], v[176:179]
    v_mfma_f32_16x16x32_bf16 v[180:183], v[140:143], v[40:43], v[180:183]
    v_mfma_f32_16x16x32_bf16 v[184:187], v[144:147], v[40:43], v[184:187]
    v_mfma_f32_16x16x32_bf16 v[188:191], v[148:151], v[40:43], v[188:191]
    ds_read_b64_tr_b16 v[116:117], v30 offset:29184
    ds_read_b64_tr_b16 v[118:119], v30 offset:30336
    ds_read_b64_tr_b16 v[120:121], v30 offset:29216
    ds_read_b64_tr_b16 v[122:123], v30 offset:30368
    ds_read_b64_tr_b16 v[124:125], v30 offset:29248
    ds_read_b64_tr_b16 v[126:127], v30 offset:30400
    ds_read_b64_tr_b16 v[128:129], v30 offset:29280
    ds_read_b64_tr_b16 v[130:131], v30 offset:30432
    ds_read_b64_tr_b16 v[132:133], v30 offset:29312
    ds_read_b64_tr_b16 v[134:135], v30 offset:30464
    ds_read_b64_tr_b16 v[136:137], v30 offset:29344
    ds_read_b64_tr_b16 v[138:139], v30 offset:30496
    ds_read_b64_tr_b16 v[140:141], v30 offset:29376
    ds_read_b64_tr_b16 v[142:143], v30 offset:30528
    ds_read_b64_tr_b16 v[144:145], v30 offset:29408
    ds_read_b64_tr_b16 v[146:147], v30 offset:30560
    ds_read_b64_tr_b16 v[148:149], v30 offset:29440
    ds_read_b64_tr_b16 v[150:151], v30 offset:30592
    s_waitcnt lgkmcnt(0)
    v_mfma_f32_16x16x32_bf16 v[156:159], v[116:119], v[44:47], v[156:159]
    v_mfma_f32_16x16x32_bf16 v[160:163], v[120:123], v[44:47], v[160:163]
    v_mfma_f32_16x16x32_bf16 v[164:167], v[124:127], v[44:47], v[164:167]
    v_mfma_f32_16x16x32_bf16 v[168:171], v[128:131], v[44:47], v[168:171]
    v_mfma_f32_16x16x32_bf16 v[172:175], v[132:135], v[44:47], v[172:175]
    v_mfma_f32_16x16x32_bf16 v[176:179], v[136:139], v[44:47], v[176:179]
    v_mfma_f32_16x16x32_bf16 v[180:183], v[140:143], v[44:47], v[180:183]
    v_mfma_f32_16x16x32_bf16 v[184:187], v[144:147], v[44:47], v[184:187]
    v_mfma_f32_16x16x32_bf16 v[188:191], v[148:151], v[44:47], v[188:191]
    s_waitcnt vmcnt(13)
    ds_write_b64 v21, v[80:81] offset:0
    ds_write_b64 v22, v[82:83] offset:0
    ds_write_b64 v23, v[84:85] offset:0
    ds_write_b64 v24, v[86:87] offset:0
    ds_write_b64 v25, v[88:89] offset:0
    ds_write_b64 v26, v[90:91] offset:0
    ds_write_b64 v27, v[92:93] offset:0
    ds_write_b64 v28, v[94:95] offset:0
    ds_write_b64 v29, v[96:97] offset:0
    s_waitcnt lgkmcnt(0)
    s_barrier
    s_add_u32 s29, s28, 294912
    buffer_load_dwordx2 v[80:81], v12, s[12:15], s29 offen
    buffer_load_dwordx2 v[82:83], v13, s[12:15], s29 offen
    buffer_load_dwordx2 v[84:85], v14, s[12:15], s29 offen
    buffer_load_dwordx2 v[86:87], v15, s[12:15], s29 offen
    buffer_load_dwordx2 v[88:89], v16, s[12:15], s29 offen
    buffer_load_dwordx2 v[90:91], v17, s[12:15], s29 offen
    buffer_load_dwordx2 v[92:93], v18, s[12:15], s29 offen
    buffer_load_dwordx2 v[94:95], v19, s[12:15], s29 offen
    buffer_load_dwordx2 v[96:97], v20, s[12:15], s29 offen
    s_add_u32 s30, s27, 512
    buffer_load_dwordx4 v[40:43], v10, s[8:11], s30 offen offset:0
    buffer_load_dwordx4 v[44:47], v10, s[8:11], s30 offen offset:64
    ds_read_b64_tr_b16 v[116:117], v30 offset:0
    ds_read_b64_tr_b16 v[118:119], v30 offset:1152
    ds_read_b64_tr_b16 v[120:121], v30 offset:32
    ds_read_b64_tr_b16 v[122:123], v30 offset:1184
    ds_read_b64_tr_b16 v[124:125], v30 offset:64
    ds_read_b64_tr_b16 v[126:127], v30 offset:1216
    ds_read_b64_tr_b16 v[128:129], v30 offset:96
    ds_read_b64_tr_b16 v[130:131], v30 offset:1248
    ds_read_b64_tr_b16 v[132:133], v30 offset:128
    ds_read_b64_tr_b16 v[134:135], v30 offset:1280
    ds_read_b64_tr_b16 v[136:137], v30 offset:160
    ds_read_b64_tr_b16 v[138:139], v30 offset:1312
    ds_read_b64_tr_b16 v[140:141], v30 offset:192
    ds_read_b64_tr_b16 v[142:143], v30 offset:1344
    ds_read_b64_tr_b16 v[144:145], v30 offset:224
    ds_read_b64_tr_b16 v[146:147], v30 offset:1376
    ds_read_b64_tr_b16 v[148:149], v30 offset:256
    ds_read_b64_tr_b16 v[150:151], v30 offset:1408
    s_waitcnt vmcnt(22)
    s_waitcnt lgkmcnt(0)
    v_mfma_f32_16x16x32_bf16 v[156:159], v[116:119], v[48:51], v[156:159]
    v_mfma_f32_16x16x32_bf16 v[160:163], v[120:123], v[48:51], v[160:163]
    v_mfma_f32_16x16x32_bf16 v[164:167], v[124:127], v[48:51], v[164:167]
    v_mfma_f32_16x16x32_bf16 v[168:171], v[128:131], v[48:51], v[168:171]
    v_mfma_f32_16x16x32_bf16 v[172:175], v[132:135], v[48:51], v[172:175]
    v_mfma_f32_16x16x32_bf16 v[176:179], v[136:139], v[48:51], v[176:179]
    v_mfma_f32_16x16x32_bf16 v[180:183], v[140:143], v[48:51], v[180:183]
    v_mfma_f32_16x16x32_bf16 v[184:187], v[144:147], v[48:51], v[184:187]
    v_mfma_f32_16x16x32_bf16 v[188:191], v[148:151], v[48:51], v[188:191]
    ds_read_b64_tr_b16 v[116:117], v30 offset:9728
    ds_read_b64_tr_b16 v[118:119], v30 offset:10880
    ds_read_b64_tr_b16 v[120:121], v30 offset:9760
    ds_read_b64_tr_b16 v[122:123], v30 offset:10912
    ds_read_b64_tr_b16 v[124:125], v30 offset:9792
    ds_read_b64_tr_b16 v[126:127], v30 offset:10944
    ds_read_b64_tr_b16 v[128:129], v30 offset:9824
    ds_read_b64_tr_b16 v[130:131], v30 offset:10976
    ds_read_b64_tr_b16 v[132:133], v30 offset:9856
    ds_read_b64_tr_b16 v[134:135], v30 offset:11008
    ds_read_b64_tr_b16 v[136:137], v30 offset:9888
    ds_read_b64_tr_b16 v[138:139], v30 offset:11040
    ds_read_b64_tr_b16 v[140:141], v30 offset:9920
    ds_read_b64_tr_b16 v[142:143], v30 offset:11072
    ds_read_b64_tr_b16 v[144:145], v30 offset:9952
    ds_read_b64_tr_b16 v[146:147], v30 offset:11104
    ds_read_b64_tr_b16 v[148:149], v30 offset:9984
    ds_read_b64_tr_b16 v[150:151], v30 offset:11136
    s_waitcnt lgkmcnt(0)
    v_mfma_f32_16x16x32_bf16 v[156:159], v[116:119], v[52:55], v[156:159]
    v_mfma_f32_16x16x32_bf16 v[160:163], v[120:123], v[52:55], v[160:163]
    v_mfma_f32_16x16x32_bf16 v[164:167], v[124:127], v[52:55], v[164:167]
    v_mfma_f32_16x16x32_bf16 v[168:171], v[128:131], v[52:55], v[168:171]
    v_mfma_f32_16x16x32_bf16 v[172:175], v[132:135], v[52:55], v[172:175]
    v_mfma_f32_16x16x32_bf16 v[176:179], v[136:139], v[52:55], v[176:179]
    v_mfma_f32_16x16x32_bf16 v[180:183], v[140:143], v[52:55], v[180:183]
    v_mfma_f32_16x16x32_bf16 v[184:187], v[144:147], v[52:55], v[184:187]
    v_mfma_f32_16x16x32_bf16 v[188:191], v[148:151], v[52:55], v[188:191]
    s_waitcnt vmcnt(13)
    ds_write_b64 v21, v[98:99] offset:19456
    ds_write_b64 v22, v[100:101] offset:19456
    ds_write_b64 v23, v[102:103] offset:19456
    ds_write_b64 v24, v[104:105] offset:19456
    ds_write_b64 v25, v[106:107] offset:19456
    ds_write_b64 v26, v[108:109] offset:19456
    ds_write_b64 v27, v[110:111] offset:19456
    ds_write_b64 v28, v[112:113] offset:19456
    ds_write_b64 v29, v[114:115] offset:19456
    s_waitcnt lgkmcnt(0)
    s_barrier
    s_add_u32 s29, s28, 368640
    buffer_load_dwordx2 v[98:99], v12, s[12:15], s29 offen
    buffer_load_dwordx2 v[100:101], v13, s[12:15], s29 offen
    buffer_load_dwordx2 v[102:103], v14, s[12:15], s29 offen
    buffer_load_dwordx2 v[104:105], v15, s[12:15], s29 offen
    buffer_load_dwordx2 v[106:107], v16, s[12:15], s29 offen
    buffer_load_dwordx2 v[108:109], v17, s[12:15], s29 offen
    buffer_load_dwordx2 v[110:111], v18, s[12:15], s29 offen
    buffer_load_dwordx2 v[112:113], v19, s[12:15], s29 offen
    buffer_load_dwordx2 v[114:115], v20, s[12:15], s29 offen
    s_add_u32 s30, s27, 640
    buffer_load_dwordx4 v[48:51], v10, s[8:11], s30 offen offset:0
    buffer_load_dwordx4 v[52:55], v10, s[8:11], s30 offen offset:64
    ds_read_b64_tr_b16 v[116:117], v30 offset:19456
    ds_read_b64_tr_b16 v[118:119], v30 offset:20608
    ds_read_b64_tr_b16 v[120:121], v30 offset:19488
    ds_read_b64_tr_b16 v[122:123], v30 offset:20640
    ds_read_b64_tr_b16 v[124:125], v30 offset:19520
    ds_read_b64_tr_b16 v[126:127], v30 offset:20672
    ds_read_b64_tr_b16 v[128:129], v30 offset:19552
    ds_read_b64_tr_b16 v[130:131], v30 offset:20704
    ds_read_b64_tr_b16 v[132:133], v30 offset:19584
    ds_read_b64_tr_b16 v[134:135], v30 offset:20736
    ds_read_b64_tr_b16 v[136:137], v30 offset:19616
    ds_read_b64_tr_b16 v[138:139], v30 offset:20768
    ds_read_b64_tr_b16 v[140:141], v30 offset:19648
    ds_read_b64_tr_b16 v[142:143], v30 offset:20800
    ds_read_b64_tr_b16 v[144:145], v30 offset:19680
    ds_read_b64_tr_b16 v[146:147], v30 offset:20832
    ds_read_b64_tr_b16 v[148:149], v30 offset:19712
    ds_read_b64_tr_b16 v[150:151], v30 offset:20864
    s_waitcnt vmcnt(22)
    s_waitcnt lgkmcnt(0)
    v_mfma_f32_16x16x32_bf16 v[156:159], v[116:119], v[32:35], v[156:159]
    v_mfma_f32_16x16x32_bf16 v[160:163], v[120:123], v[32:35], v[160:163]
    v_mfma_f32_16x16x32_bf16 v[164:167], v[124:127], v[32:35], v[164:167]
    v_mfma_f32_16x16x32_bf16 v[168:171], v[128:131], v[32:35], v[168:171]
    v_mfma_f32_16x16x32_bf16 v[172:175], v[132:135], v[32:35], v[172:175]
    v_mfma_f32_16x16x32_bf16 v[176:179], v[136:139], v[32:35], v[176:179]
    v_mfma_f32_16x16x32_bf16 v[180:183], v[140:143], v[32:35], v[180:183]
    v_mfma_f32_16x16x32_bf16 v[184:187], v[144:147], v[32:35], v[184:187]
    v_mfma_f32_16x16x32_bf16 v[188:191], v[148:151], v[32:35], v[188:191]
    ds_read_b64_tr_b16 v[116:117], v30 offset:29184
    ds_read_b64_tr_b16 v[118:119], v30 offset:30336
    ds_read_b64_tr_b16 v[120:121], v30 offset:29216
    ds_read_b64_tr_b16 v[122:123], v30 offset:30368
    ds_read_b64_tr_b16 v[124:125], v30 offset:29248
    ds_read_b64_tr_b16 v[126:127], v30 offset:30400
    ds_read_b64_tr_b16 v[128:129], v30 offset:29280
    ds_read_b64_tr_b16 v[130:131], v30 offset:30432
    ds_read_b64_tr_b16 v[132:133], v30 offset:29312
    ds_read_b64_tr_b16 v[134:135], v30 offset:30464
    ds_read_b64_tr_b16 v[136:137], v30 offset:29344
    ds_read_b64_tr_b16 v[138:139], v30 offset:30496
    ds_read_b64_tr_b16 v[140:141], v30 offset:29376
    ds_read_b64_tr_b16 v[142:143], v30 offset:30528
    ds_read_b64_tr_b16 v[144:145], v30 offset:29408
    ds_read_b64_tr_b16 v[146:147], v30 offset:30560
    ds_read_b64_tr_b16 v[148:149], v30 offset:29440
    ds_read_b64_tr_b16 v[150:151], v30 offset:30592
    s_waitcnt lgkmcnt(0)
    v_mfma_f32_16x16x32_bf16 v[156:159], v[116:119], v[36:39], v[156:159]
    v_mfma_f32_16x16x32_bf16 v[160:163], v[120:123], v[36:39], v[160:163]
    v_mfma_f32_16x16x32_bf16 v[164:167], v[124:127], v[36:39], v[164:167]
    v_mfma_f32_16x16x32_bf16 v[168:171], v[128:131], v[36:39], v[168:171]
    v_mfma_f32_16x16x32_bf16 v[172:175], v[132:135], v[36:39], v[172:175]
    v_mfma_f32_16x16x32_bf16 v[176:179], v[136:139], v[36:39], v[176:179]
    v_mfma_f32_16x16x32_bf16 v[180:183], v[140:143], v[36:39], v[180:183]
    v_mfma_f32_16x16x32_bf16 v[184:187], v[144:147], v[36:39], v[184:187]
    v_mfma_f32_16x16x32_bf16 v[188:191], v[148:151], v[36:39], v[188:191]
    s_waitcnt vmcnt(13)
    ds_write_b64 v21, v[80:81] offset:0
    ds_write_b64 v22, v[82:83] offset:0
    ds_write_b64 v23, v[84:85] offset:0
    ds_write_b64 v24, v[86:87] offset:0
    ds_write_b64 v25, v[88:89] offset:0
    ds_write_b64 v26, v[90:91] offset:0
    ds_write_b64 v27, v[92:93] offset:0
    ds_write_b64 v28, v[94:95] offset:0
    ds_write_b64 v29, v[96:97] offset:0
    s_waitcnt lgkmcnt(0)
    s_barrier
    s_add_u32 s29, s28, 442368
    buffer_load_dwordx2 v[80:81], v12, s[12:15], s29 offen
    buffer_load_dwordx2 v[82:83], v13, s[12:15], s29 offen
    buffer_load_dwordx2 v[84:85], v14, s[12:15], s29 offen
    buffer_load_dwordx2 v[86:87], v15, s[12:15], s29 offen
    buffer_load_dwordx2 v[88:89], v16, s[12:15], s29 offen
    buffer_load_dwordx2 v[90:91], v17, s[12:15], s29 offen
    buffer_load_dwordx2 v[92:93], v18, s[12:15], s29 offen
    buffer_load_dwordx2 v[94:95], v19, s[12:15], s29 offen
    buffer_load_dwordx2 v[96:97], v20, s[12:15], s29 offen
    s_add_u32 s30, s27, 768
    buffer_load_dwordx4 v[32:35], v10, s[8:11], s30 offen offset:0
    buffer_load_dwordx4 v[36:39], v10, s[8:11], s30 offen offset:64
    ds_read_b64_tr_b16 v[116:117], v30 offset:0
    ds_read_b64_tr_b16 v[118:119], v30 offset:1152
    ds_read_b64_tr_b16 v[120:121], v30 offset:32
    ds_read_b64_tr_b16 v[122:123], v30 offset:1184
    ds_read_b64_tr_b16 v[124:125], v30 offset:64
    ds_read_b64_tr_b16 v[126:127], v30 offset:1216
    ds_read_b64_tr_b16 v[128:129], v30 offset:96
    ds_read_b64_tr_b16 v[130:131], v30 offset:1248
    ds_read_b64_tr_b16 v[132:133], v30 offset:128
    ds_read_b64_tr_b16 v[134:135], v30 offset:1280
    ds_read_b64_tr_b16 v[136:137], v30 offset:160
    ds_read_b64_tr_b16 v[138:139], v30 offset:1312
    ds_read_b64_tr_b16 v[140:141], v30 offset:192
    ds_read_b64_tr_b16 v[142:143], v30 offset:1344
    ds_read_b64_tr_b16 v[144:145], v30 offset:224
    ds_read_b64_tr_b16 v[146:147], v30 offset:1376
    ds_read_b64_tr_b16 v[148:149], v30 offset:256
    ds_read_b64_tr_b16 v[150:151], v30 offset:1408
    s_waitcnt vmcnt(22)
    s_waitcnt lgkmcnt(0)
    v_mfma_f32_16x16x32_bf16 v[156:159], v[116:119], v[40:43], v[156:159]
    v_mfma_f32_16x16x32_bf16 v[160:163], v[120:123], v[40:43], v[160:163]
    v_mfma_f32_16x16x32_bf16 v[164:167], v[124:127], v[40:43], v[164:167]
    v_mfma_f32_16x16x32_bf16 v[168:171], v[128:131], v[40:43], v[168:171]
    v_mfma_f32_16x16x32_bf16 v[172:175], v[132:135], v[40:43], v[172:175]
    v_mfma_f32_16x16x32_bf16 v[176:179], v[136:139], v[40:43], v[176:179]
    v_mfma_f32_16x16x32_bf16 v[180:183], v[140:143], v[40:43], v[180:183]
    v_mfma_f32_16x16x32_bf16 v[184:187], v[144:147], v[40:43], v[184:187]
    v_mfma_f32_16x16x32_bf16 v[188:191], v[148:151], v[40:43], v[188:191]
    ds_read_b64_tr_b16 v[116:117], v30 offset:9728
    ds_read_b64_tr_b16 v[118:119], v30 offset:10880
    ds_read_b64_tr_b16 v[120:121], v30 offset:9760
    ds_read_b64_tr_b16 v[122:123], v30 offset:10912
    ds_read_b64_tr_b16 v[124:125], v30 offset:9792
    ds_read_b64_tr_b16 v[126:127], v30 offset:10944
    ds_read_b64_tr_b16 v[128:129], v30 offset:9824
    ds_read_b64_tr_b16 v[130:131], v30 offset:10976
    ds_read_b64_tr_b16 v[132:133], v30 offset:9856
    ds_read_b64_tr_b16 v[134:135], v30 offset:11008
    ds_read_b64_tr_b16 v[136:137], v30 offset:9888
    ds_read_b64_tr_b16 v[138:139], v30 offset:11040
    ds_read_b64_tr_b16 v[140:141], v30 offset:9920
    ds_read_b64_tr_b16 v[142:143], v30 offset:11072
    ds_read_b64_tr_b16 v[144:145], v30 offset:9952
    ds_read_b64_tr_b16 v[146:147], v30 offset:11104
    ds_read_b64_tr_b16 v[148:149], v30 offset:9984
    ds_read_b64_tr_b16 v[150:151], v30 offset:11136
    s_waitcnt lgkmcnt(0)
    v_mfma_f32_16x16x32_bf16 v[156:159], v[116:119], v[44:47], v[156:159]
    v_mfma_f32_16x16x32_bf16 v[160:163], v[120:123], v[44:47], v[160:163]
    v_mfma_f32_16x16x32_bf16 v[164:167], v[124:127], v[44:47], v[164:167]
    v_mfma_f32_16x16x32_bf16 v[168:171], v[128:131], v[44:47], v[168:171]
    v_mfma_f32_16x16x32_bf16 v[172:175], v[132:135], v[44:47], v[172:175]
    v_mfma_f32_16x16x32_bf16 v[176:179], v[136:139], v[44:47], v[176:179]
    v_mfma_f32_16x16x32_bf16 v[180:183], v[140:143], v[44:47], v[180:183]
    v_mfma_f32_16x16x32_bf16 v[184:187], v[144:147], v[44:47], v[184:187]
    v_mfma_f32_16x16x32_bf16 v[188:191], v[148:151], v[44:47], v[188:191]
    s_waitcnt vmcnt(13)
    ds_write_b64 v21, v[98:99] offset:19456
    ds_write_b64 v22, v[100:101] offset:19456
    ds_write_b64 v23, v[102:103] offset:19456
    ds_write_b64 v24, v[104:105] offset:19456
    ds_write_b64 v25, v[106:107] offset:19456
    ds_write_b64 v26, v[108:109] offset:19456
    ds_write_b64 v27, v[110:111] offset:19456
    ds_write_b64 v28, v[112:113] offset:19456
    ds_write_b64 v29, v[114:115] offset:19456
    s_waitcnt lgkmcnt(0)
    s_barrier
    s_add_u32 s29, s28, 516096
    buffer_load_dwordx2 v[98:99], v12, s[12:15], s29 offen
    buffer_load_dwordx2 v[100:101], v13, s[12:15], s29 offen
    buffer_load_dwordx2 v[102:103], v14, s[12:15], s29 offen
    buffer_load_dwordx2 v[104:105], v15, s[12:15], s29 offen
    buffer_load_dwordx2 v[106:107], v16, s[12:15], s29 offen
    buffer_load_dwordx2 v[108:109], v17, s[12:15], s29 offen
    buffer_load_dwordx2 v[110:111], v18, s[12:15], s29 offen
    buffer_load_dwordx2 v[112:113], v19, s[12:15], s29 offen
    buffer_load_dwordx2 v[114:115], v20, s[12:15], s29 offen
    s_add_u32 s30, s27, 896
    buffer_load_dwordx4 v[40:43], v10, s[8:11], s30 offen offset:0
    buffer_load_dwordx4 v[44:47], v10, s[8:11], s30 offen offset:64
    ds_read_b64_tr_b16 v[116:117], v30 offset:19456
    ds_read_b64_tr_b16 v[118:119], v30 offset:20608
    ds_read_b64_tr_b16 v[120:121], v30 offset:19488
    ds_read_b64_tr_b16 v[122:123], v30 offset:20640
    ds_read_b64_tr_b16 v[124:125], v30 offset:19520
    ds_read_b64_tr_b16 v[126:127], v30 offset:20672
    ds_read_b64_tr_b16 v[128:129], v30 offset:19552
    ds_read_b64_tr_b16 v[130:131], v30 offset:20704
    ds_read_b64_tr_b16 v[132:133], v30 offset:19584
    ds_read_b64_tr_b16 v[134:135], v30 offset:20736
    ds_read_b64_tr_b16 v[136:137], v30 offset:19616
    ds_read_b64_tr_b16 v[138:139], v30 offset:20768
    ds_read_b64_tr_b16 v[140:141], v30 offset:19648
    ds_read_b64_tr_b16 v[142:143], v30 offset:20800
    ds_read_b64_tr_b16 v[144:145], v30 offset:19680
    ds_read_b64_tr_b16 v[146:147], v30 offset:20832
    ds_read_b64_tr_b16 v[148:149], v30 offset:19712
    ds_read_b64_tr_b16 v[150:151], v30 offset:20864
    s_waitcnt vmcnt(22)
    s_waitcnt lgkmcnt(0)
    v_mfma_f32_16x16x32_bf16 v[156:159], v[116:119], v[48:51], v[156:159]
    v_mfma_f32_16x16x32_bf16 v[160:163], v[120:123], v[48:51], v[160:163]
    v_mfma_f32_16x16x32_bf16 v[164:167], v[124:127], v[48:51], v[164:167]
    v_mfma_f32_16x16x32_bf16 v[168:171], v[128:131], v[48:51], v[168:171]
    v_mfma_f32_16x16x32_bf16 v[172:175], v[132:135], v[48:51], v[172:175]
    v_mfma_f32_16x16x32_bf16 v[176:179], v[136:139], v[48:51], v[176:179]
    v_mfma_f32_16x16x32_bf16 v[180:183], v[140:143], v[48:51], v[180:183]
    v_mfma_f32_16x16x32_bf16 v[184:187], v[144:147], v[48:51], v[184:187]
    v_mfma_f32_16x16x32_bf16 v[188:191], v[148:151], v[48:51], v[188:191]
    ds_read_b64_tr_b16 v[116:117], v30 offset:29184
    ds_read_b64_tr_b16 v[118:119], v30 offset:30336
    ds_read_b64_tr_b16 v[120:121], v30 offset:29216
    ds_read_b64_tr_b16 v[122:123], v30 offset:30368
    ds_read_b64_tr_b16 v[124:125], v30 offset:29248
    ds_read_b64_tr_b16 v[126:127], v30 offset:30400
    ds_read_b64_tr_b16 v[128:129], v30 offset:29280
    ds_read_b64_tr_b16 v[130:131], v30 offset:30432
    ds_read_b64_tr_b16 v[132:133], v30 offset:29312
    ds_read_b64_tr_b16 v[134:135], v30 offset:30464
    ds_read_b64_tr_b16 v[136:137], v30 offset:29344
    ds_read_b64_tr_b16 v[138:139], v30 offset:30496
    ds_read_b64_tr_b16 v[140:141], v30 offset:29376
    ds_read_b64_tr_b16 v[142:143], v30 offset:30528
    ds_read_b64_tr_b16 v[144:145], v30 offset:29408
    ds_read_b64_tr_b16 v[146:147], v30 offset:30560
    ds_read_b64_tr_b16 v[148:149], v30 offset:29440
    ds_read_b64_tr_b16 v[150:151], v30 offset:30592
    s_waitcnt lgkmcnt(0)
    v_mfma_f32_16x16x32_bf16 v[156:159], v[116:119], v[52:55], v[156:159]
    v_mfma_f32_16x16x32_bf16 v[160:163], v[120:123], v[52:55], v[160:163]
    v_mfma_f32_16x16x32_bf16 v[164:167], v[124:127], v[52:55], v[164:167]
    v_mfma_f32_16x16x32_bf16 v[168:171], v[128:131], v[52:55], v[168:171]
    v_mfma_f32_16x16x32_bf16 v[172:175], v[132:135], v[52:55], v[172:175]
    v_mfma_f32_16x16x32_bf16 v[176:179], v[136:139], v[52:55], v[176:179]
    v_mfma_f32_16x16x32_bf16 v[180:183], v[140:143], v[52:55], v[180:183]
    v_mfma_f32_16x16x32_bf16 v[184:187], v[144:147], v[52:55], v[184:187]
    v_mfma_f32_16x16x32_bf16 v[188:191], v[148:151], v[52:55], v[188:191]
    s_waitcnt vmcnt(13)
    ds_write_b64 v21, v[80:81] offset:0
    ds_write_b64 v22, v[82:83] offset:0
    ds_write_b64 v23, v[84:85] offset:0
    ds_write_b64 v24, v[86:87] offset:0
    ds_write_b64 v25, v[88:89] offset:0
    ds_write_b64 v26, v[90:91] offset:0
    ds_write_b64 v27, v[92:93] offset:0
    ds_write_b64 v28, v[94:95] offset:0
    ds_write_b64 v29, v[96:97] offset:0
    s_waitcnt lgkmcnt(0)
    s_barrier
    s_add_u32 s29, s28, 589824
    buffer_load_dwordx2 v[80:81], v12, s[12:15], s29 offen
    buffer_load_dwordx2 v[82:83], v13, s[12:15], s29 offen
    buffer_load_dwordx2 v[84:85], v14, s[12:15], s29 offen
    buffer_load_dwordx2 v[86:87], v15, s[12:15], s29 offen
    buffer_load_dwordx2 v[88:89], v16, s[12:15], s29 offen
    buffer_load_dwordx2 v[90:91], v17, s[12:15], s29 offen
    buffer_load_dwordx2 v[92:93], v18, s[12:15], s29 offen
    buffer_load_dwordx2 v[94:95], v19, s[12:15], s29 offen
    buffer_load_dwordx2 v[96:97], v20, s[12:15], s29 offen
    s_add_u32 s30, s27, 1024
    buffer_load_dwordx4 v[48:51], v10, s[8:11], s30 offen offset:0
    buffer_load_dwordx4 v[52:55], v10, s[8:11], s30 offen offset:64
    ds_read_b64_tr_b16 v[116:117], v30 offset:0
    ds_read_b64_tr_b16 v[118:119], v30 offset:1152
    ds_read_b64_tr_b16 v[120:121], v30 offset:32
    ds_read_b64_tr_b16 v[122:123], v30 offset:1184
    ds_read_b64_tr_b16 v[124:125], v30 offset:64
    ds_read_b64_tr_b16 v[126:127], v30 offset:1216
    ds_read_b64_tr_b16 v[128:129], v30 offset:96
    ds_read_b64_tr_b16 v[130:131], v30 offset:1248
    ds_read_b64_tr_b16 v[132:133], v30 offset:128
    ds_read_b64_tr_b16 v[134:135], v30 offset:1280
    ds_read_b64_tr_b16 v[136:137], v30 offset:160
    ds_read_b64_tr_b16 v[138:139], v30 offset:1312
    ds_read_b64_tr_b16 v[140:141], v30 offset:192
    ds_read_b64_tr_b16 v[142:143], v30 offset:1344
    ds_read_b64_tr_b16 v[144:145], v30 offset:224
    ds_read_b64_tr_b16 v[146:147], v30 offset:1376
    ds_read_b64_tr_b16 v[148:149], v30 offset:256
    ds_read_b64_tr_b16 v[150:151], v30 offset:1408
    s_waitcnt vmcnt(22)
    s_waitcnt lgkmcnt(0)
    v_mfma_f32_16x16x32_bf16 v[156:159], v[116:119], v[32:35], v[156:159]
    v_mfma_f32_16x16x32_bf16 v[160:163], v[120:123], v[32:35], v[160:163]
    v_mfma_f32_16x16x32_bf16 v[164:167], v[124:127], v[32:35], v[164:167]
    v_mfma_f32_16x16x32_bf16 v[168:171], v[128:131], v[32:35], v[168:171]
    v_mfma_f32_16x16x32_bf16 v[172:175], v[132:135], v[32:35], v[172:175]
    v_mfma_f32_16x16x32_bf16 v[176:179], v[136:139], v[32:35], v[176:179]
    v_mfma_f32_16x16x32_bf16 v[180:183], v[140:143], v[32:35], v[180:183]
    v_mfma_f32_16x16x32_bf16 v[184:187], v[144:147], v[32:35], v[184:187]
    v_mfma_f32_16x16x32_bf16 v[188:191], v[148:151], v[32:35], v[188:191]
    ds_read_b64_tr_b16 v[116:117], v30 offset:9728
    ds_read_b64_tr_b16 v[118:119], v30 offset:10880
    ds_read_b64_tr_b16 v[120:121], v30 offset:9760
    ds_read_b64_tr_b16 v[122:123], v30 offset:10912
    ds_read_b64_tr_b16 v[124:125], v30 offset:9792
    ds_read_b64_tr_b16 v[126:127], v30 offset:10944
    ds_read_b64_tr_b16 v[128:129], v30 offset:9824
    ds_read_b64_tr_b16 v[130:131], v30 offset:10976
    ds_read_b64_tr_b16 v[132:133], v30 offset:9856
    ds_read_b64_tr_b16 v[134:135], v30 offset:11008
    ds_read_b64_tr_b16 v[136:137], v30 offset:9888
    ds_read_b64_tr_b16 v[138:139], v30 offset:11040
    ds_read_b64_tr_b16 v[140:141], v30 offset:9920
    ds_read_b64_tr_b16 v[142:143], v30 offset:11072
    ds_read_b64_tr_b16 v[144:145], v30 offset:9952
    ds_read_b64_tr_b16 v[146:147], v30 offset:11104
    ds_read_b64_tr_b16 v[148:149], v30 offset:9984
    ds_read_b64_tr_b16 v[150:151], v30 offset:11136
    s_waitcnt lgkmcnt(0)
    v_mfma_f32_16x16x32_bf16 v[156:159], v[116:119], v[36:39], v[156:159]
    v_mfma_f32_16x16x32_bf16 v[160:163], v[120:123], v[36:39], v[160:163]
    v_mfma_f32_16x16x32_bf16 v[164:167], v[124:127], v[36:39], v[164:167]
    v_mfma_f32_16x16x32_bf16 v[168:171], v[128:131], v[36:39], v[168:171]
    v_mfma_f32_16x16x32_bf16 v[172:175], v[132:135], v[36:39], v[172:175]
    v_mfma_f32_16x16x32_bf16 v[176:179], v[136:139], v[36:39], v[176:179]
    v_mfma_f32_16x16x32_bf16 v[180:183], v[140:143], v[36:39], v[180:183]
    v_mfma_f32_16x16x32_bf16 v[184:187], v[144:147], v[36:39], v[184:187]
    v_mfma_f32_16x16x32_bf16 v[188:191], v[148:151], v[36:39], v[188:191]
    s_waitcnt vmcnt(13)
    ds_write_b64 v21, v[98:99] offset:19456
    ds_write_b64 v22, v[100:101] offset:19456
    ds_write_b64 v23, v[102:103] offset:19456
    ds_write_b64 v24, v[104:105] offset:19456
    ds_write_b64 v25, v[106:107] offset:19456
    ds_write_b64 v26, v[108:109] offset:19456
    ds_write_b64 v27, v[110:111] offset:19456
    ds_write_b64 v28, v[112:113] offset:19456
    ds_write_b64 v29, v[114:115] offset:19456
    s_waitcnt lgkmcnt(0)
    s_barrier
    ds_read_b64_tr_b16 v[116:117], v30 offset:19456
    ds_read_b64_tr_b16 v[118:119], v30 offset:20608
    ds_read_b64_tr_b16 v[120:121], v30 offset:19488
    ds_read_b64_tr_b16 v[122:123], v30 offset:20640
    ds_read_b64_tr_b16 v[124:125], v30 offset:19520
    ds_read_b64_tr_b16 v[126:127], v30 offset:20672
    ds_read_b64_tr_b16 v[128:129], v30 offset:19552
    ds_read_b64_tr_b16 v[130:131], v30 offset:20704
    ds_read_b64_tr_b16 v[132:133], v30 offset:19584
    ds_read_b64_tr_b16 v[134:135], v30 offset:20736
    ds_read_b64_tr_b16 v[136:137], v30 offset:19616
    ds_read_b64_tr_b16 v[138:139], v30 offset:20768
    ds_read_b64_tr_b16 v[140:141], v30 offset:19648
    ds_read_b64_tr_b16 v[142:143], v30 offset:20800
    ds_read_b64_tr_b16 v[144:145], v30 offset:19680
    ds_read_b64_tr_b16 v[146:147], v30 offset:20832
    ds_read_b64_tr_b16 v[148:149], v30 offset:19712
    ds_read_b64_tr_b16 v[150:151], v30 offset:20864
    s_waitcnt vmcnt(11)
    s_waitcnt lgkmcnt(0)
    v_mfma_f32_16x16x32_bf16 v[156:159], v[116:119], v[40:43], v[156:159]
    v_mfma_f32_16x16x32_bf16 v[160:163], v[120:123], v[40:43], v[160:163]
    v_mfma_f32_16x16x32_bf16 v[164:167], v[124:127], v[40:43], v[164:167]
    v_mfma_f32_16x16x32_bf16 v[168:171], v[128:131], v[40:43], v[168:171]
    v_mfma_f32_16x16x32_bf16 v[172:175], v[132:135], v[40:43], v[172:175]
    v_mfma_f32_16x16x32_bf16 v[176:179], v[136:139], v[40:43], v[176:179]
    v_mfma_f32_16x16x32_bf16 v[180:183], v[140:143], v[40:43], v[180:183]
    v_mfma_f32_16x16x32_bf16 v[184:187], v[144:147], v[40:43], v[184:187]
    v_mfma_f32_16x16x32_bf16 v[188:191], v[148:151], v[40:43], v[188:191]
    ds_read_b64_tr_b16 v[116:117], v30 offset:29184
    ds_read_b64_tr_b16 v[118:119], v30 offset:30336
    ds_read_b64_tr_b16 v[120:121], v30 offset:29216
    ds_read_b64_tr_b16 v[122:123], v30 offset:30368
    ds_read_b64_tr_b16 v[124:125], v30 offset:29248
    ds_read_b64_tr_b16 v[126:127], v30 offset:30400
    ds_read_b64_tr_b16 v[128:129], v30 offset:29280
    ds_read_b64_tr_b16 v[130:131], v30 offset:30432
    ds_read_b64_tr_b16 v[132:133], v30 offset:29312
    ds_read_b64_tr_b16 v[134:135], v30 offset:30464
    ds_read_b64_tr_b16 v[136:137], v30 offset:29344
    ds_read_b64_tr_b16 v[138:139], v30 offset:30496
    ds_read_b64_tr_b16 v[140:141], v30 offset:29376
    ds_read_b64_tr_b16 v[142:143], v30 offset:30528
    ds_read_b64_tr_b16 v[144:145], v30 offset:29408
    ds_read_b64_tr_b16 v[146:147], v30 offset:30560
    ds_read_b64_tr_b16 v[148:149], v30 offset:29440
    ds_read_b64_tr_b16 v[150:151], v30 offset:30592
    s_waitcnt lgkmcnt(0)
    v_mfma_f32_16x16x32_bf16 v[156:159], v[116:119], v[44:47], v[156:159]
    v_mfma_f32_16x16x32_bf16 v[160:163], v[120:123], v[44:47], v[160:163]
    v_mfma_f32_16x16x32_bf16 v[164:167], v[124:127], v[44:47], v[164:167]
    v_mfma_f32_16x16x32_bf16 v[168:171], v[128:131], v[44:47], v[168:171]
    v_mfma_f32_16x16x32_bf16 v[172:175], v[132:135], v[44:47], v[172:175]
    v_mfma_f32_16x16x32_bf16 v[176:179], v[136:139], v[44:47], v[176:179]
    v_mfma_f32_16x16x32_bf16 v[180:183], v[140:143], v[44:47], v[180:183]
    v_mfma_f32_16x16x32_bf16 v[184:187], v[144:147], v[44:47], v[184:187]
    v_mfma_f32_16x16x32_bf16 v[188:191], v[148:151], v[44:47], v[188:191]
    s_waitcnt vmcnt(2)
    ds_write_b64 v21, v[80:81] offset:0
    ds_write_b64 v22, v[82:83] offset:0
    ds_write_b64 v23, v[84:85] offset:0
    ds_write_b64 v24, v[86:87] offset:0
    ds_write_b64 v25, v[88:89] offset:0
    ds_write_b64 v26, v[90:91] offset:0
    ds_write_b64 v27, v[92:93] offset:0
    ds_write_b64 v28, v[94:95] offset:0
    ds_write_b64 v29, v[96:97] offset:0
    s_waitcnt lgkmcnt(0)
    s_barrier
    ds_read_b64_tr_b16 v[116:117], v30 offset:0
    ds_read_b64_tr_b16 v[118:119], v30 offset:1152
    ds_read_b64_tr_b16 v[120:121], v30 offset:32
    ds_read_b64_tr_b16 v[122:123], v30 offset:1184
    ds_read_b64_tr_b16 v[124:125], v30 offset:64
    ds_read_b64_tr_b16 v[126:127], v30 offset:1216
    ds_read_b64_tr_b16 v[128:129], v30 offset:96
    ds_read_b64_tr_b16 v[130:131], v30 offset:1248
    ds_read_b64_tr_b16 v[132:133], v30 offset:128
    ds_read_b64_tr_b16 v[134:135], v30 offset:1280
    ds_read_b64_tr_b16 v[136:137], v30 offset:160
    ds_read_b64_tr_b16 v[138:139], v30 offset:1312
    ds_read_b64_tr_b16 v[140:141], v30 offset:192
    ds_read_b64_tr_b16 v[142:143], v30 offset:1344
    ds_read_b64_tr_b16 v[144:145], v30 offset:224
    ds_read_b64_tr_b16 v[146:147], v30 offset:1376
    ds_read_b64_tr_b16 v[148:149], v30 offset:256
    ds_read_b64_tr_b16 v[150:151], v30 offset:1408
    s_waitcnt vmcnt(0)
    s_waitcnt lgkmcnt(0)
    v_mfma_f32_16x16x32_bf16 v[156:159], v[116:119], v[48:51], v[156:159]
    v_mfma_f32_16x16x32_bf16 v[160:163], v[120:123], v[48:51], v[160:163]
    v_mfma_f32_16x16x32_bf16 v[164:167], v[124:127], v[48:51], v[164:167]
    v_mfma_f32_16x16x32_bf16 v[168:171], v[128:131], v[48:51], v[168:171]
    v_mfma_f32_16x16x32_bf16 v[172:175], v[132:135], v[48:51], v[172:175]
    v_mfma_f32_16x16x32_bf16 v[176:179], v[136:139], v[48:51], v[176:179]
    v_mfma_f32_16x16x32_bf16 v[180:183], v[140:143], v[48:51], v[180:183]
    v_mfma_f32_16x16x32_bf16 v[184:187], v[144:147], v[48:51], v[184:187]
    v_mfma_f32_16x16x32_bf16 v[188:191], v[148:151], v[48:51], v[188:191]
    ds_read_b64_tr_b16 v[116:117], v30 offset:9728
    ds_read_b64_tr_b16 v[118:119], v30 offset:10880
    ds_read_b64_tr_b16 v[120:121], v30 offset:9760
    ds_read_b64_tr_b16 v[122:123], v30 offset:10912
    ds_read_b64_tr_b16 v[124:125], v30 offset:9792
    ds_read_b64_tr_b16 v[126:127], v30 offset:10944
    ds_read_b64_tr_b16 v[128:129], v30 offset:9824
    ds_read_b64_tr_b16 v[130:131], v30 offset:10976
    ds_read_b64_tr_b16 v[132:133], v30 offset:9856
    ds_read_b64_tr_b16 v[134:135], v30 offset:11008
    ds_read_b64_tr_b16 v[136:137], v30 offset:9888
    ds_read_b64_tr_b16 v[138:139], v30 offset:11040
    ds_read_b64_tr_b16 v[140:141], v30 offset:9920
    ds_read_b64_tr_b16 v[142:143], v30 offset:11072
    ds_read_b64_tr_b16 v[144:145], v30 offset:9952
    ds_read_b64_tr_b16 v[146:147], v30 offset:11104
    ds_read_b64_tr_b16 v[148:149], v30 offset:9984
    ds_read_b64_tr_b16 v[150:151], v30 offset:11136
    s_waitcnt lgkmcnt(0)
    v_mfma_f32_16x16x32_bf16 v[156:159], v[116:119], v[52:55], v[156:159]
    v_mfma_f32_16x16x32_bf16 v[160:163], v[120:123], v[52:55], v[160:163]
    v_mfma_f32_16x16x32_bf16 v[164:167], v[124:127], v[52:55], v[164:167]
    v_mfma_f32_16x16x32_bf16 v[168:171], v[128:131], v[52:55], v[168:171]
    v_mfma_f32_16x16x32_bf16 v[172:175], v[132:135], v[52:55], v[172:175]
    v_mfma_f32_16x16x32_bf16 v[176:179], v[136:139], v[52:55], v[176:179]
    v_mfma_f32_16x16x32_bf16 v[180:183], v[140:143], v[52:55], v[180:183]
    v_mfma_f32_16x16x32_bf16 v[184:187], v[144:147], v[52:55], v[184:187]
    v_mfma_f32_16x16x32_bf16 v[188:191], v[148:151], v[52:55], v[188:191]
    s_nop 15
    s_nop 3
    s_load_dwordx2 s[36:37], s[0:1], 0
    s_load_dwordx2 s[38:39], s[0:1], 72
    s_load_dwordx2 s[40:41], s[0:1], 64
    s_add_u32 s32, s16, 50331648
    s_addc_u32 s33, s17, 0
    s_mov_b32 s34, 18874368
    s_mov_b32 s35, 0x00020000
    s_mul_i32 s31, s22, 288
    v_mul_u32_u24 v7, 8, v4
    v_add_u32 v7, s31, v7
    s_mov_b32 s25, 1152
    v_add_u32 v6, 0, v5
    v_mul_lo_u32 v6, v6, s25
    v_add_u32 v60, v6, v7
    s_mul_i32 s31, s22, 288
    v_lshlrev_b32 v8, 3, v4
    s_waitcnt lgkmcnt(0)
    s_mov_b32 s44, s36
    s_mov_b32 s45, s37
    s_mov_b32 s46, 2359296
    s_mov_b32 s47, 0x00020000
    s_mov_b32 s48, s38
    s_mov_b32 s49, s39
    s_mov_b32 s50, 2359296
    s_mov_b32 s51, 0x00020000
    s_mov_b32 s52, s40
    s_mov_b32 s53, s41
    s_mov_b32 s54, 1152
    s_mov_b32 s55, 0x00020000
    buffer_load_dwordx2 v[64:65], v8, s[52:55], s31 offen offset:0
    buffer_load_dwordx2 v[66:67], v8, s[52:55], s31 offen offset:32
    buffer_load_dwordx2 v[68:69], v8, s[52:55], s31 offen offset:64
    buffer_load_dwordx2 v[70:71], v8, s[52:55], s31 offen offset:96
    buffer_load_dwordx2 v[72:73], v8, s[52:55], s31 offen offset:128
    buffer_load_dwordx2 v[74:75], v8, s[52:55], s31 offen offset:160
    buffer_load_dwordx2 v[76:77], v8, s[52:55], s31 offen offset:192
    buffer_load_dwordx2 v[78:79], v8, s[52:55], s31 offen offset:224
    buffer_load_dwordx2 v[80:81], v8, s[52:55], s31 offen offset:256
    v_lshlrev_b32 v62, 1, v60
    s_mov_b32 s56, 0
    buffer_load_dwordx4 v[84:87], v62, s[32:35], s56 offen offset:0
    s_mov_b32 s56, 4718592
    buffer_load_dwordx4 v[88:91], v62, s[32:35], s56 offen offset:0
    s_mov_b32 s56, 9437184
    buffer_load_dwordx4 v[92:95], v62, s[32:35], s56 offen offset:0
    s_mov_b32 s56, 14155776
    buffer_load_dwordx4 v[96:99], v62, s[32:35], s56 offen offset:0
    buffer_load_dwordx2 v[100:101], v60, s[44:47], 0 offen offset:0
    s_waitcnt vmcnt(0)
    v_add_f32 v84, v84, v88
    v_add_f32 v92, v92, v96
    v_add_f32 v84, v84, v92
    v_add_f32 v85, v85, v89
    v_add_f32 v93, v93, v97
    v_add_f32 v85, v85, v93
    v_add_f32 v86, v86, v90
    v_add_f32 v94, v94, v98
    v_add_f32 v86, v86, v94
    v_add_f32 v87, v87, v91
    v_add_f32 v95, v95, v99
    v_add_f32 v87, v87, v95
    v_lshlrev_b32 v88, 16, v64
    v_and_b32 v89, 0xffff0000, v64
    v_lshlrev_b32 v90, 16, v65
    v_and_b32 v91, 0xffff0000, v65
    v_add_f32 v84, v84, v88
    v_add_f32 v85, v85, v89
    v_add_f32 v86, v86, v90
    v_add_f32 v87, v87, v91
    v_mul_f32 v88, 0xbfb8aa3b, v84
    v_mul_f32 v89, 0xbfb8aa3b, v85
    v_mul_f32 v90, 0xbfb8aa3b, v86
    v_mul_f32 v91, 0xbfb8aa3b, v87
    v_exp_f32 v88, v88
    v_exp_f32 v89, v89
    v_exp_f32 v90, v90
    v_exp_f32 v91, v91
    v_add_f32 v88, 1.0, v88
    v_add_f32 v89, 1.0, v89
    v_add_f32 v90, 1.0, v90
    v_add_f32 v91, 1.0, v91
    v_rcp_f32 v88, v88
    v_rcp_f32 v89, v89
    v_rcp_f32 v90, v90
    v_rcp_f32 v91, v91
    v_mul_f32 v84, v84, v88
    v_mul_f32 v85, v85, v89
    v_mul_f32 v86, v86, v90
    v_mul_f32 v87, v87, v91
    v_lshlrev_b32 v88, 16, v100
    v_and_b32 v89, 0xffff0000, v100
    v_lshlrev_b32 v90, 16, v101
    v_and_b32 v91, 0xffff0000, v101
    v_fma_f32 v156, v156, v84, v88
    v_fma_f32 v157, v157, v85, v89
    v_fma_f32 v158, v158, v86, v90
    v_fma_f32 v159, v159, v87, v91
    v_cvt_pk_bf16_f32 v156, v156, v157
    v_cvt_pk_bf16_f32 v157, v158, v159
    buffer_store_dwordx2 v[156:157], v60, s[48:51], 0 offen offset:0
    s_mov_b32 s56, 0
    buffer_load_dwordx4 v[84:87], v62, s[32:35], s56 offen offset:64
    s_mov_b32 s56, 4718592
    buffer_load_dwordx4 v[88:91], v62, s[32:35], s56 offen offset:64
    s_mov_b32 s56, 9437184
    buffer_load_dwordx4 v[92:95], v62, s[32:35], s56 offen offset:64
    s_mov_b32 s56, 14155776
    buffer_load_dwordx4 v[96:99], v62, s[32:35], s56 offen offset:64
    buffer_load_dwordx2 v[100:101], v60, s[44:47], 0 offen offset:32
    s_waitcnt vmcnt(0)
    v_add_f32 v84, v84, v88
    v_add_f32 v92, v92, v96
    v_add_f32 v84, v84, v92
    v_add_f32 v85, v85, v89
    v_add_f32 v93, v93, v97
    v_add_f32 v85, v85, v93
    v_add_f32 v86, v86, v90
    v_add_f32 v94, v94, v98
    v_add_f32 v86, v86, v94
    v_add_f32 v87, v87, v91
    v_add_f32 v95, v95, v99
    v_add_f32 v87, v87, v95
    v_lshlrev_b32 v88, 16, v66
    v_and_b32 v89, 0xffff0000, v66
    v_lshlrev_b32 v90, 16, v67
    v_and_b32 v91, 0xffff0000, v67
    v_add_f32 v84, v84, v88
    v_add_f32 v85, v85, v89
    v_add_f32 v86, v86, v90
    v_add_f32 v87, v87, v91
    v_mul_f32 v88, 0xbfb8aa3b, v84
    v_mul_f32 v89, 0xbfb8aa3b, v85
    v_mul_f32 v90, 0xbfb8aa3b, v86
    v_mul_f32 v91, 0xbfb8aa3b, v87
    v_exp_f32 v88, v88
    v_exp_f32 v89, v89
    v_exp_f32 v90, v90
    v_exp_f32 v91, v91
    v_add_f32 v88, 1.0, v88
    v_add_f32 v89, 1.0, v89
    v_add_f32 v90, 1.0, v90
    v_add_f32 v91, 1.0, v91
    v_rcp_f32 v88, v88
    v_rcp_f32 v89, v89
    v_rcp_f32 v90, v90
    v_rcp_f32 v91, v91
    v_mul_f32 v84, v84, v88
    v_mul_f32 v85, v85, v89
    v_mul_f32 v86, v86, v90
    v_mul_f32 v87, v87, v91
    v_lshlrev_b32 v88, 16, v100
    v_and_b32 v89, 0xffff0000, v100
    v_lshlrev_b32 v90, 16, v101
    v_and_b32 v91, 0xffff0000, v101
    v_fma_f32 v160, v160, v84, v88
    v_fma_f32 v161, v161, v85, v89
    v_fma_f32 v162, v162, v86, v90
    v_fma_f32 v163, v163, v87, v91
    v_cvt_pk_bf16_f32 v160, v160, v161
    v_cvt_pk_bf16_f32 v161, v162, v163
    buffer_store_dwordx2 v[160:161], v60, s[48:51], 0 offen offset:32
    s_mov_b32 s56, 0
    buffer_load_dwordx4 v[84:87], v62, s[32:35], s56 offen offset:128
    s_mov_b32 s56, 4718592
    buffer_load_dwordx4 v[88:91], v62, s[32:35], s56 offen offset:128
    s_mov_b32 s56, 9437184
    buffer_load_dwordx4 v[92:95], v62, s[32:35], s56 offen offset:128
    s_mov_b32 s56, 14155776
    buffer_load_dwordx4 v[96:99], v62, s[32:35], s56 offen offset:128
    buffer_load_dwordx2 v[100:101], v60, s[44:47], 0 offen offset:64
    s_waitcnt vmcnt(0)
    v_add_f32 v84, v84, v88
    v_add_f32 v92, v92, v96
    v_add_f32 v84, v84, v92
    v_add_f32 v85, v85, v89
    v_add_f32 v93, v93, v97
    v_add_f32 v85, v85, v93
    v_add_f32 v86, v86, v90
    v_add_f32 v94, v94, v98
    v_add_f32 v86, v86, v94
    v_add_f32 v87, v87, v91
    v_add_f32 v95, v95, v99
    v_add_f32 v87, v87, v95
    v_lshlrev_b32 v88, 16, v68
    v_and_b32 v89, 0xffff0000, v68
    v_lshlrev_b32 v90, 16, v69
    v_and_b32 v91, 0xffff0000, v69
    v_add_f32 v84, v84, v88
    v_add_f32 v85, v85, v89
    v_add_f32 v86, v86, v90
    v_add_f32 v87, v87, v91
    v_mul_f32 v88, 0xbfb8aa3b, v84
    v_mul_f32 v89, 0xbfb8aa3b, v85
    v_mul_f32 v90, 0xbfb8aa3b, v86
    v_mul_f32 v91, 0xbfb8aa3b, v87
    v_exp_f32 v88, v88
    v_exp_f32 v89, v89
    v_exp_f32 v90, v90
    v_exp_f32 v91, v91
    v_add_f32 v88, 1.0, v88
    v_add_f32 v89, 1.0, v89
    v_add_f32 v90, 1.0, v90
    v_add_f32 v91, 1.0, v91
    v_rcp_f32 v88, v88
    v_rcp_f32 v89, v89
    v_rcp_f32 v90, v90
    v_rcp_f32 v91, v91
    v_mul_f32 v84, v84, v88
    v_mul_f32 v85, v85, v89
    v_mul_f32 v86, v86, v90
    v_mul_f32 v87, v87, v91
    v_lshlrev_b32 v88, 16, v100
    v_and_b32 v89, 0xffff0000, v100
    v_lshlrev_b32 v90, 16, v101
    v_and_b32 v91, 0xffff0000, v101
    v_fma_f32 v164, v164, v84, v88
    v_fma_f32 v165, v165, v85, v89
    v_fma_f32 v166, v166, v86, v90
    v_fma_f32 v167, v167, v87, v91
    v_cvt_pk_bf16_f32 v164, v164, v165
    v_cvt_pk_bf16_f32 v165, v166, v167
    buffer_store_dwordx2 v[164:165], v60, s[48:51], 0 offen offset:64
    s_mov_b32 s56, 0
    buffer_load_dwordx4 v[84:87], v62, s[32:35], s56 offen offset:192
    s_mov_b32 s56, 4718592
    buffer_load_dwordx4 v[88:91], v62, s[32:35], s56 offen offset:192
    s_mov_b32 s56, 9437184
    buffer_load_dwordx4 v[92:95], v62, s[32:35], s56 offen offset:192
    s_mov_b32 s56, 14155776
    buffer_load_dwordx4 v[96:99], v62, s[32:35], s56 offen offset:192
    buffer_load_dwordx2 v[100:101], v60, s[44:47], 0 offen offset:96
    s_waitcnt vmcnt(0)
    v_add_f32 v84, v84, v88
    v_add_f32 v92, v92, v96
    v_add_f32 v84, v84, v92
    v_add_f32 v85, v85, v89
    v_add_f32 v93, v93, v97
    v_add_f32 v85, v85, v93
    v_add_f32 v86, v86, v90
    v_add_f32 v94, v94, v98
    v_add_f32 v86, v86, v94
    v_add_f32 v87, v87, v91
    v_add_f32 v95, v95, v99
    v_add_f32 v87, v87, v95
    v_lshlrev_b32 v88, 16, v70
    v_and_b32 v89, 0xffff0000, v70
    v_lshlrev_b32 v90, 16, v71
    v_and_b32 v91, 0xffff0000, v71
    v_add_f32 v84, v84, v88
    v_add_f32 v85, v85, v89
    v_add_f32 v86, v86, v90
    v_add_f32 v87, v87, v91
    v_mul_f32 v88, 0xbfb8aa3b, v84
    v_mul_f32 v89, 0xbfb8aa3b, v85
    v_mul_f32 v90, 0xbfb8aa3b, v86
    v_mul_f32 v91, 0xbfb8aa3b, v87
    v_exp_f32 v88, v88
    v_exp_f32 v89, v89
    v_exp_f32 v90, v90
    v_exp_f32 v91, v91
    v_add_f32 v88, 1.0, v88
    v_add_f32 v89, 1.0, v89
    v_add_f32 v90, 1.0, v90
    v_add_f32 v91, 1.0, v91
    v_rcp_f32 v88, v88
    v_rcp_f32 v89, v89
    v_rcp_f32 v90, v90
    v_rcp_f32 v91, v91
    v_mul_f32 v84, v84, v88
    v_mul_f32 v85, v85, v89
    v_mul_f32 v86, v86, v90
    v_mul_f32 v87, v87, v91
    v_lshlrev_b32 v88, 16, v100
    v_and_b32 v89, 0xffff0000, v100
    v_lshlrev_b32 v90, 16, v101
    v_and_b32 v91, 0xffff0000, v101
    v_fma_f32 v168, v168, v84, v88
    v_fma_f32 v169, v169, v85, v89
    v_fma_f32 v170, v170, v86, v90
    v_fma_f32 v171, v171, v87, v91
    v_cvt_pk_bf16_f32 v168, v168, v169
    v_cvt_pk_bf16_f32 v169, v170, v171
    buffer_store_dwordx2 v[168:169], v60, s[48:51], 0 offen offset:96
    s_mov_b32 s56, 0
    buffer_load_dwordx4 v[84:87], v62, s[32:35], s56 offen offset:256
    s_mov_b32 s56, 4718592
    buffer_load_dwordx4 v[88:91], v62, s[32:35], s56 offen offset:256
    s_mov_b32 s56, 9437184
    buffer_load_dwordx4 v[92:95], v62, s[32:35], s56 offen offset:256
    s_mov_b32 s56, 14155776
    buffer_load_dwordx4 v[96:99], v62, s[32:35], s56 offen offset:256
    buffer_load_dwordx2 v[100:101], v60, s[44:47], 0 offen offset:128
    s_waitcnt vmcnt(0)
    v_add_f32 v84, v84, v88
    v_add_f32 v92, v92, v96
    v_add_f32 v84, v84, v92
    v_add_f32 v85, v85, v89
    v_add_f32 v93, v93, v97
    v_add_f32 v85, v85, v93
    v_add_f32 v86, v86, v90
    v_add_f32 v94, v94, v98
    v_add_f32 v86, v86, v94
    v_add_f32 v87, v87, v91
    v_add_f32 v95, v95, v99
    v_add_f32 v87, v87, v95
    v_lshlrev_b32 v88, 16, v72
    v_and_b32 v89, 0xffff0000, v72
    v_lshlrev_b32 v90, 16, v73
    v_and_b32 v91, 0xffff0000, v73
    v_add_f32 v84, v84, v88
    v_add_f32 v85, v85, v89
    v_add_f32 v86, v86, v90
    v_add_f32 v87, v87, v91
    v_mul_f32 v88, 0xbfb8aa3b, v84
    v_mul_f32 v89, 0xbfb8aa3b, v85
    v_mul_f32 v90, 0xbfb8aa3b, v86
    v_mul_f32 v91, 0xbfb8aa3b, v87
    v_exp_f32 v88, v88
    v_exp_f32 v89, v89
    v_exp_f32 v90, v90
    v_exp_f32 v91, v91
    v_add_f32 v88, 1.0, v88
    v_add_f32 v89, 1.0, v89
    v_add_f32 v90, 1.0, v90
    v_add_f32 v91, 1.0, v91
    v_rcp_f32 v88, v88
    v_rcp_f32 v89, v89
    v_rcp_f32 v90, v90
    v_rcp_f32 v91, v91
    v_mul_f32 v84, v84, v88
    v_mul_f32 v85, v85, v89
    v_mul_f32 v86, v86, v90
    v_mul_f32 v87, v87, v91
    v_lshlrev_b32 v88, 16, v100
    v_and_b32 v89, 0xffff0000, v100
    v_lshlrev_b32 v90, 16, v101
    v_and_b32 v91, 0xffff0000, v101
    v_fma_f32 v172, v172, v84, v88
    v_fma_f32 v173, v173, v85, v89
    v_fma_f32 v174, v174, v86, v90
    v_fma_f32 v175, v175, v87, v91
    v_cvt_pk_bf16_f32 v172, v172, v173
    v_cvt_pk_bf16_f32 v173, v174, v175
    buffer_store_dwordx2 v[172:173], v60, s[48:51], 0 offen offset:128
    s_mov_b32 s56, 0
    buffer_load_dwordx4 v[84:87], v62, s[32:35], s56 offen offset:320
    s_mov_b32 s56, 4718592
    buffer_load_dwordx4 v[88:91], v62, s[32:35], s56 offen offset:320
    s_mov_b32 s56, 9437184
    buffer_load_dwordx4 v[92:95], v62, s[32:35], s56 offen offset:320
    s_mov_b32 s56, 14155776
    buffer_load_dwordx4 v[96:99], v62, s[32:35], s56 offen offset:320
    buffer_load_dwordx2 v[100:101], v60, s[44:47], 0 offen offset:160
    s_waitcnt vmcnt(0)
    v_add_f32 v84, v84, v88
    v_add_f32 v92, v92, v96
    v_add_f32 v84, v84, v92
    v_add_f32 v85, v85, v89
    v_add_f32 v93, v93, v97
    v_add_f32 v85, v85, v93
    v_add_f32 v86, v86, v90
    v_add_f32 v94, v94, v98
    v_add_f32 v86, v86, v94
    v_add_f32 v87, v87, v91
    v_add_f32 v95, v95, v99
    v_add_f32 v87, v87, v95
    v_lshlrev_b32 v88, 16, v74
    v_and_b32 v89, 0xffff0000, v74
    v_lshlrev_b32 v90, 16, v75
    v_and_b32 v91, 0xffff0000, v75
    v_add_f32 v84, v84, v88
    v_add_f32 v85, v85, v89
    v_add_f32 v86, v86, v90
    v_add_f32 v87, v87, v91
    v_mul_f32 v88, 0xbfb8aa3b, v84
    v_mul_f32 v89, 0xbfb8aa3b, v85
    v_mul_f32 v90, 0xbfb8aa3b, v86
    v_mul_f32 v91, 0xbfb8aa3b, v87
    v_exp_f32 v88, v88
    v_exp_f32 v89, v89
    v_exp_f32 v90, v90
    v_exp_f32 v91, v91
    v_add_f32 v88, 1.0, v88
    v_add_f32 v89, 1.0, v89
    v_add_f32 v90, 1.0, v90
    v_add_f32 v91, 1.0, v91
    v_rcp_f32 v88, v88
    v_rcp_f32 v89, v89
    v_rcp_f32 v90, v90
    v_rcp_f32 v91, v91
    v_mul_f32 v84, v84, v88
    v_mul_f32 v85, v85, v89
    v_mul_f32 v86, v86, v90
    v_mul_f32 v87, v87, v91
    v_lshlrev_b32 v88, 16, v100
    v_and_b32 v89, 0xffff0000, v100
    v_lshlrev_b32 v90, 16, v101
    v_and_b32 v91, 0xffff0000, v101
    v_fma_f32 v176, v176, v84, v88
    v_fma_f32 v177, v177, v85, v89
    v_fma_f32 v178, v178, v86, v90
    v_fma_f32 v179, v179, v87, v91
    v_cvt_pk_bf16_f32 v176, v176, v177
    v_cvt_pk_bf16_f32 v177, v178, v179
    buffer_store_dwordx2 v[176:177], v60, s[48:51], 0 offen offset:160
    s_mov_b32 s56, 0
    buffer_load_dwordx4 v[84:87], v62, s[32:35], s56 offen offset:384
    s_mov_b32 s56, 4718592
    buffer_load_dwordx4 v[88:91], v62, s[32:35], s56 offen offset:384
    s_mov_b32 s56, 9437184
    buffer_load_dwordx4 v[92:95], v62, s[32:35], s56 offen offset:384
    s_mov_b32 s56, 14155776
    buffer_load_dwordx4 v[96:99], v62, s[32:35], s56 offen offset:384
    buffer_load_dwordx2 v[100:101], v60, s[44:47], 0 offen offset:192
    s_waitcnt vmcnt(0)
    v_add_f32 v84, v84, v88
    v_add_f32 v92, v92, v96
    v_add_f32 v84, v84, v92
    v_add_f32 v85, v85, v89
    v_add_f32 v93, v93, v97
    v_add_f32 v85, v85, v93
    v_add_f32 v86, v86, v90
    v_add_f32 v94, v94, v98
    v_add_f32 v86, v86, v94
    v_add_f32 v87, v87, v91
    v_add_f32 v95, v95, v99
    v_add_f32 v87, v87, v95
    v_lshlrev_b32 v88, 16, v76
    v_and_b32 v89, 0xffff0000, v76
    v_lshlrev_b32 v90, 16, v77
    v_and_b32 v91, 0xffff0000, v77
    v_add_f32 v84, v84, v88
    v_add_f32 v85, v85, v89
    v_add_f32 v86, v86, v90
    v_add_f32 v87, v87, v91
    v_mul_f32 v88, 0xbfb8aa3b, v84
    v_mul_f32 v89, 0xbfb8aa3b, v85
    v_mul_f32 v90, 0xbfb8aa3b, v86
    v_mul_f32 v91, 0xbfb8aa3b, v87
    v_exp_f32 v88, v88
    v_exp_f32 v89, v89
    v_exp_f32 v90, v90
    v_exp_f32 v91, v91
    v_add_f32 v88, 1.0, v88
    v_add_f32 v89, 1.0, v89
    v_add_f32 v90, 1.0, v90
    v_add_f32 v91, 1.0, v91
    v_rcp_f32 v88, v88
    v_rcp_f32 v89, v89
    v_rcp_f32 v90, v90
    v_rcp_f32 v91, v91
    v_mul_f32 v84, v84, v88
    v_mul_f32 v85, v85, v89
    v_mul_f32 v86, v86, v90
    v_mul_f32 v87, v87, v91
    v_lshlrev_b32 v88, 16, v100
    v_and_b32 v89, 0xffff0000, v100
    v_lshlrev_b32 v90, 16, v101
    v_and_b32 v91, 0xffff0000, v101
    v_fma_f32 v180, v180, v84, v88
    v_fma_f32 v181, v181, v85, v89
    v_fma_f32 v182, v182, v86, v90
    v_fma_f32 v183, v183, v87, v91
    v_cvt_pk_bf16_f32 v180, v180, v181
    v_cvt_pk_bf16_f32 v181, v182, v183
    buffer_store_dwordx2 v[180:181], v60, s[48:51], 0 offen offset:192
    s_mov_b32 s56, 0
    buffer_load_dwordx4 v[84:87], v62, s[32:35], s56 offen offset:448
    s_mov_b32 s56, 4718592
    buffer_load_dwordx4 v[88:91], v62, s[32:35], s56 offen offset:448
    s_mov_b32 s56, 9437184
    buffer_load_dwordx4 v[92:95], v62, s[32:35], s56 offen offset:448
    s_mov_b32 s56, 14155776
    buffer_load_dwordx4 v[96:99], v62, s[32:35], s56 offen offset:448
    buffer_load_dwordx2 v[100:101], v60, s[44:47], 0 offen offset:224
    s_waitcnt vmcnt(0)
    v_add_f32 v84, v84, v88
    v_add_f32 v92, v92, v96
    v_add_f32 v84, v84, v92
    v_add_f32 v85, v85, v89
    v_add_f32 v93, v93, v97
    v_add_f32 v85, v85, v93
    v_add_f32 v86, v86, v90
    v_add_f32 v94, v94, v98
    v_add_f32 v86, v86, v94
    v_add_f32 v87, v87, v91
    v_add_f32 v95, v95, v99
    v_add_f32 v87, v87, v95
    v_lshlrev_b32 v88, 16, v78
    v_and_b32 v89, 0xffff0000, v78
    v_lshlrev_b32 v90, 16, v79
    v_and_b32 v91, 0xffff0000, v79
    v_add_f32 v84, v84, v88
    v_add_f32 v85, v85, v89
    v_add_f32 v86, v86, v90
    v_add_f32 v87, v87, v91
    v_mul_f32 v88, 0xbfb8aa3b, v84
    v_mul_f32 v89, 0xbfb8aa3b, v85
    v_mul_f32 v90, 0xbfb8aa3b, v86
    v_mul_f32 v91, 0xbfb8aa3b, v87
    v_exp_f32 v88, v88
    v_exp_f32 v89, v89
    v_exp_f32 v90, v90
    v_exp_f32 v91, v91
    v_add_f32 v88, 1.0, v88
    v_add_f32 v89, 1.0, v89
    v_add_f32 v90, 1.0, v90
    v_add_f32 v91, 1.0, v91
    v_rcp_f32 v88, v88
    v_rcp_f32 v89, v89
    v_rcp_f32 v90, v90
    v_rcp_f32 v91, v91
    v_mul_f32 v84, v84, v88
    v_mul_f32 v85, v85, v89
    v_mul_f32 v86, v86, v90
    v_mul_f32 v87, v87, v91
    v_lshlrev_b32 v88, 16, v100
    v_and_b32 v89, 0xffff0000, v100
    v_lshlrev_b32 v90, 16, v101
    v_and_b32 v91, 0xffff0000, v101
    v_fma_f32 v184, v184, v84, v88
    v_fma_f32 v185, v185, v85, v89
    v_fma_f32 v186, v186, v86, v90
    v_fma_f32 v187, v187, v87, v91
    v_cvt_pk_bf16_f32 v184, v184, v185
    v_cvt_pk_bf16_f32 v185, v186, v187
    buffer_store_dwordx2 v[184:185], v60, s[48:51], 0 offen offset:224
    s_mov_b32 s56, 0
    buffer_load_dwordx4 v[84:87], v62, s[32:35], s56 offen offset:512
    s_mov_b32 s56, 4718592
    buffer_load_dwordx4 v[88:91], v62, s[32:35], s56 offen offset:512
    s_mov_b32 s56, 9437184
    buffer_load_dwordx4 v[92:95], v62, s[32:35], s56 offen offset:512
    s_mov_b32 s56, 14155776
    buffer_load_dwordx4 v[96:99], v62, s[32:35], s56 offen offset:512
    buffer_load_dwordx2 v[100:101], v60, s[44:47], 0 offen offset:256
    s_waitcnt vmcnt(0)
    v_add_f32 v84, v84, v88
    v_add_f32 v92, v92, v96
    v_add_f32 v84, v84, v92
    v_add_f32 v85, v85, v89
    v_add_f32 v93, v93, v97
    v_add_f32 v85, v85, v93
    v_add_f32 v86, v86, v90
    v_add_f32 v94, v94, v98
    v_add_f32 v86, v86, v94
    v_add_f32 v87, v87, v91
    v_add_f32 v95, v95, v99
    v_add_f32 v87, v87, v95
    v_lshlrev_b32 v88, 16, v80
    v_and_b32 v89, 0xffff0000, v80
    v_lshlrev_b32 v90, 16, v81
    v_and_b32 v91, 0xffff0000, v81
    v_add_f32 v84, v84, v88
    v_add_f32 v85, v85, v89
    v_add_f32 v86, v86, v90
    v_add_f32 v87, v87, v91
    v_mul_f32 v88, 0xbfb8aa3b, v84
    v_mul_f32 v89, 0xbfb8aa3b, v85
    v_mul_f32 v90, 0xbfb8aa3b, v86
    v_mul_f32 v91, 0xbfb8aa3b, v87
    v_exp_f32 v88, v88
    v_exp_f32 v89, v89
    v_exp_f32 v90, v90
    v_exp_f32 v91, v91
    v_add_f32 v88, 1.0, v88
    v_add_f32 v89, 1.0, v89
    v_add_f32 v90, 1.0, v90
    v_add_f32 v91, 1.0, v91
    v_rcp_f32 v88, v88
    v_rcp_f32 v89, v89
    v_rcp_f32 v90, v90
    v_rcp_f32 v91, v91
    v_mul_f32 v84, v84, v88
    v_mul_f32 v85, v85, v89
    v_mul_f32 v86, v86, v90
    v_mul_f32 v87, v87, v91
    v_lshlrev_b32 v88, 16, v100
    v_and_b32 v89, 0xffff0000, v100
    v_lshlrev_b32 v90, 16, v101
    v_and_b32 v91, 0xffff0000, v101
    v_fma_f32 v188, v188, v84, v88
    v_fma_f32 v189, v189, v85, v89
    v_fma_f32 v190, v190, v86, v90
    v_fma_f32 v191, v191, v87, v91
    v_cvt_pk_bf16_f32 v188, v188, v189
    v_cvt_pk_bf16_f32 v189, v190, v191
    buffer_store_dwordx2 v[188:189], v60, s[48:51], 0 offen offset:256
L_k_final_kernel_end:
    s_endpgm
.section .rodata,"a"
.p2align 6
.amdhsa_kernel k_ln_kernel
  .amdhsa_next_free_vgpr 48
  .amdhsa_next_free_sgpr 102
  .amdhsa_accum_offset 48
  .amdhsa_group_segment_fixed_size 0
  .amdhsa_kernarg_size 96
  .amdhsa_user_sgpr_count 2
  .amdhsa_user_sgpr_kernarg_segment_ptr 1
  .amdhsa_system_sgpr_workgroup_id_x 1
.end_amdhsa_kernel
.p2align 6
.amdhsa_kernel k_qkv_kernel
  .amdhsa_next_free_vgpr 232
  .amdhsa_next_free_sgpr 102
  .amdhsa_accum_offset 232
  .amdhsa_group_segment_fixed_size 0
  .amdhsa_kernarg_size 96
  .amdhsa_user_sgpr_count 2
  .amdhsa_user_sgpr_kernarg_segment_ptr 1
  .amdhsa_system_sgpr_workgroup_id_x 1
.end_amdhsa_kernel
.p2align 6
.amdhsa_kernel k_l3_kernel
  .amdhsa_next_free_vgpr 232
  .amdhsa_next_free_sgpr 102
  .amdhsa_accum_offset 232
  .amdhsa_group_segment_fixed_size 0
  .amdhsa_kernarg_size 96
  .amdhsa_user_sgpr_count 2
  .amdhsa_user_sgpr_kernarg_segment_ptr 1
  .amdhsa_system_sgpr_workgroup_id_x 1
.end_amdhsa_kernel
.p2align 6
.amdhsa_kernel k_l4_kernel
  .amdhsa_next_free_vgpr 232
  .amdhsa_next_free_sgpr 102
  .amdhsa_accum_offset 232
  .amdhsa_group_segment_fixed_size 0
  .amdhsa_kernarg_size 96
  .amdhsa_user_sgpr_count 2
  .amdhsa_user_sgpr_kernarg_segment_ptr 1
  .amdhsa_system_sgpr_workgroup_id_x 1
.end_amdhsa_kernel
.p2align 6
.amdhsa_kernel k_final_kernel
  .amdhsa_next_free_vgpr 232
  .amdhsa_next_free_sgpr 102
  .amdhsa_accum_offset 232
  .amdhsa_group_segment_fixed_size 0
  .amdhsa_kernarg_size 96
  .amdhsa_user_sgpr_count 2
  .amdhsa_user_sgpr_kernarg_segment_ptr 1
  .amdhsa_system_sgpr_workgroup_id_x 1
.end_amdhsa_kernel
```
